```python
import torch

def _softmax(x, axis=-1):
    return torch.softmax(x, dim=axis)
def _gelu(x):
    return torch.nn.functional.gelu(x, approximate="tanh")
def _silu(x):
    return torch.nn.functional.silu(x)
def _sigmoid(x):
    return torch.sigmoid(x)
def _layernorm(x, axis=-1, eps=1e-5):
    m = x.mean(dim=axis, keepdim=True)
    v = x.var(dim=axis, keepdim=True, unbiased=False)
    return (x - m) / torch.sqrt(v + eps)
def _scatter_add(tgt, idx, src, axis=0):
    return tgt.clone().index_add_(axis, idx, src)
def _segment_sum(src, seg, n):
    out = torch.zeros((n,) + src.shape[1:], dtype=src.dtype)
    return out.index_add_(0, seg, src)
def _pad(x, pw):
    flat = tuple(v for pair in reversed(pw) for v in pair)
    return torch.nn.functional.pad(x, flat)

kernel_name = 'parallel_sum__spectral_gfnet__dense_activation_mish__prompt'

def setup_inputs():

    _w = (lambda a: (lambda t: t.to(torch.bfloat16) if t.is_floating_point() else t)(torch.as_tensor(a)))
    def _A_setup():
        B, S, D = 1, 2048, 576
        Df = D // 2 + 1
        return {
            "x": _w((lambda *s: torch.randn(*s, dtype=torch.bfloat16) * 0.05)(B, S, D)),
            "w_r": _w((lambda *s: torch.randn(*s, dtype=torch.bfloat16) * 0.8)(S, Df) * 0.02),
            "w_i": _w((lambda *s: torch.randn(*s, dtype=torch.bfloat16) * 0.8)(S, Df) * 0.02),
        }
    _A_in = _A_setup()

    def _B_setup():
        B, S, D, F = 1, 2048, 576, 4608
        return {
            "x": _w((lambda *s: torch.randn(*s, dtype=torch.bfloat16) * 0.05)(B, S, D)),
            "w1": _w((lambda *s: torch.randn(*s, dtype=torch.bfloat16) * 0.8)(D, F) * (D ** -0.5)),
            "b1": _w((lambda *s: torch.randn(*s, dtype=torch.bfloat16) * 0.2)(F)),
            "w2": _w((lambda *s: torch.randn(*s, dtype=torch.bfloat16) * 0.1)(F, D) * (F ** -0.5)),
        }
    _B_in = _B_setup()

    return {
        "A_x": _A_in["x"],
        "A_w_r": _A_in["w_r"],
        "A_w_i": _A_in["w_i"],
        "B_x": _B_in["x"],
        "B_w1": _B_in["w1"],
        "B_b1": _B_in["b1"],
        "B_w2": _B_in["w2"],
    }

def reference(A_x, A_w_r, A_w_i, B_x, B_w1, B_b1, B_w2):
    def _A_ref(x, w_r, w_i):
        B, S, D = x.shape
        X = (lambda x, axes=(-2,-1): torch.fft.rfft2(x.float(), dim=axes))(x, axes=(-2, -1))
        W = w_r + 1j * w_i
        X = X * W
        y = (lambda x, s, axes=(-2,-1): torch.fft.irfft2(x, s=s, dim=axes).to(torch.bfloat16))(X, (S, D), axes=(-2, -1))
        return y

    def _B_ref(x, w1, b1, w2):
        h = torch.einsum("bsd,df->bsf", x, w1) + b1
        sp = torch.log1p(torch.exp(-torch.abs(h))) + torch.where(h > 0, h, torch.zeros_like(h))
        act = h * torch.tanh(sp)
        return torch.einsum("bsf,fd->bsd", act, w2)

    x = A_x
    xn = _layernorm(x, axis=-1)
    return x + _A_ref(xn, A_w_r, A_w_i) + _B_ref(xn, B_w1, B_b1, B_w2)
```

```asm
; @launch grid=(256,1,1) block=(256,1,1) lds=161936
.amdgcn_target "amdgcn-amd-amdhsa--gfx950"
.text
.globl parallel_sum__spectral_gfnet__dense_activation_mish__prompt_kernel
.p2align 8
.type parallel_sum__spectral_gfnet__dense_activation_mish__prompt_kernel,@function
parallel_sum__spectral_gfnet__dense_activation_mish__prompt_kernel:
    s_cmp_ge_u32 s2, 256
    s_cbranch_scc1 L2_end
    s_load_dwordx4 s[4:7], s[0:1], 0
    s_load_dwordx2 s[24:25], s[0:1], 16
    s_load_dwordx2 s[26:27], s[0:1], 72
    s_load_dwordx2 s[28:29], s[0:1], 32
    s_load_dwordx2 s[30:31], s[0:1], 48
    s_load_dwordx2 s[60:61], s[0:1], 40
    s_getpc_b64 s[50:51]
L0_pc:
    s_lshr_b32 s40, s2, 3
    s_lshl_b32 s41, s40, 7
    v_lshlrev_b32 v1, 12, v0
    v_add_u32 v1, s41, v1
    v_min_u32 v1, L_text_end-L0_pc-4, v1
    v_cmp_gt_u32 vcc, 16, v0
    s_nop 0
    s_and_saveexec_b64 s[52:53], vcc
    s_cbranch_execz L0_nc
    global_load_dword v252, v1, s[50:51]
L0_nc:
    s_mov_b64 exec, s[52:53]
    s_cmp_ge_u32 s2, 192
    s_cbranch_scc1 L0_nx0
    s_and_b32 s16, s2, 63
    v_lshrrev_b32 v1, 3, v0
    v_and_b32 v2, 7, v0
    v_mul_u32_u24 v3, 73728, v1
    v_lshl_add_u32 v3, v2, 4, v3
    s_mul_i32 s18, s16, 1152
    s_mov_b32 s10, 2359296
    s_mov_b32 s11, 0x20000
    s_waitcnt lgkmcnt(0)
    s_mov_b64 s[8:9], s[4:5]
    buffer_load_dwordx4 v[16:19], v3, s[8:11], s18 offen offset:0
    buffer_load_dwordx4 v[20:23], v3, s[8:11], s18 offen offset:128
    buffer_load_dwordx4 v[24:27], v3, s[8:11], s18 offen offset:256
    buffer_load_dwordx4 v[28:31], v3, s[8:11], s18 offen offset:384
    buffer_load_dwordx4 v[32:35], v3, s[8:11], s18 offen offset:512
    buffer_load_dwordx4 v[36:39], v3, s[8:11], s18 offen offset:640
    buffer_load_dwordx4 v[40:43], v3, s[8:11], s18 offen offset:768
    buffer_load_dwordx4 v[44:47], v3, s[8:11], s18 offen offset:896
    buffer_load_dwordx4 v[48:51], v3, s[8:11], s18 offen offset:1024
L0_nx0:
    v_lshrrev_b32 v4, 6, v0
    s_nop 0
    v_readfirstlane_b32 s19, v4
    v_and_b32 v5, 31, v0
    v_bfe_u32 v6, v0, 5, 1
    v_lshlrev_b32 v248, 4, v0
    s_lshl_b32 s41, s2, 4
    v_mov_b32 v249, s41
    s_mov_b32 s62, 48824320
    v_mov_b32 v250, 161920
    v_mov_b32 v251, 0
    ds_write_b32 v250, v251
    s_and_b32 s41, s2, 1
    s_lshl_b32 s41, s41, 3
    s_lshr_b32 s42, s2, 5
    s_add_u32 s41, s41, s42
    s_lshl_b32 s41, s41, 10
    s_add_u32 s41, s41, 4096
    v_and_b32 v253, 15, v0
    v_min_u32 v253, 8, v253
    v_lshlrev_b32 v1, 4, v4
    v_add_u32 v253, v253, v1
    v_lshlrev_b32 v253, 4, v253
    v_add_u32 v253, s41, v253
    v_mov_b32 v254, 0x10000000
    s_bfe_u32 s42, s2, 0x10003
    s_and_b32 s43, s2, 6
    s_bfe_u32 s58, s2, 0x10004
    s_add_u32 s43, s43, s58
    s_mul_i32 s96, s43, 1152
    s_mul_i32 s97, s42, 576
    s_add_u32 s97, s97, s96
    s_lshl_b32 s43, s42, 10
    s_add_u32 s96, s96, s43
    v_lshrrev_b32 v1, 4, v0
    v_sub_u32 v2, 8, v1
    s_cmp_eq_u32 s42, 1
    s_cselect_b64 vcc, -1, 0
    v_cndmask_b32 v1, v1, v2, vcc
    v_and_b32 v2, 15, v0
    v_lshlrev_b32 v2, 2, v2
    v_lshl_add_u32 v255, v1, 6, v2
    s_cmp_ge_u32 s2, 192
    s_cbranch_scc1 L0_helper
    s_and_b32 s16, s2, 63
    s_lshr_b32 s17, s2, 6
    v_lshrrev_b32 v1, 3, v0
    v_and_b32 v2, 7, v0
    v_mul_u32_u24 v3, 73728, v1
    v_lshl_add_u32 v3, v2, 4, v3
    s_mul_i32 s18, s16, 1152
    v_and_b32 v8, 3, v5
    v_bfe_u32 v9, v5, 3, 2
    v_lshl_add_u32 v8, v9, 2, v8
    v_bfe_u32 v9, v5, 2, 1
    v_lshl_add_u32 v8, v9, 4, v8
    v_and_b32 v9, 15, v8
    v_lshrrev_b32 v7, 4, v8
    v_lshl_add_u32 v7, v9, 1, v7
    s_mul_i32 s20, s17, 3
    s_add_u32 s20, s20, s19
    s_lshl_b32 s21, s16, 4
    s_add_u32 s21, s21, s20
    s_lshl_b32 s21, s21, 4
    s_add_u32 s21, s21, 4096
    v_mov_b32 v254, s21
    s_lshl_b32 s21, s20, 5
    v_add_u32 v7, s21, v7
    v_cmp_eq_u32 s[44:45], 0, v7
    v_and_b32 v8, 1, v7
    v_cmp_eq_u32 s[46:47], 1, v8
    v_lshlrev_b32 v8, 31, v8
    v_or_b32 v10, 1.0, v8
    v_bfe_u32 v8, v7, 1, 1
    v_mul_u32_u24 v8, 0x8000, v8
    v_lshl_add_u32 v244, v8, 16, v8
    v_add_u32 v8, 1, v7
    v_bfe_u32 v8, v8, 1, 1
    v_mul_u32_u24 v8, 0x8000, v8
    v_lshl_add_u32 v245, v8, 16, v8
    v_cvt_f32_u32 v7, v7
    v_mul_f32 v7, 0x3ae38e39, v7
    v_cvt_f32_u32 v8, v6
    v_mul_f32 v8, 0x41000000, v8
    v_mul_f32 v8, v8, v7
    v_mul_f32 v246, 0x41800000, v7
    v_cos_f32 v246, v246
    s_nop 0
    v_add_f32 v246, v246, v246
    v_mov_b32 v247, v246
    s_waitcnt lgkmcnt(0)
    s_mov_b32 s12, s26
    s_mov_b32 s13, s27
    s_mov_b32 s14, 49029120
    s_mov_b32 s15, 0x20000
    s_mov_b32 s36, s60
    s_mov_b32 s37, s61
    s_mov_b32 s38, 9216
    s_mov_b32 s39, 0x20000
    buffer_load_dword a4, v255, s[36:39], s97 offen
    buffer_load_dword a0, v248, s[12:15], s62 offen sc1
    buffer_load_dword a1, v249, s[12:15], s62 offen sc1
    buffer_load_dword a2, v253, s[12:15], s62 offen sc1
    buffer_load_dword a3, v254, s[12:15], s62 offen sc1
    s_cmp_eq_u32 s19, 3
    s_cbranch_scc1 L0_w3a
    v_mov_b32 v124, v8
    v_fmamk_f32 v125, v7, 0x3f800000, v8
    v_fmamk_f32 v126, v7, 0x40000000, v8
    v_fmamk_f32 v127, v7, 0x40400000, v8
    v_fmamk_f32 v128, v7, 0x40800000, v8
    v_fmamk_f32 v129, v7, 0x40a00000, v8
    v_fmamk_f32 v130, v7, 0x40c00000, v8
    v_fmamk_f32 v131, v7, 0x40e00000, v8
    v_cos_f32 v52, v124
    v_sin_f32_e64 v60, -v124
    v_cos_f32 v53, v125
    v_sin_f32_e64 v61, -v125
    v_cos_f32 v54, v126
    v_sin_f32_e64 v62, -v126
    v_cos_f32 v55, v127
    v_sin_f32_e64 v63, -v127
    v_cos_f32 v56, v128
    v_sin_f32_e64 v64, -v128
    v_cos_f32 v57, v129
    v_sin_f32_e64 v65, -v129
    v_cos_f32 v58, v130
    v_sin_f32_e64 v66, -v130
    v_cos_f32 v59, v131
    v_sin_f32_e64 v67, -v131
    v_cndmask_b32 v60, v60, 1.0, s[44:45]
    v_cndmask_b32 v61, v61, -1.0, s[44:45]
    v_cndmask_b32 v62, v62, 1.0, s[44:45]
    v_cndmask_b32 v63, v63, -1.0, s[44:45]
    v_cndmask_b32 v64, v64, 1.0, s[44:45]
    v_cndmask_b32 v65, v65, -1.0, s[44:45]
    v_cndmask_b32 v66, v66, 1.0, s[44:45]
    v_cndmask_b32 v67, v67, -1.0, s[44:45]
    v_cvt_pk_bf16_f32 v148, v52, v53
    v_cvt_pk_bf16_f32 v149, v54, v55
    v_cvt_pk_bf16_f32 v150, v56, v57
    v_cvt_pk_bf16_f32 v151, v58, v59
    v_cvt_pk_bf16_f32 v152, v60, v61
    v_cvt_pk_bf16_f32 v153, v62, v63
    v_cvt_pk_bf16_f32 v154, v64, v65
    v_cvt_pk_bf16_f32 v155, v66, v67
    v_fmamk_f32 v124, v7, 0x41800000, v8
    v_fmamk_f32 v125, v7, 0x41880000, v8
    v_fmamk_f32 v126, v7, 0x41900000, v8
    v_fmamk_f32 v127, v7, 0x41980000, v8
    v_fmamk_f32 v128, v7, 0x41a00000, v8
    v_fmamk_f32 v129, v7, 0x41a80000, v8
    v_fmamk_f32 v130, v7, 0x41b00000, v8
    v_fmamk_f32 v131, v7, 0x41b80000, v8
    v_cos_f32 v68, v124
    v_sin_f32_e64 v76, -v124
    v_cos_f32 v69, v125
    v_sin_f32_e64 v77, -v125
    v_cos_f32 v70, v126
    v_sin_f32_e64 v78, -v126
    v_cos_f32 v71, v127
    v_sin_f32_e64 v79, -v127
    v_cos_f32 v72, v128
    v_sin_f32_e64 v80, -v128
    v_cos_f32 v73, v129
    v_sin_f32_e64 v81, -v129
    v_cos_f32 v74, v130
    v_sin_f32_e64 v82, -v130
    v_cos_f32 v75, v131
    v_sin_f32_e64 v83, -v131
    v_cndmask_b32 v76, v76, 1.0, s[44:45]
    v_cndmask_b32 v77, v77, -1.0, s[44:45]
    v_cndmask_b32 v78, v78, 1.0, s[44:45]
    v_cndmask_b32 v79, v79, -1.0, s[44:45]
    v_cndmask_b32 v80, v80, 1.0, s[44:45]
    v_cndmask_b32 v81, v81, -1.0, s[44:45]
    v_cndmask_b32 v82, v82, 1.0, s[44:45]
    v_cndmask_b32 v83, v83, -1.0, s[44:45]
    v_cvt_pk_bf16_f32 v156, v68, v69
    v_cvt_pk_bf16_f32 v157, v70, v71
    v_cvt_pk_bf16_f32 v158, v72, v73
    v_cvt_pk_bf16_f32 v159, v74, v75
    v_cvt_pk_bf16_f32 v160, v76, v77
    v_cvt_pk_bf16_f32 v161, v78, v79
    v_cvt_pk_bf16_f32 v162, v80, v81
    v_cvt_pk_bf16_f32 v163, v82, v83
    v_pk_fma_f32 v[52:53], v[68:69], v[246:247], v[52:53] neg_lo:[0,0,1] neg_hi:[0,0,1]
    v_pk_fma_f32 v[54:55], v[70:71], v[246:247], v[54:55] neg_lo:[0,0,1] neg_hi:[0,0,1]
    v_pk_fma_f32 v[56:57], v[72:73], v[246:247], v[56:57] neg_lo:[0,0,1] neg_hi:[0,0,1]
    v_pk_fma_f32 v[58:59], v[74:75], v[246:247], v[58:59] neg_lo:[0,0,1] neg_hi:[0,0,1]
    v_pk_fma_f32 v[60:61], v[76:77], v[246:247], v[60:61] neg_lo:[0,0,1] neg_hi:[0,0,1]
    v_pk_fma_f32 v[62:63], v[78:79], v[246:247], v[62:63] neg_lo:[0,0,1] neg_hi:[0,0,1]
    v_pk_fma_f32 v[64:65], v[80:81], v[246:247], v[64:65] neg_lo:[0,0,1] neg_hi:[0,0,1]
    v_pk_fma_f32 v[66:67], v[82:83], v[246:247], v[66:67] neg_lo:[0,0,1] neg_hi:[0,0,1]
    v_cvt_pk_bf16_f32 v164, v52, v53
    v_cvt_pk_bf16_f32 v165, v54, v55
    v_cvt_pk_bf16_f32 v166, v56, v57
    v_cvt_pk_bf16_f32 v167, v58, v59
    v_cvt_pk_bf16_f32 v168, v60, v61
    v_cvt_pk_bf16_f32 v169, v62, v63
    v_cvt_pk_bf16_f32 v170, v64, v65
    v_cvt_pk_bf16_f32 v171, v66, v67
    v_pk_fma_f32 v[68:69], v[52:53], v[246:247], v[68:69] neg_lo:[0,0,1] neg_hi:[0,0,1]
    v_pk_fma_f32 v[70:71], v[54:55], v[246:247], v[70:71] neg_lo:[0,0,1] neg_hi:[0,0,1]
    v_pk_fma_f32 v[72:73], v[56:57], v[246:247], v[72:73] neg_lo:[0,0,1] neg_hi:[0,0,1]
    v_pk_fma_f32 v[74:75], v[58:59], v[246:247], v[74:75] neg_lo:[0,0,1] neg_hi:[0,0,1]
    v_pk_fma_f32 v[76:77], v[60:61], v[246:247], v[76:77] neg_lo:[0,0,1] neg_hi:[0,0,1]
    v_pk_fma_f32 v[78:79], v[62:63], v[246:247], v[78:79] neg_lo:[0,0,1] neg_hi:[0,0,1]
    v_pk_fma_f32 v[80:81], v[64:65], v[246:247], v[80:81] neg_lo:[0,0,1] neg_hi:[0,0,1]
    v_pk_fma_f32 v[82:83], v[66:67], v[246:247], v[82:83] neg_lo:[0,0,1] neg_hi:[0,0,1]
    v_cvt_pk_bf16_f32 v172, v68, v69
    v_cvt_pk_bf16_f32 v173, v70, v71
    v_cvt_pk_bf16_f32 v174, v72, v73
    v_cvt_pk_bf16_f32 v175, v74, v75
    v_cvt_pk_bf16_f32 v176, v76, v77
    v_cvt_pk_bf16_f32 v177, v78, v79
    v_cvt_pk_bf16_f32 v178, v80, v81
    v_cvt_pk_bf16_f32 v179, v82, v83
    v_pk_fma_f32 v[52:53], v[68:69], v[246:247], v[52:53] neg_lo:[0,0,1] neg_hi:[0,0,1]
    v_pk_fma_f32 v[54:55], v[70:71], v[246:247], v[54:55] neg_lo:[0,0,1] neg_hi:[0,0,1]
    v_pk_fma_f32 v[56:57], v[72:73], v[246:247], v[56:57] neg_lo:[0,0,1] neg_hi:[0,0,1]
    v_pk_fma_f32 v[58:59], v[74:75], v[246:247], v[58:59] neg_lo:[0,0,1] neg_hi:[0,0,1]
    v_pk_fma_f32 v[60:61], v[76:77], v[246:247], v[60:61] neg_lo:[0,0,1] neg_hi:[0,0,1]
    v_pk_fma_f32 v[62:63], v[78:79], v[246:247], v[62:63] neg_lo:[0,0,1] neg_hi:[0,0,1]
    v_pk_fma_f32 v[64:65], v[80:81], v[246:247], v[64:65] neg_lo:[0,0,1] neg_hi:[0,0,1]
    v_pk_fma_f32 v[66:67], v[82:83], v[246:247], v[66:67] neg_lo:[0,0,1] neg_hi:[0,0,1]
    v_cvt_pk_bf16_f32 v180, v52, v53
    v_cvt_pk_bf16_f32 v181, v54, v55
    v_cvt_pk_bf16_f32 v182, v56, v57
    v_cvt_pk_bf16_f32 v183, v58, v59
    v_cvt_pk_bf16_f32 v184, v60, v61
    v_cvt_pk_bf16_f32 v185, v62, v63
    v_cvt_pk_bf16_f32 v186, v64, v65
    v_cvt_pk_bf16_f32 v187, v66, v67
    v_pk_fma_f32 v[68:69], v[52:53], v[246:247], v[68:69] neg_lo:[0,0,1] neg_hi:[0,0,1]
    v_pk_fma_f32 v[70:71], v[54:55], v[246:247], v[70:71] neg_lo:[0,0,1] neg_hi:[0,0,1]
    v_pk_fma_f32 v[72:73], v[56:57], v[246:247], v[72:73] neg_lo:[0,0,1] neg_hi:[0,0,1]
    v_pk_fma_f32 v[74:75], v[58:59], v[246:247], v[74:75] neg_lo:[0,0,1] neg_hi:[0,0,1]
    v_pk_fma_f32 v[76:77], v[60:61], v[246:247], v[76:77] neg_lo:[0,0,1] neg_hi:[0,0,1]
    v_pk_fma_f32 v[78:79], v[62:63], v[246:247], v[78:79] neg_lo:[0,0,1] neg_hi:[0,0,1]
    v_pk_fma_f32 v[80:81], v[64:65], v[246:247], v[80:81] neg_lo:[0,0,1] neg_hi:[0,0,1]
    v_pk_fma_f32 v[82:83], v[66:67], v[246:247], v[82:83] neg_lo:[0,0,1] neg_hi:[0,0,1]
    v_cvt_pk_bf16_f32 v188, v68, v69
    v_cvt_pk_bf16_f32 v189, v70, v71
    v_cvt_pk_bf16_f32 v190, v72, v73
    v_cvt_pk_bf16_f32 v191, v74, v75
    v_cvt_pk_bf16_f32 v192, v76, v77
    v_cvt_pk_bf16_f32 v193, v78, v79
    v_cvt_pk_bf16_f32 v194, v80, v81
    v_cvt_pk_bf16_f32 v195, v82, v83
    v_pk_fma_f32 v[52:53], v[68:69], v[246:247], v[52:53] neg_lo:[0,0,1] neg_hi:[0,0,1]
    v_pk_fma_f32 v[54:55], v[70:71], v[246:247], v[54:55] neg_lo:[0,0,1] neg_hi:[0,0,1]
    v_pk_fma_f32 v[56:57], v[72:73], v[246:247], v[56:57] neg_lo:[0,0,1] neg_hi:[0,0,1]
    v_pk_fma_f32 v[58:59], v[74:75], v[246:247], v[58:59] neg_lo:[0,0,1] neg_hi:[0,0,1]
    v_pk_fma_f32 v[60:61], v[76:77], v[246:247], v[60:61] neg_lo:[0,0,1] neg_hi:[0,0,1]
    v_pk_fma_f32 v[62:63], v[78:79], v[246:247], v[62:63] neg_lo:[0,0,1] neg_hi:[0,0,1]
    v_pk_fma_f32 v[64:65], v[80:81], v[246:247], v[64:65] neg_lo:[0,0,1] neg_hi:[0,0,1]
    v_pk_fma_f32 v[66:67], v[82:83], v[246:247], v[66:67] neg_lo:[0,0,1] neg_hi:[0,0,1]
    v_cvt_pk_bf16_f32 v196, v52, v53
    v_cvt_pk_bf16_f32 v197, v54, v55
    v_cvt_pk_bf16_f32 v198, v56, v57
    v_cvt_pk_bf16_f32 v199, v58, v59
    v_cvt_pk_bf16_f32 v200, v60, v61
    v_cvt_pk_bf16_f32 v201, v62, v63
    v_cvt_pk_bf16_f32 v202, v64, v65
    v_cvt_pk_bf16_f32 v203, v66, v67
    v_pk_fma_f32 v[68:69], v[52:53], v[246:247], v[68:69] neg_lo:[0,0,1] neg_hi:[0,0,1]
    v_pk_fma_f32 v[70:71], v[54:55], v[246:247], v[70:71] neg_lo:[0,0,1] neg_hi:[0,0,1]
    v_pk_fma_f32 v[72:73], v[56:57], v[246:247], v[72:73] neg_lo:[0,0,1] neg_hi:[0,0,1]
    v_pk_fma_f32 v[74:75], v[58:59], v[246:247], v[74:75] neg_lo:[0,0,1] neg_hi:[0,0,1]
    v_pk_fma_f32 v[76:77], v[60:61], v[246:247], v[76:77] neg_lo:[0,0,1] neg_hi:[0,0,1]
    v_pk_fma_f32 v[78:79], v[62:63], v[246:247], v[78:79] neg_lo:[0,0,1] neg_hi:[0,0,1]
    v_pk_fma_f32 v[80:81], v[64:65], v[246:247], v[80:81] neg_lo:[0,0,1] neg_hi:[0,0,1]
    v_pk_fma_f32 v[82:83], v[66:67], v[246:247], v[82:83] neg_lo:[0,0,1] neg_hi:[0,0,1]
    v_cvt_pk_bf16_f32 v204, v68, v69
    v_cvt_pk_bf16_f32 v205, v70, v71
    v_cvt_pk_bf16_f32 v206, v72, v73
    v_cvt_pk_bf16_f32 v207, v74, v75
    v_cvt_pk_bf16_f32 v208, v76, v77
    v_cvt_pk_bf16_f32 v209, v78, v79
    v_cvt_pk_bf16_f32 v210, v80, v81
    v_cvt_pk_bf16_f32 v211, v82, v83
    v_pk_fma_f32 v[52:53], v[68:69], v[246:247], v[52:53] neg_lo:[0,0,1] neg_hi:[0,0,1]
    v_pk_fma_f32 v[54:55], v[70:71], v[246:247], v[54:55] neg_lo:[0,0,1] neg_hi:[0,0,1]
    v_pk_fma_f32 v[56:57], v[72:73], v[246:247], v[56:57] neg_lo:[0,0,1] neg_hi:[0,0,1]
    v_pk_fma_f32 v[58:59], v[74:75], v[246:247], v[58:59] neg_lo:[0,0,1] neg_hi:[0,0,1]
    v_pk_fma_f32 v[60:61], v[76:77], v[246:247], v[60:61] neg_lo:[0,0,1] neg_hi:[0,0,1]
    v_pk_fma_f32 v[62:63], v[78:79], v[246:247], v[62:63] neg_lo:[0,0,1] neg_hi:[0,0,1]
    v_pk_fma_f32 v[64:65], v[80:81], v[246:247], v[64:65] neg_lo:[0,0,1] neg_hi:[0,0,1]
    v_pk_fma_f32 v[66:67], v[82:83], v[246:247], v[66:67] neg_lo:[0,0,1] neg_hi:[0,0,1]
    v_cvt_pk_bf16_f32 v212, v52, v53
    v_cvt_pk_bf16_f32 v213, v54, v55
    v_cvt_pk_bf16_f32 v214, v56, v57
    v_cvt_pk_bf16_f32 v215, v58, v59
    v_cvt_pk_bf16_f32 v216, v60, v61
    v_cvt_pk_bf16_f32 v217, v62, v63
    v_cvt_pk_bf16_f32 v218, v64, v65
    v_cvt_pk_bf16_f32 v219, v66, v67
    v_mov_b32 v12, 0
    v_mov_b32 v13, 0
    v_mov_b32 v14, 0
    v_mov_b32 v15, 0
    s_waitcnt vmcnt(13)
    v_lshlrev_b32 v52, 16, v16
    v_and_b32 v53, 0xffff0000, v16
    v_lshlrev_b32 v54, 16, v17
    v_and_b32 v55, 0xffff0000, v17
    v_lshlrev_b32 v56, 16, v18
    v_and_b32 v57, 0xffff0000, v18
    v_lshlrev_b32 v58, 16, v19
    v_and_b32 v59, 0xffff0000, v19
    v_pk_add_f32 v[12:13], v[12:13], v[52:53]
    v_pk_add_f32 v[14:15], v[14:15], v[54:55]
    v_pk_add_f32 v[12:13], v[12:13], v[56:57]
    v_pk_add_f32 v[14:15], v[14:15], v[58:59]
    s_waitcnt vmcnt(12)
    v_lshlrev_b32 v60, 16, v20
    v_and_b32 v61, 0xffff0000, v20
    v_lshlrev_b32 v62, 16, v21
    v_and_b32 v63, 0xffff0000, v21
    v_lshlrev_b32 v64, 16, v22
    v_and_b32 v65, 0xffff0000, v22
    v_lshlrev_b32 v66, 16, v23
    v_and_b32 v67, 0xffff0000, v23
    v_pk_add_f32 v[12:13], v[12:13], v[60:61]
    v_pk_add_f32 v[14:15], v[14:15], v[62:63]
    v_pk_add_f32 v[12:13], v[12:13], v[64:65]
    v_pk_add_f32 v[14:15], v[14:15], v[66:67]
    s_waitcnt vmcnt(11)
    v_lshlrev_b32 v68, 16, v24
    v_and_b32 v69, 0xffff0000, v24
    v_lshlrev_b32 v70, 16, v25
    v_and_b32 v71, 0xffff0000, v25
    v_lshlrev_b32 v72, 16, v26
    v_and_b32 v73, 0xffff0000, v26
    v_lshlrev_b32 v74, 16, v27
    v_and_b32 v75, 0xffff0000, v27
    v_pk_add_f32 v[12:13], v[12:13], v[68:69]
    v_pk_add_f32 v[14:15], v[14:15], v[70:71]
    v_pk_add_f32 v[12:13], v[12:13], v[72:73]
    v_pk_add_f32 v[14:15], v[14:15], v[74:75]
    s_waitcnt vmcnt(10)
    v_lshlrev_b32 v76, 16, v28
    v_and_b32 v77, 0xffff0000, v28
    v_lshlrev_b32 v78, 16, v29
    v_and_b32 v79, 0xffff0000, v29
    v_lshlrev_b32 v80, 16, v30
    v_and_b32 v81, 0xffff0000, v30
    v_lshlrev_b32 v82, 16, v31
    v_and_b32 v83, 0xffff0000, v31
    v_pk_add_f32 v[12:13], v[12:13], v[76:77]
    v_pk_add_f32 v[14:15], v[14:15], v[78:79]
    v_pk_add_f32 v[12:13], v[12:13], v[80:81]
    v_pk_add_f32 v[14:15], v[14:15], v[82:83]
    s_waitcnt vmcnt(9)
    v_lshlrev_b32 v84, 16, v32
    v_and_b32 v85, 0xffff0000, v32
    v_lshlrev_b32 v86, 16, v33
    v_and_b32 v87, 0xffff0000, v33
    v_lshlrev_b32 v88, 16, v34
    v_and_b32 v89, 0xffff0000, v34
    v_lshlrev_b32 v90, 16, v35
    v_and_b32 v91, 0xffff0000, v35
    v_pk_add_f32 v[12:13], v[12:13], v[84:85]
    v_pk_add_f32 v[14:15], v[14:15], v[86:87]
    v_pk_add_f32 v[12:13], v[12:13], v[88:89]
    v_pk_add_f32 v[14:15], v[14:15], v[90:91]
    s_waitcnt vmcnt(8)
    v_lshlrev_b32 v92, 16, v36
    v_and_b32 v93, 0xffff0000, v36
    v_lshlrev_b32 v94, 16, v37
    v_and_b32 v95, 0xffff0000, v37
    v_lshlrev_b32 v96, 16, v38
    v_and_b32 v97, 0xffff0000, v38
    v_lshlrev_b32 v98, 16, v39
    v_and_b32 v99, 0xffff0000, v39
    v_pk_add_f32 v[12:13], v[12:13], v[92:93]
    v_pk_add_f32 v[14:15], v[14:15], v[94:95]
    v_pk_add_f32 v[12:13], v[12:13], v[96:97]
    v_pk_add_f32 v[14:15], v[14:15], v[98:99]
    s_waitcnt vmcnt(7)
    v_lshlrev_b32 v100, 16, v40
    v_and_b32 v101, 0xffff0000, v40
    v_lshlrev_b32 v102, 16, v41
    v_and_b32 v103, 0xffff0000, v41
    v_lshlrev_b32 v104, 16, v42
    v_and_b32 v105, 0xffff0000, v42
    v_lshlrev_b32 v106, 16, v43
    v_and_b32 v107, 0xffff0000, v43
    v_pk_add_f32 v[12:13], v[12:13], v[100:101]
    v_pk_add_f32 v[14:15], v[14:15], v[102:103]
    v_pk_add_f32 v[12:13], v[12:13], v[104:105]
    v_pk_add_f32 v[14:15], v[14:15], v[106:107]
    s_waitcnt vmcnt(6)
    v_lshlrev_b32 v108, 16, v44
    v_and_b32 v109, 0xffff0000, v44
    v_lshlrev_b32 v110, 16, v45
    v_and_b32 v111, 0xffff0000, v45
    v_lshlrev_b32 v112, 16, v46
    v_and_b32 v113, 0xffff0000, v46
    v_lshlrev_b32 v114, 16, v47
    v_and_b32 v115, 0xffff0000, v47
    v_pk_add_f32 v[12:13], v[12:13], v[108:109]
    v_pk_add_f32 v[14:15], v[14:15], v[110:111]
    v_pk_add_f32 v[12:13], v[12:13], v[112:113]
    v_pk_add_f32 v[14:15], v[14:15], v[114:115]
    s_waitcnt vmcnt(5)
    v_lshlrev_b32 v116, 16, v48
    v_and_b32 v117, 0xffff0000, v48
    v_lshlrev_b32 v118, 16, v49
    v_and_b32 v119, 0xffff0000, v49
    v_lshlrev_b32 v120, 16, v50
    v_and_b32 v121, 0xffff0000, v50
    v_lshlrev_b32 v122, 16, v51
    v_and_b32 v123, 0xffff0000, v51
    v_pk_add_f32 v[12:13], v[12:13], v[116:117]
    v_pk_add_f32 v[14:15], v[14:15], v[118:119]
    v_pk_add_f32 v[12:13], v[12:13], v[120:121]
    v_pk_add_f32 v[14:15], v[14:15], v[122:123]
L0_ln2:
    v_pk_add_f32 v[12:13], v[12:13], v[14:15]
    v_add_f32 v12, v12, v13
    s_nop 1
    v_add_f32_dpp v12, v12, v12 quad_perm:[1,0,3,2] row_mask:0xf bank_mask:0xf
    s_nop 1
    v_add_f32_dpp v12, v12, v12 quad_perm:[2,3,0,1] row_mask:0xf bank_mask:0xf
    s_nop 1
    v_add_f32_dpp v12, v12, v12 row_half_mirror row_mask:0xf bank_mask:0xf
    v_mul_f32 v12, 0x3ae38e39, v12
    v_cvt_pk_bf16_f32 v14, v12, v12
    v_lshlrev_b32 v14, 16, v14
    v_mov_b32 v15, v14
    v_sub_f32 v11, v12, v14
    v_mov_b32 v124, 0
    v_mov_b32 v125, 0
    v_mov_b32 v126, 0
    v_mov_b32 v127, 0
    v_pk_add_f32 v[52:53], v[52:53], v[14:15] neg_lo:[0,1] neg_hi:[0,1]
    v_pk_add_f32 v[54:55], v[54:55], v[14:15] neg_lo:[0,1] neg_hi:[0,1]
    v_pk_add_f32 v[56:57], v[56:57], v[14:15] neg_lo:[0,1] neg_hi:[0,1]
    v_pk_add_f32 v[58:59], v[58:59], v[14:15] neg_lo:[0,1] neg_hi:[0,1]
    v_pk_add_f32 v[60:61], v[60:61], v[14:15] neg_lo:[0,1] neg_hi:[0,1]
    v_pk_add_f32 v[62:63], v[62:63], v[14:15] neg_lo:[0,1] neg_hi:[0,1]
    v_pk_add_f32 v[64:65], v[64:65], v[14:15] neg_lo:[0,1] neg_hi:[0,1]
    v_pk_add_f32 v[66:67], v[66:67], v[14:15] neg_lo:[0,1] neg_hi:[0,1]
    v_pk_add_f32 v[68:69], v[68:69], v[14:15] neg_lo:[0,1] neg_hi:[0,1]
    v_pk_add_f32 v[70:71], v[70:71], v[14:15] neg_lo:[0,1] neg_hi:[0,1]
    v_pk_add_f32 v[72:73], v[72:73], v[14:15] neg_lo:[0,1] neg_hi:[0,1]
    v_pk_add_f32 v[74:75], v[74:75], v[14:15] neg_lo:[0,1] neg_hi:[0,1]
    v_pk_add_f32 v[76:77], v[76:77], v[14:15] neg_lo:[0,1] neg_hi:[0,1]
    v_pk_add_f32 v[78:79], v[78:79], v[14:15] neg_lo:[0,1] neg_hi:[0,1]
    v_pk_add_f32 v[80:81], v[80:81], v[14:15] neg_lo:[0,1] neg_hi:[0,1]
    v_pk_add_f32 v[82:83], v[82:83], v[14:15] neg_lo:[0,1] neg_hi:[0,1]
    v_pk_add_f32 v[84:85], v[84:85], v[14:15] neg_lo:[0,1] neg_hi:[0,1]
    v_pk_add_f32 v[86:87], v[86:87], v[14:15] neg_lo:[0,1] neg_hi:[0,1]
    v_pk_add_f32 v[88:89], v[88:89], v[14:15] neg_lo:[0,1] neg_hi:[0,1]
    v_pk_add_f32 v[90:91], v[90:91], v[14:15] neg_lo:[0,1] neg_hi:[0,1]
    v_pk_add_f32 v[92:93], v[92:93], v[14:15] neg_lo:[0,1] neg_hi:[0,1]
    v_pk_add_f32 v[94:95], v[94:95], v[14:15] neg_lo:[0,1] neg_hi:[0,1]
    v_pk_add_f32 v[96:97], v[96:97], v[14:15] neg_lo:[0,1] neg_hi:[0,1]
    v_pk_add_f32 v[98:99], v[98:99], v[14:15] neg_lo:[0,1] neg_hi:[0,1]
    v_pk_add_f32 v[100:101], v[100:101], v[14:15] neg_lo:[0,1] neg_hi:[0,1]
    v_pk_add_f32 v[102:103], v[102:103], v[14:15] neg_lo:[0,1] neg_hi:[0,1]
    v_pk_add_f32 v[104:105], v[104:105], v[14:15] neg_lo:[0,1] neg_hi:[0,1]
    v_pk_add_f32 v[106:107], v[106:107], v[14:15] neg_lo:[0,1] neg_hi:[0,1]
    v_pk_add_f32 v[108:109], v[108:109], v[14:15] neg_lo:[0,1] neg_hi:[0,1]
    v_pk_add_f32 v[110:111], v[110:111], v[14:15] neg_lo:[0,1] neg_hi:[0,1]
    v_pk_add_f32 v[112:113], v[112:113], v[14:15] neg_lo:[0,1] neg_hi:[0,1]
    v_pk_add_f32 v[114:115], v[114:115], v[14:15] neg_lo:[0,1] neg_hi:[0,1]
    v_pk_add_f32 v[116:117], v[116:117], v[14:15] neg_lo:[0,1] neg_hi:[0,1]
    v_pk_add_f32 v[118:119], v[118:119], v[14:15] neg_lo:[0,1] neg_hi:[0,1]
    v_pk_add_f32 v[120:121], v[120:121], v[14:15] neg_lo:[0,1] neg_hi:[0,1]
    v_pk_add_f32 v[122:123], v[122:123], v[14:15] neg_lo:[0,1] neg_hi:[0,1]
    v_pk_fma_f32 v[124:125], v[52:53], v[52:53], v[124:125]
    v_pk_fma_f32 v[126:127], v[54:55], v[54:55], v[126:127]
    v_pk_fma_f32 v[124:125], v[56:57], v[56:57], v[124:125]
    v_pk_fma_f32 v[126:127], v[58:59], v[58:59], v[126:127]
    v_pk_fma_f32 v[124:125], v[60:61], v[60:61], v[124:125]
    v_pk_fma_f32 v[126:127], v[62:63], v[62:63], v[126:127]
    v_pk_fma_f32 v[124:125], v[64:65], v[64:65], v[124:125]
    v_pk_fma_f32 v[126:127], v[66:67], v[66:67], v[126:127]
    v_pk_fma_f32 v[124:125], v[68:69], v[68:69], v[124:125]
    v_pk_fma_f32 v[126:127], v[70:71], v[70:71], v[126:127]
    v_pk_fma_f32 v[124:125], v[72:73], v[72:73], v[124:125]
    v_pk_fma_f32 v[126:127], v[74:75], v[74:75], v[126:127]
    v_pk_fma_f32 v[124:125], v[76:77], v[76:77], v[124:125]
    v_pk_fma_f32 v[126:127], v[78:79], v[78:79], v[126:127]
    v_pk_fma_f32 v[124:125], v[80:81], v[80:81], v[124:125]
    v_pk_fma_f32 v[126:127], v[82:83], v[82:83], v[126:127]
    v_pk_fma_f32 v[124:125], v[84:85], v[84:85], v[124:125]
    v_pk_fma_f32 v[126:127], v[86:87], v[86:87], v[126:127]
    v_pk_fma_f32 v[124:125], v[88:89], v[88:89], v[124:125]
    v_pk_fma_f32 v[126:127], v[90:91], v[90:91], v[126:127]
    v_pk_fma_f32 v[124:125], v[92:93], v[92:93], v[124:125]
    v_pk_fma_f32 v[126:127], v[94:95], v[94:95], v[126:127]
    v_pk_fma_f32 v[124:125], v[96:97], v[96:97], v[124:125]
    v_pk_fma_f32 v[126:127], v[98:99], v[98:99], v[126:127]
    v_pk_fma_f32 v[124:125], v[100:101], v[100:101], v[124:125]
    v_pk_fma_f32 v[126:127], v[102:103], v[102:103], v[126:127]
    v_pk_fma_f32 v[124:125], v[104:105], v[104:105], v[124:125]
    v_pk_fma_f32 v[126:127], v[106:107], v[106:107], v[126:127]
    v_pk_fma_f32 v[124:125], v[108:109], v[108:109], v[124:125]
    v_pk_fma_f32 v[126:127], v[110:111], v[110:111], v[126:127]
    v_pk_fma_f32 v[124:125], v[112:113], v[112:113], v[124:125]
    v_pk_fma_f32 v[126:127], v[114:115], v[114:115], v[126:127]
    v_pk_fma_f32 v[124:125], v[116:117], v[116:117], v[124:125]
    v_pk_fma_f32 v[126:127], v[118:119], v[118:119], v[126:127]
    v_pk_fma_f32 v[124:125], v[120:121], v[120:121], v[124:125]
    v_pk_fma_f32 v[126:127], v[122:123], v[122:123], v[126:127]
    v_pk_add_f32 v[12:13], v[124:125], v[126:127]
    v_add_f32 v12, v12, v13
    s_nop 1
    v_add_f32_dpp v12, v12, v12 quad_perm:[1,0,3,2] row_mask:0xf bank_mask:0xf
    s_nop 1
    v_add_f32_dpp v12, v12, v12 quad_perm:[2,3,0,1] row_mask:0xf bank_mask:0xf
    s_nop 1
    v_add_f32_dpp v12, v12, v12 row_half_mirror row_mask:0xf bank_mask:0xf
    v_mul_f32 v12, 0x3ae38e39, v12
    v_fma_f32 v12, -v11, v11, v12
    v_max_f32 v12, 0, v12
    v_cvt_pk_bf16_f32 v12, v12, v12
    v_lshlrev_b32 v12, 16, v12
    v_add_f32 v12, 0x3727c5ac, v12
    v_cvt_pk_bf16_f32 v12, v12, v12
    v_lshlrev_b32 v12, 16, v12
    v_sqrt_f32 v12, v12
    s_nop 0
    v_cvt_pk_bf16_f32 v12, v12, v12
    v_lshlrev_b32 v12, 16, v12
    v_rcp_f32 v12, v12
    v_mul_u32_u24 v11, 528, v2
    v_mul_f32 v12, 0x3fb8aa3b, v12
    v_mov_b32 v13, v12
    v_lshl_add_u32 v11, v1, 4, v11
    v_add_u32 v11, 98304, v11
    v_pk_mul_f32 v[124:125], v[52:53], v[12:13]
    v_pk_mul_f32 v[126:127], v[54:55], v[12:13]
    v_pk_mul_f32 v[128:129], v[56:57], v[12:13]
    v_pk_mul_f32 v[130:131], v[58:59], v[12:13]
    v_cvt_pk_bf16_f32 v16, v124, v125
    v_cvt_pk_bf16_f32 v17, v126, v127
    v_cvt_pk_bf16_f32 v18, v128, v129
    v_cvt_pk_bf16_f32 v19, v130, v131
    ds_write_b128 v11, v[16:19] offset:0
    v_pk_mul_f32 v[124:125], v[60:61], v[12:13]
    v_pk_mul_f32 v[126:127], v[62:63], v[12:13]
    v_pk_mul_f32 v[128:129], v[64:65], v[12:13]
    v_pk_mul_f32 v[130:131], v[66:67], v[12:13]
    v_cvt_pk_bf16_f32 v20, v124, v125
    v_cvt_pk_bf16_f32 v21, v126, v127
    v_cvt_pk_bf16_f32 v22, v128, v129
    v_cvt_pk_bf16_f32 v23, v130, v131
    ds_write_b128 v11, v[20:23] offset:4224
    v_pk_mul_f32 v[124:125], v[68:69], v[12:13]
    v_pk_mul_f32 v[126:127], v[70:71], v[12:13]
    v_pk_mul_f32 v[128:129], v[72:73], v[12:13]
    v_pk_mul_f32 v[130:131], v[74:75], v[12:13]
    v_cvt_pk_bf16_f32 v24, v124, v125
    v_cvt_pk_bf16_f32 v25, v126, v127
    v_cvt_pk_bf16_f32 v26, v128, v129
    v_cvt_pk_bf16_f32 v27, v130, v131
    ds_write_b128 v11, v[24:27] offset:8448
    v_pk_mul_f32 v[124:125], v[76:77], v[12:13]
    v_pk_mul_f32 v[126:127], v[78:79], v[12:13]
    v_pk_mul_f32 v[128:129], v[80:81], v[12:13]
    v_pk_mul_f32 v[130:131], v[82:83], v[12:13]
    v_cvt_pk_bf16_f32 v28, v124, v125
    v_cvt_pk_bf16_f32 v29, v126, v127
    v_cvt_pk_bf16_f32 v30, v128, v129
    v_cvt_pk_bf16_f32 v31, v130, v131
    ds_write_b128 v11, v[28:31] offset:12672
    v_pk_mul_f32 v[124:125], v[84:85], v[12:13]
    v_pk_mul_f32 v[126:127], v[86:87], v[12:13]
    v_pk_mul_f32 v[128:129], v[88:89], v[12:13]
    v_pk_mul_f32 v[130:131], v[90:91], v[12:13]
    v_cvt_pk_bf16_f32 v32, v124, v125
    v_cvt_pk_bf16_f32 v33, v126, v127
    v_cvt_pk_bf16_f32 v34, v128, v129
    v_cvt_pk_bf16_f32 v35, v130, v131
    ds_write_b128 v11, v[32:35] offset:16896
    v_pk_mul_f32 v[124:125], v[92:93], v[12:13]
    v_pk_mul_f32 v[126:127], v[94:95], v[12:13]
    v_pk_mul_f32 v[128:129], v[96:97], v[12:13]
    v_pk_mul_f32 v[130:131], v[98:99], v[12:13]
    v_cvt_pk_bf16_f32 v36, v124, v125
    v_cvt_pk_bf16_f32 v37, v126, v127
    v_cvt_pk_bf16_f32 v38, v128, v129
    v_cvt_pk_bf16_f32 v39, v130, v131
    ds_write_b128 v11, v[36:39] offset:21120
    v_pk_mul_f32 v[124:125], v[100:101], v[12:13]
    v_pk_mul_f32 v[126:127], v[102:103], v[12:13]
    v_pk_mul_f32 v[128:129], v[104:105], v[12:13]
    v_pk_mul_f32 v[130:131], v[106:107], v[12:13]
    v_cvt_pk_bf16_f32 v40, v124, v125
    v_cvt_pk_bf16_f32 v41, v126, v127
    v_cvt_pk_bf16_f32 v42, v128, v129
    v_cvt_pk_bf16_f32 v43, v130, v131
    ds_write_b128 v11, v[40:43] offset:25344
    v_pk_mul_f32 v[124:125], v[108:109], v[12:13]
    v_pk_mul_f32 v[126:127], v[110:111], v[12:13]
    v_pk_mul_f32 v[128:129], v[112:113], v[12:13]
    v_pk_mul_f32 v[130:131], v[114:115], v[12:13]
    v_cvt_pk_bf16_f32 v44, v124, v125
    v_cvt_pk_bf16_f32 v45, v126, v127
    v_cvt_pk_bf16_f32 v46, v128, v129
    v_cvt_pk_bf16_f32 v47, v130, v131
    ds_write_b128 v11, v[44:47] offset:29568
    v_pk_mul_f32 v[124:125], v[116:117], v[12:13]
    v_pk_mul_f32 v[126:127], v[118:119], v[12:13]
    v_pk_mul_f32 v[128:129], v[120:121], v[12:13]
    v_pk_mul_f32 v[130:131], v[122:123], v[12:13]
    v_cvt_pk_bf16_f32 v48, v124, v125
    v_cvt_pk_bf16_f32 v49, v126, v127
    v_cvt_pk_bf16_f32 v50, v128, v129
    v_cvt_pk_bf16_f32 v51, v130, v131
    ds_write_b128 v11, v[48:51] offset:33792
    v_mul_u32_u24 v11, 528, v6
    v_lshl_add_u32 v11, v5, 4, v11
    v_add_u32 v11, 98304, v11
    s_lshl_b32 s23, s20, 2
    s_mul_i32 s22, s23, 1056
    v_add_u32 v9, s22, v11
    s_mul_i32 s22, s16, 36
    s_add_u32 s22, s22, s23
    s_lshl_b32 s21, s22, 10
    v_and_b32 v12, 0x3ff, v248
    s_cmp_eq_u32 s19, 3
    s_cbranch_scc1 L0_sn
    s_waitcnt vmcnt(0)
L0_sn:
    s_waitcnt lgkmcnt(0)
    s_barrier
    s_cmp_eq_u32 s19, 3
    s_cbranch_scc1 L0_w3b
    ds_read_b128 v[132:135], v9 offset:0
    ds_read_b128 v[136:139], v9 offset:1056
    ds_read_b128 v[140:143], v9 offset:2112
    ds_read_b128 v[144:147], v9 offset:3168
    ds_read_b128 v[16:19], v11 offset:0
    ds_read_b128 v[20:23], v11 offset:19008
    ds_read_b128 v[24:27], v11 offset:9504
    ds_read_b128 v[28:31], v11 offset:28512
    ds_read_b128 v[32:35], v11 offset:1056
    ds_read_b128 v[36:39], v11 offset:20064
    ds_read_b128 v[40:43], v11 offset:10560
    s_waitcnt lgkmcnt(6)
    v_mfma_f32_32x32x16_bf16 v[52:67], v[16:19], v[148:151], 0
    buffer_store_dwordx4 v[132:135], v12, s[12:15], s21 offen offset:0 sc1
    v_cndmask_b32 v116, v148, v152, s[46:47]
    v_cndmask_b32 v120, v152, v148, s[46:47]
    v_cndmask_b32 v117, v149, v153, s[46:47]
    v_cndmask_b32 v121, v153, v149, s[46:47]
    v_mfma_f32_32x32x16_bf16 v[68:83], v[16:19], v[152:155], 0
    buffer_store_dwordx4 v[136:139], v12, s[12:15], s21 offen offset:1024 sc1
    v_cndmask_b32 v118, v150, v154, s[46:47]
    v_cndmask_b32 v122, v154, v150, s[46:47]
    v_cndmask_b32 v119, v151, v155, s[46:47]
    v_cndmask_b32 v123, v155, v151, s[46:47]
    ds_read_b128 v[44:47], v11 offset:29568
    s_waitcnt lgkmcnt(6)
    v_mfma_f32_32x32x16_bf16 v[84:99], v[20:23], v[148:151], 0
    buffer_store_dwordx4 v[140:143], v12, s[12:15], s21 offen offset:2048 sc1
    v_xor_b32 v116, v244, v116
    v_xor_b32 v120, v245, v120
    v_xor_b32 v117, v244, v117
    v_xor_b32 v121, v245, v121
    v_mfma_f32_32x32x16_bf16 v[100:115], v[20:23], v[152:155], 0
    buffer_store_dwordx4 v[144:147], v12, s[12:15], s21 offen offset:3072 sc1
    v_xor_b32 v118, v244, v118
    v_xor_b32 v122, v245, v122
    v_xor_b32 v119, v244, v119
    v_xor_b32 v123, v245, v123
    ds_read_b128 v[16:19], v11 offset:2112
    s_waitcnt lgkmcnt(6)
    v_mfma_f32_32x32x16_bf16 v[52:67], v[24:27], v[116:119], v[52:67]
    v_cndmask_b32 v124, v156, v160, s[46:47]
    v_cndmask_b32 v128, v160, v156, s[46:47]
    v_mfma_f32_32x32x16_bf16 v[68:83], v[24:27], v[120:123], v[68:83]
    v_cndmask_b32 v125, v157, v161, s[46:47]
    v_cndmask_b32 v129, v161, v157, s[46:47]
    s_barrier
    ds_read_b128 v[20:23], v11 offset:21120
    s_waitcnt lgkmcnt(6)
    v_mfma_f32_32x32x16_bf16 v[84:99], v[28:31], v[116:119], v[84:99]
    v_cndmask_b32 v126, v158, v162, s[46:47]
    v_cndmask_b32 v130, v162, v158, s[46:47]
    v_mfma_f32_32x32x16_bf16 v[100:115], v[28:31], v[120:123], v[100:115]
    v_cndmask_b32 v127, v159, v163, s[46:47]
    v_cndmask_b32 v131, v163, v159, s[46:47]
    ds_read_b128 v[24:27], v11 offset:11616
    s_waitcnt lgkmcnt(6)
    v_mfma_f32_32x32x16_bf16 v[52:67], v[32:35], v[156:159], v[52:67]
    v_xor_b32 v124, v244, v124
    v_xor_b32 v128, v245, v128
    v_mfma_f32_32x32x16_bf16 v[68:83], v[32:35], v[160:163], v[68:83]
    v_xor_b32 v125, v244, v125
    v_xor_b32 v129, v245, v129
    ds_read_b128 v[28:31], v11 offset:30624
    s_waitcnt lgkmcnt(6)
    v_mfma_f32_32x32x16_bf16 v[84:99], v[36:39], v[156:159], v[84:99]
    v_xor_b32 v126, v244, v126
    v_xor_b32 v130, v245, v130
    v_mfma_f32_32x32x16_bf16 v[100:115], v[36:39], v[160:163], v[100:115]
    v_xor_b32 v127, v244, v127
    v_xor_b32 v131, v245, v131
    ds_read_b128 v[32:35], v11 offset:3168
    s_waitcnt lgkmcnt(6)
    v_mfma_f32_32x32x16_bf16 v[52:67], v[40:43], v[124:127], v[52:67]
    v_cndmask_b32 v116, v164, v168, s[46:47]
    v_cndmask_b32 v120, v168, v164, s[46:47]
    v_mfma_f32_32x32x16_bf16 v[68:83], v[40:43], v[128:131], v[68:83]
    v_cndmask_b32 v117, v165, v169, s[46:47]
    v_cndmask_b32 v121, v169, v165, s[46:47]
    ds_read_b128 v[36:39], v11 offset:22176
    s_waitcnt lgkmcnt(6)
    v_mfma_f32_32x32x16_bf16 v[84:99], v[44:47], v[124:127], v[84:99]
    v_cndmask_b32 v118, v166, v170, s[46:47]
    v_cndmask_b32 v122, v170, v166, s[46:47]
    v_mfma_f32_32x32x16_bf16 v[100:115], v[44:47], v[128:131], v[100:115]
    v_cndmask_b32 v119, v167, v171, s[46:47]
    v_cndmask_b32 v123, v171, v167, s[46:47]
    ds_read_b128 v[40:43], v11 offset:12672
    s_waitcnt lgkmcnt(6)
    v_mfma_f32_32x32x16_bf16 v[52:67], v[16:19], v[164:167], v[52:67]
    v_xor_b32 v116, v244, v116
    v_xor_b32 v120, v245, v120
    v_mfma_f32_32x32x16_bf16 v[68:83], v[16:19], v[168:171], v[68:83]
    v_xor_b32 v117, v244, v117
    v_xor_b32 v121, v245, v121
    ds_read_b128 v[44:47], v11 offset:31680
    s_waitcnt lgkmcnt(6)
    v_mfma_f32_32x32x16_bf16 v[84:99], v[20:23], v[164:167], v[84:99]
    v_xor_b32 v118, v244, v118
    v_xor_b32 v122, v245, v122
    v_mfma_f32_32x32x16_bf16 v[100:115], v[20:23], v[168:171], v[100:115]
    v_xor_b32 v119, v244, v119
    v_xor_b32 v123, v245, v123
    ds_read_b128 v[16:19], v11 offset:4224
    s_waitcnt lgkmcnt(6)
    v_mfma_f32_32x32x16_bf16 v[52:67], v[24:27], v[116:119], v[52:67]
    v_cndmask_b32 v124, v172, v176, s[46:47]
    v_cndmask_b32 v128, v176, v172, s[46:47]
    v_mfma_f32_32x32x16_bf16 v[68:83], v[24:27], v[120:123], v[68:83]
    v_cndmask_b32 v125, v173, v177, s[46:47]
    v_cndmask_b32 v129, v177, v173, s[46:47]
    ds_read_b128 v[20:23], v11 offset:23232
    s_waitcnt lgkmcnt(6)
    v_mfma_f32_32x32x16_bf16 v[84:99], v[28:31], v[116:119], v[84:99]
    v_cndmask_b32 v126, v174, v178, s[46:47]
    v_cndmask_b32 v130, v178, v174, s[46:47]
    v_mfma_f32_32x32x16_bf16 v[100:115], v[28:31], v[120:123], v[100:115]
    v_cndmask_b32 v127, v175, v179, s[46:47]
    v_cndmask_b32 v131, v179, v175, s[46:47]
    ds_read_b128 v[24:27], v11 offset:13728
    s_waitcnt lgkmcnt(6)
    v_mfma_f32_32x32x16_bf16 v[52:67], v[32:35], v[172:175], v[52:67]
    v_xor_b32 v124, v244, v124
    v_xor_b32 v128, v245, v128
    v_cvt_f32_u32 v7, v5
    v_mul_f32 v7, 0x3d000000, v7
    v_mfma_f32_32x32x16_bf16 v[68:83], v[32:35], v[176:179], v[68:83]
    v_xor_b32 v125, v244, v125
    v_xor_b32 v129, v245, v129
    v_lshlrev_b32 v8, 8, v6
    v_add_u32 v8, s16, v8
    ds_read_b128 v[28:31], v11 offset:32736
    s_waitcnt lgkmcnt(6)
    v_mfma_f32_32x32x16_bf16 v[84:99], v[36:39], v[172:175], v[84:99]
    v_xor_b32 v126, v244, v126
    v_xor_b32 v130, v245, v130
    v_cvt_f32_u32 v8, v8
    v_mul_f32 v8, 0x3c800000, v8
    v_mfma_f32_32x32x16_bf16 v[100:115], v[36:39], v[176:179], v[100:115]
    v_xor_b32 v127, v244, v127
    v_xor_b32 v131, v245, v131
    v_mul_f32 v8, v8, v7
    v_mov_b32 v148, v8
    ds_read_b128 v[32:35], v11 offset:5280
    s_waitcnt lgkmcnt(6)
    v_mfma_f32_32x32x16_bf16 v[52:67], v[40:43], v[124:127], v[52:67]
    v_cndmask_b32 v116, v180, v184, s[46:47]
    v_cndmask_b32 v120, v184, v180, s[46:47]
    v_fmamk_f32 v149, v7, 0x3f800000, v8
    v_fmamk_f32 v150, v7, 0x40000000, v8
    v_mfma_f32_32x32x16_bf16 v[68:83], v[40:43], v[128:131], v[68:83]
    v_cndmask_b32 v117, v181, v185, s[46:47]
    v_cndmask_b32 v121, v185, v181, s[46:47]
    v_fmamk_f32 v151, v7, 0x40400000, v8
    v_fmamk_f32 v152, v7, 0x41000000, v8
    ds_read_b128 v[36:39], v11 offset:24288
    s_waitcnt lgkmcnt(6)
    v_mfma_f32_32x32x16_bf16 v[84:99], v[44:47], v[124:127], v[84:99]
    v_cndmask_b32 v118, v182, v186, s[46:47]
    v_cndmask_b32 v122, v186, v182, s[46:47]
    v_fmamk_f32 v153, v7, 0x41100000, v8
    v_fmamk_f32 v154, v7, 0x41200000, v8
    v_mfma_f32_32x32x16_bf16 v[100:115], v[44:47], v[128:131], v[100:115]
    v_cndmask_b32 v119, v183, v187, s[46:47]
    v_cndmask_b32 v123, v187, v183, s[46:47]
    v_fmamk_f32 v155, v7, 0x41300000, v8
    v_cos_f32 v156, v148
    ds_read_b128 v[40:43], v11 offset:14784
    s_waitcnt lgkmcnt(6)
    v_mfma_f32_32x32x16_bf16 v[52:67], v[16:19], v[180:183], v[52:67]
    v_xor_b32 v116, v244, v116
    v_xor_b32 v120, v245, v120
    v_sin_f32_e64 v164, -v148
    v_cos_f32 v157, v149
    v_mfma_f32_32x32x16_bf16 v[68:83], v[16:19], v[184:187], v[68:83]
    v_xor_b32 v117, v244, v117
    v_xor_b32 v121, v245, v121
    v_sin_f32_e64 v165, -v149
    v_cos_f32 v158, v150
    s_waitcnt vmcnt(0)
    v_accvgpr_read_b32 v255, a3
    v_add_u32 v255, 1, v255
    s_mov_b64 exec, 1
    buffer_store_dword v255, v254, s[12:15], s62 offen sc1
    s_mov_b64 exec, -1
    ds_read_b128 v[44:47], v11 offset:33792
    s_waitcnt lgkmcnt(6)
    v_mfma_f32_32x32x16_bf16 v[84:99], v[20:23], v[180:183], v[84:99]
    v_xor_b32 v118, v244, v118
    v_xor_b32 v122, v245, v122
    v_sin_f32_e64 v166, -v150
    v_cos_f32 v159, v151
    v_mfma_f32_32x32x16_bf16 v[100:115], v[20:23], v[184:187], v[100:115]
    v_xor_b32 v119, v244, v119
    v_xor_b32 v123, v245, v123
    v_sin_f32_e64 v167, -v151
    v_cos_f32 v160, v152
    s_cmp_lg_u32 s19, 0
    s_cbranch_scc1 L0_nzm
    v_mov_b32 v140, 0
    v_mov_b32 v141, 0
    v_mov_b32 v142, 0
    v_mov_b32 v143, 0
    s_lshl_b32 s22, s2, 10
    s_add_u32 s22, s22, 48562176
    buffer_store_dwordx4 v[140:143], v248, s[12:15], s22 offen sc1
    s_mov_b32 s22, 48959488
    s_mov_b64 exec, 1
    buffer_store_dword v140, v249, s[12:15], s22 offen sc1
    s_lshl_b32 s22, s2, 8
    s_add_u32 s22, s22, 48963584
    s_mov_b64 exec, 0xffff
    buffer_store_dwordx4 v[140:143], v248, s[12:15], s22 offen sc1
    s_mov_b64 exec, -1
L0_nzm:
    ds_read_b128 v[16:19], v11 offset:6336
    s_waitcnt lgkmcnt(6)
    v_mfma_f32_32x32x16_bf16 v[52:67], v[24:27], v[116:119], v[52:67]
    v_cndmask_b32 v124, v188, v192, s[46:47]
    v_cndmask_b32 v128, v192, v188, s[46:47]
    v_sin_f32_e64 v168, -v152
    v_cos_f32 v161, v153
    v_mfma_f32_32x32x16_bf16 v[68:83], v[24:27], v[120:123], v[68:83]
    v_cndmask_b32 v125, v189, v193, s[46:47]
    v_cndmask_b32 v129, v193, v189, s[46:47]
    v_sin_f32_e64 v169, -v153
    v_cos_f32 v162, v154
    ds_read_b128 v[20:23], v11 offset:25344
    s_waitcnt lgkmcnt(6)
    v_mfma_f32_32x32x16_bf16 v[84:99], v[28:31], v[116:119], v[84:99]
    v_cndmask_b32 v126, v190, v194, s[46:47]
    v_cndmask_b32 v130, v194, v190, s[46:47]
    v_sin_f32_e64 v170, -v154
    v_cos_f32 v163, v155
    v_mfma_f32_32x32x16_bf16 v[100:115], v[28:31], v[120:123], v[100:115]
    v_cndmask_b32 v127, v191, v195, s[46:47]
    v_cndmask_b32 v131, v195, v191, s[46:47]
    v_sin_f32_e64 v171, -v155
    v_cvt_pk_bf16_f32 v220, v156, v157
    ds_read_b128 v[24:27], v11 offset:15840
    s_waitcnt lgkmcnt(6)
    v_mfma_f32_32x32x16_bf16 v[52:67], v[32:35], v[188:191], v[52:67]
    v_xor_b32 v124, v244, v124
    v_xor_b32 v128, v245, v128
    v_cvt_pk_bf16_f32 v228, v164, v165
    v_cvt_pk_bf16_f32 v221, v158, v159
    v_mfma_f32_32x32x16_bf16 v[68:83], v[32:35], v[192:195], v[68:83]
    v_xor_b32 v125, v244, v125
    v_xor_b32 v129, v245, v129
    v_cvt_pk_bf16_f32 v229, v166, v167
    v_cvt_pk_bf16_f32 v222, v160, v161
    ds_read_b128 v[28:31], v11 offset:34848
    s_waitcnt lgkmcnt(6)
    v_mfma_f32_32x32x16_bf16 v[84:99], v[36:39], v[188:191], v[84:99]
    v_xor_b32 v126, v244, v126
    v_xor_b32 v130, v245, v130
    v_cvt_pk_bf16_f32 v230, v168, v169
    v_cvt_pk_bf16_f32 v223, v162, v163
    v_mfma_f32_32x32x16_bf16 v[100:115], v[36:39], v[192:195], v[100:115]
    v_xor_b32 v127, v244, v127
    v_xor_b32 v131, v245, v131
    v_cvt_pk_bf16_f32 v231, v170, v171
    v_fmamk_f32 v148, v7, 0x41800000, v8
    ds_read_b128 v[32:35], v11 offset:7392
    s_waitcnt lgkmcnt(6)
    v_mfma_f32_32x32x16_bf16 v[52:67], v[40:43], v[124:127], v[52:67]
    v_cndmask_b32 v116, v196, v200, s[46:47]
    v_cndmask_b32 v120, v200, v196, s[46:47]
    v_fmamk_f32 v149, v7, 0x41880000, v8
    v_fmamk_f32 v150, v7, 0x41900000, v8
    v_mfma_f32_32x32x16_bf16 v[68:83], v[40:43], v[128:131], v[68:83]
    v_cndmask_b32 v117, v197, v201, s[46:47]
    v_cndmask_b32 v121, v201, v197, s[46:47]
    v_fmamk_f32 v151, v7, 0x41980000, v8
    v_fmamk_f32 v152, v7, 0x41c00000, v8
    ds_read_b128 v[36:39], v11 offset:26400
    s_waitcnt lgkmcnt(6)
    v_mfma_f32_32x32x16_bf16 v[84:99], v[44:47], v[124:127], v[84:99]
    v_cndmask_b32 v118, v198, v202, s[46:47]
    v_cndmask_b32 v122, v202, v198, s[46:47]
    v_fmamk_f32 v153, v7, 0x41c80000, v8
    v_fmamk_f32 v154, v7, 0x41d00000, v8
    v_mfma_f32_32x32x16_bf16 v[100:115], v[44:47], v[128:131], v[100:115]
    v_cndmask_b32 v119, v199, v203, s[46:47]
    v_cndmask_b32 v123, v203, v199, s[46:47]
    v_fmamk_f32 v155, v7, 0x41d80000, v8
    v_cos_f32 v156, v148
    ds_read_b128 v[40:43], v11 offset:16896
    s_waitcnt lgkmcnt(6)
    v_mfma_f32_32x32x16_bf16 v[52:67], v[16:19], v[196:199], v[52:67]
    v_xor_b32 v116, v244, v116
    v_xor_b32 v120, v245, v120
    v_sin_f32_e64 v164, -v148
    v_cos_f32 v157, v149
    v_mfma_f32_32x32x16_bf16 v[68:83], v[16:19], v[200:203], v[68:83]
    v_xor_b32 v117, v244, v117
    v_xor_b32 v121, v245, v121
    v_sin_f32_e64 v165, -v149
    v_cos_f32 v158, v150
    ds_read_b128 v[44:47], v11 offset:35904
    s_waitcnt lgkmcnt(6)
    v_mfma_f32_32x32x16_bf16 v[84:99], v[20:23], v[196:199], v[84:99]
    v_xor_b32 v118, v244, v118
    v_xor_b32 v122, v245, v122
    v_sin_f32_e64 v166, -v150
    v_cos_f32 v159, v151
    v_mfma_f32_32x32x16_bf16 v[100:115], v[20:23], v[200:203], v[100:115]
    v_xor_b32 v119, v244, v119
    v_xor_b32 v123, v245, v123
    v_sin_f32_e64 v167, -v151
    v_cos_f32 v160, v152
    ds_read_b128 v[16:19], v11 offset:8448
    s_waitcnt lgkmcnt(6)
    v_mfma_f32_32x32x16_bf16 v[52:67], v[24:27], v[116:119], v[52:67]
    v_cndmask_b32 v124, v204, v208, s[46:47]
    v_cndmask_b32 v128, v208, v204, s[46:47]
    v_sin_f32_e64 v168, -v152
    v_cos_f32 v161, v153
    v_mfma_f32_32x32x16_bf16 v[68:83], v[24:27], v[120:123], v[68:83]
    v_cndmask_b32 v125, v205, v209, s[46:47]
    v_cndmask_b32 v129, v209, v205, s[46:47]
    v_sin_f32_e64 v169, -v153
    v_cos_f32 v162, v154
    ds_read_b128 v[20:23], v11 offset:27456
    s_waitcnt lgkmcnt(6)
    v_mfma_f32_32x32x16_bf16 v[84:99], v[28:31], v[116:119], v[84:99]
    v_cndmask_b32 v126, v206, v210, s[46:47]
    v_cndmask_b32 v130, v210, v206, s[46:47]
    v_sin_f32_e64 v170, -v154
    v_cos_f32 v163, v155
    v_mfma_f32_32x32x16_bf16 v[100:115], v[28:31], v[120:123], v[100:115]
    v_cndmask_b32 v127, v207, v211, s[46:47]
    v_cndmask_b32 v131, v211, v207, s[46:47]
    v_sin_f32_e64 v171, -v155
    v_cvt_pk_bf16_f32 v224, v156, v157
    ds_read_b128 v[24:27], v11 offset:17952
    s_waitcnt lgkmcnt(6)
    v_mfma_f32_32x32x16_bf16 v[52:67], v[32:35], v[204:207], v[52:67]
    v_xor_b32 v124, v244, v124
    v_xor_b32 v128, v245, v128
    v_cvt_pk_bf16_f32 v232, v164, v165
    v_cvt_pk_bf16_f32 v225, v158, v159
    v_mfma_f32_32x32x16_bf16 v[68:83], v[32:35], v[208:211], v[68:83]
    v_xor_b32 v125, v244, v125
    v_xor_b32 v129, v245, v129
    v_cvt_pk_bf16_f32 v233, v166, v167
    v_cvt_pk_bf16_f32 v226, v160, v161
    ds_read_b128 v[28:31], v11 offset:36960
    s_waitcnt lgkmcnt(6)
    v_mfma_f32_32x32x16_bf16 v[84:99], v[36:39], v[204:207], v[84:99]
    v_xor_b32 v126, v244, v126
    v_xor_b32 v130, v245, v130
    v_cvt_pk_bf16_f32 v234, v168, v169
    v_cvt_pk_bf16_f32 v227, v162, v163
    v_mfma_f32_32x32x16_bf16 v[100:115], v[36:39], v[208:211], v[100:115]
    v_xor_b32 v127, v244, v127
    v_xor_b32 v131, v245, v131
    v_cvt_pk_bf16_f32 v235, v170, v171
    v_xor_b32 v236, 0x80008000, v228
    s_waitcnt lgkmcnt(5)
    v_mfma_f32_32x32x16_bf16 v[52:67], v[40:43], v[124:127], v[52:67]
    v_cndmask_b32 v116, v212, v216, s[46:47]
    v_cndmask_b32 v120, v216, v212, s[46:47]
    v_xor_b32 v237, 0x80008000, v229
    v_xor_b32 v238, 0x80008000, v230
    v_mfma_f32_32x32x16_bf16 v[68:83], v[40:43], v[128:131], v[68:83]
    v_cndmask_b32 v117, v213, v217, s[46:47]
    v_cndmask_b32 v121, v217, v213, s[46:47]
    v_xor_b32 v239, 0x80008000, v231
    v_xor_b32 v240, 0x80008000, v232
    s_waitcnt lgkmcnt(4)
    v_mfma_f32_32x32x16_bf16 v[84:99], v[44:47], v[124:127], v[84:99]
    v_cndmask_b32 v118, v214, v218, s[46:47]
    v_cndmask_b32 v122, v218, v214, s[46:47]
    v_xor_b32 v241, 0x80008000, v233
    v_xor_b32 v242, 0x80008000, v234
    v_mfma_f32_32x32x16_bf16 v[100:115], v[44:47], v[128:131], v[100:115]
    v_cndmask_b32 v119, v215, v219, s[46:47]
    v_cndmask_b32 v123, v219, v215, s[46:47]
    v_xor_b32 v243, 0x80008000, v235
    s_waitcnt lgkmcnt(3)
    v_mfma_f32_32x32x16_bf16 v[52:67], v[16:19], v[212:215], v[52:67]
    v_xor_b32 v116, v244, v116
    v_xor_b32 v120, v245, v120
    v_mfma_f32_32x32x16_bf16 v[68:83], v[16:19], v[216:219], v[68:83]
    v_xor_b32 v117, v244, v117
    v_xor_b32 v121, v245, v121
    s_waitcnt lgkmcnt(2)
    v_mfma_f32_32x32x16_bf16 v[84:99], v[20:23], v[212:215], v[84:99]
    v_xor_b32 v118, v244, v118
    v_xor_b32 v122, v245, v122
    v_mfma_f32_32x32x16_bf16 v[100:115], v[20:23], v[216:219], v[100:115]
    v_xor_b32 v119, v244, v119
    v_xor_b32 v123, v245, v123
    s_waitcnt lgkmcnt(1)
    v_mfma_f32_32x32x16_bf16 v[52:67], v[24:27], v[116:119], v[52:67]
    v_mfma_f32_32x32x16_bf16 v[68:83], v[24:27], v[120:123], v[68:83]
    s_waitcnt lgkmcnt(0)
    v_mfma_f32_32x32x16_bf16 v[84:99], v[28:31], v[116:119], v[84:99]
    v_mfma_f32_32x32x16_bf16 v[100:115], v[28:31], v[120:123], v[100:115]
    s_nop 10
    v_fmac_f32 v52, v10, v84
    v_fmac_f32 v53, v10, v85
    v_fmac_f32 v54, v10, v86
    v_fmac_f32 v55, v10, v87
    v_fmac_f32 v56, v10, v88
    v_fmac_f32 v57, v10, v89
    v_fmac_f32 v58, v10, v90
    v_fmac_f32 v59, v10, v91
    v_fmac_f32 v60, v10, v92
    v_fmac_f32 v61, v10, v93
    v_fmac_f32 v62, v10, v94
    v_fmac_f32 v63, v10, v95
    v_fmac_f32 v64, v10, v96
    v_fmac_f32 v65, v10, v97
    v_fmac_f32 v66, v10, v98
    v_fmac_f32 v67, v10, v99
    v_cvt_pk_bf16_f32 v16, v52, v53
    v_cvt_pk_bf16_f32 v17, v54, v55
    v_cvt_pk_bf16_f32 v18, v56, v57
    v_cvt_pk_bf16_f32 v19, v58, v59
    v_cvt_pk_bf16_f32 v20, v60, v61
    v_cvt_pk_bf16_f32 v21, v62, v63
    v_cvt_pk_bf16_f32 v22, v64, v65
    v_cvt_pk_bf16_f32 v23, v66, v67
    v_mfma_f32_32x32x16_bf16 v[148:163], v[16:19], v[220:223], 0
    v_fmac_f32 v68, v10, v100
    v_fmac_f32 v69, v10, v101
    v_fmac_f32 v70, v10, v102
    v_fmac_f32 v71, v10, v103
    v_fmac_f32 v72, v10, v104
    v_fmac_f32 v73, v10, v105
    v_mfma_f32_32x32x16_bf16 v[164:179], v[16:19], v[228:231], 0
    v_fmac_f32 v74, v10, v106
    v_fmac_f32 v75, v10, v107
    v_fmac_f32 v76, v10, v108
    v_fmac_f32 v77, v10, v109
    v_fmac_f32 v78, v10, v110
    v_fmac_f32 v79, v10, v111
    v_mfma_f32_32x32x16_bf16 v[148:163], v[20:23], v[224:227], v[148:163]
    v_fmac_f32 v80, v10, v112
    v_fmac_f32 v81, v10, v113
    v_fmac_f32 v82, v10, v114
    v_fmac_f32 v83, v10, v115
    v_cvt_pk_bf16_f32 v24, v68, v69
    v_cvt_pk_bf16_f32 v25, v70, v71
    v_mfma_f32_32x32x16_bf16 v[164:179], v[20:23], v[232:235], v[164:179]
    v_cvt_pk_bf16_f32 v26, v72, v73
    v_cvt_pk_bf16_f32 v27, v74, v75
    v_cvt_pk_bf16_f32 v28, v76, v77
    v_cvt_pk_bf16_f32 v29, v78, v79
    v_cvt_pk_bf16_f32 v30, v80, v81
    v_cvt_pk_bf16_f32 v31, v82, v83
    v_mfma_f32_32x32x16_bf16 v[180:195], v[24:27], v[236:239], v[148:163]
    s_nop 0
    v_mfma_f32_32x32x16_bf16 v[180:195], v[28:31], v[240:243], v[180:195]
    v_mfma_f32_32x32x16_bf16 v[196:211], v[24:27], v[220:223], v[164:179]
    v_mfma_f32_32x32x16_bf16 v[196:211], v[28:31], v[224:227], v[196:211]
    s_mul_i32 s23, s19, 4608
    s_add_u32 s23, s23, 136320
    v_mul_u32_u24 v11, 144, v5
    v_lshl_add_u32 v11, v6, 5, v11
    v_add_u32 v11, s23, v11
    v_bfe_u32 v1, v0, 3, 3
    v_mul_u32_u24 v3, 144, v1
    v_lshl_add_u32 v3, v2, 4, v3
    v_add_u32 v3, s23, v3
    v_mul_u32_u24 v9, 73728, v1
    v_lshl_add_u32 v9, v2, 4, v9
    s_lshl_b32 s22, s20, 7
    s_add_u32 s22, s22, s18
    s_add_u32 s22, s22, 2359296
    s_cmp_lg_u32 s20, 0
    s_cbranch_scc1 L0_nonyq
    s_mov_b32 exec_hi, 0
    v_sub_f32 v7, v196, v164
    v_sub_f32 v8, v148, v180
    v_mov_b32 v180, v148
    v_mov_b32 v196, v164
    v_cvt_pk_bf16_f32 v7, v7, v8
    v_lshlrev_b32 v8, 1, v5
    s_lshl_b32 s23, s16, 7
    s_add_u32 s23, s23, 4718592
    buffer_store_short v7, v8, s[12:15], s23 offen sc1
    buffer_store_short_d16_hi v7, v8, s[12:15], s23 offen offset:64 sc1
    s_mov_b32 exec_hi, -1
L0_nonyq:
    buffer_load_dword v252, v253, s[12:15], s62 offen sc1
    v_cvt_pk_bf16_f32 v16, v180, v181
    v_cvt_pk_bf16_f32 v17, v182, v183
    v_cvt_pk_bf16_f32 v18, v184, v185
    v_cvt_pk_bf16_f32 v19, v186, v187
    v_cvt_pk_bf16_f32 v20, v188, v189
    v_cvt_pk_bf16_f32 v21, v190, v191
    v_cvt_pk_bf16_f32 v22, v192, v193
    v_cvt_pk_bf16_f32 v23, v194, v195
    ds_write_b128 v11, v[16:19] offset:0
    ds_write_b128 v11, v[20:23] offset:16
    v_cvt_pk_bf16_f32 v24, v196, v197
    v_cvt_pk_bf16_f32 v25, v198, v199
    v_cvt_pk_bf16_f32 v26, v200, v201
    v_cvt_pk_bf16_f32 v27, v202, v203
    v_cvt_pk_bf16_f32 v28, v204, v205
    v_cvt_pk_bf16_f32 v29, v206, v207
    v_cvt_pk_bf16_f32 v30, v208, v209
    v_cvt_pk_bf16_f32 v31, v210, v211
    ds_write_b128 v11, v[24:27] offset:64
    ds_write_b128 v11, v[28:31] offset:80
    s_waitcnt lgkmcnt(0)
    ds_read_b128 v[32:35], v3 offset:0
    ds_read_b128 v[36:39], v3 offset:1152
    ds_read_b128 v[40:43], v3 offset:2304
    ds_read_b128 v[44:47], v3 offset:3456
    s_waitcnt lgkmcnt(3)
    buffer_store_dwordx4 v[32:35], v9, s[12:15], s22 offen sc1
    s_add_u32 s22, s22, 589824
    s_waitcnt lgkmcnt(2)
    buffer_store_dwordx4 v[36:39], v9, s[12:15], s22 offen sc1
    s_add_u32 s22, s22, 589824
    s_waitcnt lgkmcnt(1)
    buffer_store_dwordx4 v[40:43], v9, s[12:15], s22 offen sc1
    s_add_u32 s22, s22, 589824
    s_waitcnt lgkmcnt(0)
    buffer_store_dwordx4 v[44:47], v9, s[12:15], s22 offen sc1
    s_mov_b32 s3, 2
    s_branch L0_done
L0_w3a:
    s_mov_b32 s32, s28
    s_mov_b32 s33, s29
    s_mov_b32 s34, 5308416
    s_mov_b32 s35, 0x20000
    s_mov_b32 s36, s30
    s_mov_b32 s37, s31
    s_mov_b32 s38, 5308416
    s_mov_b32 s39, 0x20000
    v_bfe_u32 v240, v0, 3, 3
    v_mul_u32_u24 v240, 9216, v240
    v_lshl_add_u32 v240, v2, 4, v240
    v_and_b32 v241, 0x3ff, v248
    s_and_b32 s42, s2, 7
    s_mul_i32 s54, s42, 1152
    s_mul_i32 s43, s40, 221184
    s_add_u32 s54, s54, s43
    s_add_u32 s55, s54, 73728
    s_add_u32 s56, s54, 147456
    s_mul_i32 s57, s42, 663552
    s_mul_i32 s43, s40, 27648
    s_add_u32 s57, s57, s43
    buffer_load_dwordx4 a[252:255], v240, s[32:35], s54 offen offset:0
    buffer_load_dwordx4 a[252:255], v240, s[32:35], s55 offen offset:0
    buffer_load_dwordx4 a[252:255], v240, s[32:35], s56 offen offset:0
    buffer_load_dwordx4 a[252:255], v240, s[32:35], s54 offen offset:1024
    buffer_load_dwordx4 a[252:255], v240, s[32:35], s55 offen offset:1024
    buffer_load_dwordx4 a[252:255], v240, s[32:35], s56 offen offset:1024
    buffer_load_dwordx4 a[252:255], v240, s[32:35], s54 offen offset:128
    buffer_load_dwordx4 a[252:255], v240, s[32:35], s55 offen offset:128
    buffer_load_dwordx4 a[252:255], v240, s[32:35], s56 offen offset:128
    buffer_load_dwordx4 a[252:255], v240, s[32:35], s54 offen offset:896
    buffer_load_dwordx4 a[252:255], v240, s[32:35], s55 offen offset:896
    buffer_load_dwordx4 a[252:255], v240, s[32:35], s56 offen offset:896
    buffer_load_dwordx4 a[252:255], v240, s[32:35], s54 offen offset:256
    buffer_load_dwordx4 a[252:255], v240, s[32:35], s55 offen offset:256
    buffer_load_dwordx4 a[252:255], v240, s[32:35], s56 offen offset:256
    buffer_load_dwordx4 a[252:255], v240, s[32:35], s54 offen offset:768
    buffer_load_dwordx4 a[252:255], v240, s[32:35], s55 offen offset:768
    buffer_load_dwordx4 a[252:255], v240, s[32:35], s56 offen offset:768
    buffer_load_dwordx4 a[252:255], v240, s[32:35], s54 offen offset:384
    buffer_load_dwordx4 a[252:255], v240, s[32:35], s55 offen offset:384
    buffer_load_dwordx4 a[252:255], v240, s[32:35], s56 offen offset:384
    buffer_load_dwordx4 a[252:255], v240, s[32:35], s54 offen offset:640
    buffer_load_dwordx4 a[252:255], v240, s[32:35], s55 offen offset:640
    buffer_load_dwordx4 a[252:255], v240, s[32:35], s56 offen offset:640
    buffer_load_dwordx4 a[252:255], v240, s[32:35], s54 offen offset:512
    buffer_load_dwordx4 a[252:255], v240, s[32:35], s55 offen offset:512
    buffer_load_dwordx4 a[252:255], v240, s[32:35], s56 offen offset:512
    v_mov_b32 v12, 0
    v_mov_b32 v13, 0
    v_mov_b32 v14, 0
    v_mov_b32 v15, 0
    s_waitcnt vmcnt(40)
    v_lshlrev_b32 v52, 16, v16
    v_and_b32 v53, 0xffff0000, v16
    v_lshlrev_b32 v54, 16, v17
    v_and_b32 v55, 0xffff0000, v17
    v_lshlrev_b32 v56, 16, v18
    v_and_b32 v57, 0xffff0000, v18
    v_lshlrev_b32 v58, 16, v19
    v_and_b32 v59, 0xffff0000, v19
    v_pk_add_f32 v[12:13], v[12:13], v[52:53]
    v_pk_add_f32 v[14:15], v[14:15], v[54:55]
    v_pk_add_f32 v[12:13], v[12:13], v[56:57]
    v_pk_add_f32 v[14:15], v[14:15], v[58:59]
    s_waitcnt vmcnt(39)
    v_lshlrev_b32 v60, 16, v20
    v_and_b32 v61, 0xffff0000, v20
    v_lshlrev_b32 v62, 16, v21
    v_and_b32 v63, 0xffff0000, v21
    v_lshlrev_b32 v64, 16, v22
    v_and_b32 v65, 0xffff0000, v22
    v_lshlrev_b32 v66, 16, v23
    v_and_b32 v67, 0xffff0000, v23
    v_pk_add_f32 v[12:13], v[12:13], v[60:61]
    v_pk_add_f32 v[14:15], v[14:15], v[62:63]
    v_pk_add_f32 v[12:13], v[12:13], v[64:65]
    v_pk_add_f32 v[14:15], v[14:15], v[66:67]
    s_waitcnt vmcnt(38)
    v_lshlrev_b32 v68, 16, v24
    v_and_b32 v69, 0xffff0000, v24
    v_lshlrev_b32 v70, 16, v25
    v_and_b32 v71, 0xffff0000, v25
    v_lshlrev_b32 v72, 16, v26
    v_and_b32 v73, 0xffff0000, v26
    v_lshlrev_b32 v74, 16, v27
    v_and_b32 v75, 0xffff0000, v27
    v_pk_add_f32 v[12:13], v[12:13], v[68:69]
    v_pk_add_f32 v[14:15], v[14:15], v[70:71]
    v_pk_add_f32 v[12:13], v[12:13], v[72:73]
    v_pk_add_f32 v[14:15], v[14:15], v[74:75]
    s_waitcnt vmcnt(37)
    v_lshlrev_b32 v76, 16, v28
    v_and_b32 v77, 0xffff0000, v28
    v_lshlrev_b32 v78, 16, v29
    v_and_b32 v79, 0xffff0000, v29
    v_lshlrev_b32 v80, 16, v30
    v_and_b32 v81, 0xffff0000, v30
    v_lshlrev_b32 v82, 16, v31
    v_and_b32 v83, 0xffff0000, v31
    v_pk_add_f32 v[12:13], v[12:13], v[76:77]
    v_pk_add_f32 v[14:15], v[14:15], v[78:79]
    v_pk_add_f32 v[12:13], v[12:13], v[80:81]
    v_pk_add_f32 v[14:15], v[14:15], v[82:83]
    s_waitcnt vmcnt(36)
    v_lshlrev_b32 v84, 16, v32
    v_and_b32 v85, 0xffff0000, v32
    v_lshlrev_b32 v86, 16, v33
    v_and_b32 v87, 0xffff0000, v33
    v_lshlrev_b32 v88, 16, v34
    v_and_b32 v89, 0xffff0000, v34
    v_lshlrev_b32 v90, 16, v35
    v_and_b32 v91, 0xffff0000, v35
    v_pk_add_f32 v[12:13], v[12:13], v[84:85]
    v_pk_add_f32 v[14:15], v[14:15], v[86:87]
    v_pk_add_f32 v[12:13], v[12:13], v[88:89]
    v_pk_add_f32 v[14:15], v[14:15], v[90:91]
    s_waitcnt vmcnt(35)
    v_lshlrev_b32 v92, 16, v36
    v_and_b32 v93, 0xffff0000, v36
    v_lshlrev_b32 v94, 16, v37
    v_and_b32 v95, 0xffff0000, v37
    v_lshlrev_b32 v96, 16, v38
    v_and_b32 v97, 0xffff0000, v38
    v_lshlrev_b32 v98, 16, v39
    v_and_b32 v99, 0xffff0000, v39
    v_pk_add_f32 v[12:13], v[12:13], v[92:93]
    v_pk_add_f32 v[14:15], v[14:15], v[94:95]
    v_pk_add_f32 v[12:13], v[12:13], v[96:97]
    v_pk_add_f32 v[14:15], v[14:15], v[98:99]
    s_waitcnt vmcnt(34)
    v_lshlrev_b32 v100, 16, v40
    v_and_b32 v101, 0xffff0000, v40
    v_lshlrev_b32 v102, 16, v41
    v_and_b32 v103, 0xffff0000, v41
    v_lshlrev_b32 v104, 16, v42
    v_and_b32 v105, 0xffff0000, v42
    v_lshlrev_b32 v106, 16, v43
    v_and_b32 v107, 0xffff0000, v43
    v_pk_add_f32 v[12:13], v[12:13], v[100:101]
    v_pk_add_f32 v[14:15], v[14:15], v[102:103]
    v_pk_add_f32 v[12:13], v[12:13], v[104:105]
    v_pk_add_f32 v[14:15], v[14:15], v[106:107]
    s_waitcnt vmcnt(33)
    v_lshlrev_b32 v108, 16, v44
    v_and_b32 v109, 0xffff0000, v44
    v_lshlrev_b32 v110, 16, v45
    v_and_b32 v111, 0xffff0000, v45
    v_lshlrev_b32 v112, 16, v46
    v_and_b32 v113, 0xffff0000, v46
    v_lshlrev_b32 v114, 16, v47
    v_and_b32 v115, 0xffff0000, v47
    v_pk_add_f32 v[12:13], v[12:13], v[108:109]
    v_pk_add_f32 v[14:15], v[14:15], v[110:111]
    v_pk_add_f32 v[12:13], v[12:13], v[112:113]
    v_pk_add_f32 v[14:15], v[14:15], v[114:115]
    s_waitcnt vmcnt(32)
    v_lshlrev_b32 v116, 16, v48
    v_and_b32 v117, 0xffff0000, v48
    v_lshlrev_b32 v118, 16, v49
    v_and_b32 v119, 0xffff0000, v49
    v_lshlrev_b32 v120, 16, v50
    v_and_b32 v121, 0xffff0000, v50
    v_lshlrev_b32 v122, 16, v51
    v_and_b32 v123, 0xffff0000, v51
    v_pk_add_f32 v[12:13], v[12:13], v[116:117]
    v_pk_add_f32 v[14:15], v[14:15], v[118:119]
    v_pk_add_f32 v[12:13], v[12:13], v[120:121]
    v_pk_add_f32 v[14:15], v[14:15], v[122:123]
    s_waitcnt vmcnt(27)
    s_branch L0_ln2
L0_w3b:
    s_mov_b32 s32, s28
    s_mov_b32 s33, s29
    s_mov_b32 s34, 5308416
    s_mov_b32 s35, 0x20000
    s_mov_b32 s36, s30
    s_mov_b32 s37, s31
    s_mov_b32 s38, 5308416
    s_mov_b32 s39, 0x20000
    s_barrier
    s_mov_b32 s3, -1
    s_mov_b32 s32, s28
    s_mov_b32 s33, s29
    s_mov_b32 s34, 5308416
    s_mov_b32 s35, 0x20000
    v_bfe_u32 v236, v0, 4, 1
    v_lshlrev_b32 v236, 2, v236
    v_and_b32 v237, 7, v0
    v_xor_b32 v236, v236, v237
    v_bfe_u32 v237, v0, 3, 3
    v_mul_u32_u24 v237, 9216, v237
    v_lshl_add_u32 v236, v236, 4, v237
    v_add_u32 v237, 72704, v236
    v_add_u32 v238, 145408, v236
    s_mov_b32 s98, 0
L0_w1m:
    s_mov_b32 m0, s98
    s_add_u32 s98, s98, 3072
    buffer_load_dwordx4 v236, s[32:35], s96 offen offset:0 lds
    buffer_load_dwordx4 v237, s[32:35], s96 offen offset:1024 lds
    buffer_load_dwordx4 v238, s[32:35], s96 offen offset:2048 lds
    s_add_u32 s96, s96, 221184
    s_cmp_lt_u32 s98, 36864
    s_cbranch_scc1 L0_w1m
    s_mov_b32 s101, 0
    s_mov_b32 s100, 1020
    s_branch L2_visit
L2_vret0:
    buffer_load_dword v252, v253, s[12:15], s62 offen sc1
    s_waitcnt vmcnt(0)
    s_branch L0_done
L0_helper:
    s_sub_u32 s48, s2, 192
    s_lshr_b32 s49, s48, 1
    s_and_b32 s48, s48, 1
    s_mul_i32 s52, s49, 578
    s_and_b32 s53, s52, 15
    s_sub_u32 s52, s52, s53
    s_mul_i32 s54, s48, 591872
    s_add_u32 s52, s52, s54
    v_add_u32 v1, 0, v0
    v_mul_u32_u24 v2, 7085, v1
    v_lshrrev_b32 v2, 18, v2
    v_mul_u32_u24 v2, 17904, v2
    v_lshl_add_u32 v16, v1, 4, v2
    v_add_u32 v1, 256, v0
    v_mul_u32_u24 v2, 7085, v1
    v_lshrrev_b32 v2, 18, v2
    v_mul_u32_u24 v2, 17904, v2
    v_lshl_add_u32 v17, v1, 4, v2
    v_add_u32 v1, 512, v0
    v_mul_u32_u24 v2, 7085, v1
    v_lshrrev_b32 v2, 18, v2
    v_mul_u32_u24 v2, 17904, v2
    v_lshl_add_u32 v18, v1, 4, v2
    v_add_u32 v1, 768, v0
    v_mul_u32_u24 v2, 7085, v1
    v_lshrrev_b32 v2, 18, v2
    v_mul_u32_u24 v2, 17904, v2
    v_lshl_add_u32 v19, v1, 4, v2
    v_add_u32 v1, 1024, v0
    v_mul_u32_u24 v2, 7085, v1
    v_lshrrev_b32 v2, 18, v2
    v_mul_u32_u24 v2, 17904, v2
    v_lshl_add_u32 v20, v1, 4, v2
    s_lshl_b32 s54, s19, 10
    s_waitcnt lgkmcnt(0)
    s_mov_b32 s12, s26
    s_mov_b32 s13, s27
    s_mov_b32 s14, 49029120
    s_mov_b32 s15, 0x20000
    s_mov_b32 s8, s6
    s_mov_b32 s9, s7
    s_mov_b32 s10, 1183744
    s_mov_b32 s11, 0x20000
    s_mov_b32 s20, s24
    s_mov_b32 s21, s25
    s_mov_b32 s22, 1183744
    s_mov_b32 s23, 0x20000
    s_mov_b32 s36, s60
    s_mov_b32 s37, s61
    s_mov_b32 s38, 9216
    s_mov_b32 s39, 0x20000
    buffer_load_dword a4, v255, s[36:39], s97 offen
    buffer_load_dword a0, v248, s[12:15], s62 offen sc1
    buffer_load_dword a1, v249, s[12:15], s62 offen sc1
    buffer_load_dword a2, v253, s[12:15], s62 offen sc1
    buffer_load_dword a3, v254, s[12:15], s62 offen sc1
    s_add_u32 m0, s54, 98304
    s_nop 0
    buffer_load_dwordx4 v16, s[8:11], s52 offen nt lds
    s_add_u32 m0, s54, 118784
    s_nop 0
    buffer_load_dwordx4 v16, s[20:23], s52 offen nt lds
    s_add_u32 m0, s54, 102400
    s_nop 0
    buffer_load_dwordx4 v17, s[8:11], s52 offen nt lds
    s_add_u32 m0, s54, 122880
    s_nop 0
    buffer_load_dwordx4 v17, s[20:23], s52 offen nt lds
    s_add_u32 m0, s54, 106496
    s_nop 0
    buffer_load_dwordx4 v18, s[8:11], s52 offen nt lds
    s_add_u32 m0, s54, 126976
    s_nop 0
    buffer_load_dwordx4 v18, s[20:23], s52 offen nt lds
    s_add_u32 m0, s54, 110592
    s_nop 0
    buffer_load_dwordx4 v19, s[8:11], s52 offen nt lds
    s_add_u32 m0, s54, 131072
    s_nop 0
    buffer_load_dwordx4 v19, s[20:23], s52 offen nt lds
    s_add_u32 m0, s54, 114688
    s_nop 0
    buffer_load_dwordx4 v20, s[8:11], s52 offen nt lds
    s_add_u32 m0, s54, 135168
    s_nop 0
    buffer_load_dwordx4 v20, s[20:23], s52 offen nt lds
    v_bfe_u32 v1, v0, 4, 2
    v_mul_u32_u24 v1, 2368, v1
    v_and_b32 v2, 15, v0
    v_lshl_add_u32 v1, v2, 2, v1
    s_and_b32 s55, s19, 1
    s_mul_i32 s56, s55, 9472
    s_lshr_b32 s57, s19, 1
    s_lshl_b32 s58, s57, 6
    s_add_u32 s56, s56, s58
    s_and_b32 s58, s53, 12
    s_add_u32 s56, s56, s58
    s_add_u32 s56, s56, 98304
    v_add_u32 v1, s56, v1
    s_and_b32 s58, s53, 2
    s_lshl_b32 s58, s58, 1
    v_add_u32 v5, s58, v1
    s_mul_i32 s58, s49, 9
    s_add_u32 s58, s58, s57
    s_lshl_b32 s58, s58, 13
    s_lshl_b32 s59, s48, 1
    s_add_u32 s59, s59, s55
    s_lshl_b32 s59, s59, 10
    s_add_u32 s58, s58, s59
    s_add_u32 s58, s58, 46137344
    v_and_b32 v2, 0x3ff, v248
    v_add_u32 v3, 4096, v2
    s_mov_b32 s59, 0x05040100
    s_mov_b32 s43, 0x07060302
    s_bitcmp1_b32 s53, 1
    s_cselect_b32 s55, s43, s59
    s_cselect_b32 s56, s59, s43
    s_mov_b32 s101, 1
    s_lshl_b32 s100, 0x1111, s19
    s_branch L2_visit
L2_vret1:
    s_mov_b32 s32, s28
    s_mov_b32 s33, s29
    s_mov_b32 s34, 5308416
    s_mov_b32 s35, 0x20000
    v_bfe_u32 v236, v0, 4, 1
    v_lshlrev_b32 v236, 2, v236
    v_and_b32 v237, 7, v0
    v_xor_b32 v236, v236, v237
    v_bfe_u32 v237, v0, 3, 3
    v_mul_u32_u24 v237, 9216, v237
    v_lshl_add_u32 v236, v236, 4, v237
    v_add_u32 v237, 72704, v236
    v_add_u32 v238, 145408, v236
    s_mul_i32 s98, s19, 3072
    s_mul_i32 s99, s19, 221184
    s_add_u32 s96, s96, s99
L0_w1h:
    s_mov_b32 m0, s98
    s_add_u32 s98, s98, 12288
    buffer_load_dwordx4 v236, s[32:35], s96 offen offset:0 lds
    buffer_load_dwordx4 v237, s[32:35], s96 offen offset:1024 lds
    buffer_load_dwordx4 v238, s[32:35], s96 offen offset:2048 lds
    s_add_u32 s96, s96, 884736
    s_cmp_lt_u32 s98, 36864
    s_cbranch_scc1 L0_w1h
    s_waitcnt vmcnt(9)
    s_barrier
    s_cmp_lg_u32 s19, 0
    s_cbranch_scc1 L0_nzh
    v_mov_b32 v140, 0
    v_mov_b32 v141, 0
    v_mov_b32 v142, 0
    v_mov_b32 v143, 0
    s_lshl_b32 s22, s2, 10
    s_add_u32 s22, s22, 48562176
    buffer_store_dwordx4 v[140:143], v248, s[12:15], s22 offen sc1
    s_mov_b32 s22, 48959488
    s_mov_b64 exec, 1
    buffer_store_dword v140, v249, s[12:15], s22 offen sc1
    s_lshl_b32 s22, s2, 8
    s_add_u32 s22, s22, 48963584
    s_mov_b64 exec, 0xffff
    buffer_store_dwordx4 v[140:143], v248, s[12:15], s22 offen sc1
    s_mov_b64 exec, -1
L0_nzh:
    ds_read_b32 v24, v1 offset:0
    ds_read_b32 v28, v1 offset:20480
    ds_read_b32 v25, v1 offset:592
    ds_read_b32 v29, v1 offset:21072
    ds_read_b32 v26, v1 offset:1184
    ds_read_b32 v30, v1 offset:21664
    ds_read_b32 v27, v1 offset:1776
    ds_read_b32 v31, v1 offset:22256
    ds_read_b32 v32, v5 offset:0
    ds_read_b32 v36, v5 offset:20480
    ds_read_b32 v33, v5 offset:592
    ds_read_b32 v37, v5 offset:21072
    ds_read_b32 v34, v5 offset:1184
    ds_read_b32 v38, v5 offset:21664
    ds_read_b32 v35, v5 offset:1776
    ds_read_b32 v39, v5 offset:22256
    s_waitcnt lgkmcnt(8)
    v_perm_b32 v148, v28, v24, s55
    v_perm_b32 v149, v29, v25, s55
    v_perm_b32 v150, v30, v26, s55
    v_perm_b32 v151, v31, v27, s55
    buffer_store_dwordx4 v[148:151], v2, s[12:15], s58 offen sc1
    ds_read_b32 v40, v1 offset:128
    ds_read_b32 v44, v1 offset:20608
    ds_read_b32 v41, v1 offset:720
    ds_read_b32 v45, v1 offset:21200
    ds_read_b32 v42, v1 offset:1312
    ds_read_b32 v46, v1 offset:21792
    ds_read_b32 v43, v1 offset:1904
    ds_read_b32 v47, v1 offset:22384
    s_waitcnt lgkmcnt(8)
    v_perm_b32 v152, v36, v32, s56
    v_perm_b32 v153, v37, v33, s56
    v_perm_b32 v154, v38, v34, s56
    v_perm_b32 v155, v39, v35, s56
    buffer_store_dwordx4 v[152:155], v3, s[12:15], s58 offen sc1
    s_add_u32 s58, s58, 16384
    ds_read_b32 v48, v5 offset:128
    ds_read_b32 v52, v5 offset:20608
    ds_read_b32 v49, v5 offset:720
    ds_read_b32 v53, v5 offset:21200
    ds_read_b32 v50, v5 offset:1312
    ds_read_b32 v54, v5 offset:21792
    ds_read_b32 v51, v5 offset:1904
    ds_read_b32 v55, v5 offset:22384
    s_waitcnt lgkmcnt(8)
    v_perm_b32 v156, v44, v40, s55
    v_perm_b32 v157, v45, v41, s55
    v_perm_b32 v158, v46, v42, s55
    v_perm_b32 v159, v47, v43, s55
    buffer_store_dwordx4 v[156:159], v2, s[12:15], s58 offen sc1
    ds_read_b32 v56, v1 offset:256
    ds_read_b32 v60, v1 offset:20736
    ds_read_b32 v57, v1 offset:848
    ds_read_b32 v61, v1 offset:21328
    ds_read_b32 v58, v1 offset:1440
    ds_read_b32 v62, v1 offset:21920
    ds_read_b32 v59, v1 offset:2032
    ds_read_b32 v63, v1 offset:22512
    s_waitcnt lgkmcnt(8)
    v_perm_b32 v160, v52, v48, s56
    v_perm_b32 v161, v53, v49, s56
    v_perm_b32 v162, v54, v50, s56
    v_perm_b32 v163, v55, v51, s56
    buffer_store_dwordx4 v[160:163], v3, s[12:15], s58 offen sc1
    s_add_u32 s58, s58, 16384
    buffer_load_dword v252, v253, s[12:15], s62 offen sc1
    ds_read_b32 v64, v5 offset:256
    ds_read_b32 v68, v5 offset:20736
    ds_read_b32 v65, v5 offset:848
    ds_read_b32 v69, v5 offset:21328
    ds_read_b32 v66, v5 offset:1440
    ds_read_b32 v70, v5 offset:21920
    ds_read_b32 v67, v5 offset:2032
    ds_read_b32 v71, v5 offset:22512
    s_waitcnt lgkmcnt(8)
    v_perm_b32 v164, v60, v56, s55
    v_perm_b32 v165, v61, v57, s55
    v_perm_b32 v166, v62, v58, s55
    v_perm_b32 v167, v63, v59, s55
    buffer_store_dwordx4 v[164:167], v2, s[12:15], s58 offen sc1
    ds_read_b32 v72, v1 offset:384
    ds_read_b32 v76, v1 offset:20864
    ds_read_b32 v73, v1 offset:976
    ds_read_b32 v77, v1 offset:21456
    ds_read_b32 v74, v1 offset:1568
    ds_read_b32 v78, v1 offset:22048
    ds_read_b32 v75, v1 offset:2160
    ds_read_b32 v79, v1 offset:22640
    s_waitcnt lgkmcnt(8)
    v_perm_b32 v168, v68, v64, s56
    v_perm_b32 v169, v69, v65, s56
    v_perm_b32 v170, v70, v66, s56
    v_perm_b32 v171, v71, v67, s56
    buffer_store_dwordx4 v[168:171], v3, s[12:15], s58 offen sc1
    s_add_u32 s58, s58, 16384
    ds_read_b32 v80, v5 offset:384
    ds_read_b32 v84, v5 offset:20864
    ds_read_b32 v81, v5 offset:976
    ds_read_b32 v85, v5 offset:21456
    ds_read_b32 v82, v5 offset:1568
    ds_read_b32 v86, v5 offset:22048
    ds_read_b32 v83, v5 offset:2160
    ds_read_b32 v87, v5 offset:22640
    s_waitcnt lgkmcnt(8)
    v_perm_b32 v172, v76, v72, s55
    v_perm_b32 v173, v77, v73, s55
    v_perm_b32 v174, v78, v74, s55
    v_perm_b32 v175, v79, v75, s55
    buffer_store_dwordx4 v[172:175], v2, s[12:15], s58 offen sc1
    ds_read_b32 v88, v1 offset:512
    ds_read_b32 v92, v1 offset:20992
    ds_read_b32 v89, v1 offset:1104
    ds_read_b32 v93, v1 offset:21584
    ds_read_b32 v90, v1 offset:1696
    ds_read_b32 v94, v1 offset:22176
    ds_read_b32 v91, v1 offset:2288
    ds_read_b32 v95, v1 offset:22768
    s_waitcnt lgkmcnt(8)
    v_perm_b32 v176, v84, v80, s56
    v_perm_b32 v177, v85, v81, s56
    v_perm_b32 v178, v86, v82, s56
    v_perm_b32 v179, v87, v83, s56
    buffer_store_dwordx4 v[176:179], v3, s[12:15], s58 offen sc1
    s_add_u32 s58, s58, 16384
    ds_read_b32 v96, v5 offset:512
    ds_read_b32 v100, v5 offset:20992
    ds_read_b32 v97, v5 offset:1104
    ds_read_b32 v101, v5 offset:21584
    ds_read_b32 v98, v5 offset:1696
    ds_read_b32 v102, v5 offset:22176
    ds_read_b32 v99, v5 offset:2288
    ds_read_b32 v103, v5 offset:22768
    s_waitcnt lgkmcnt(0)
    s_mov_b32 s3, 3
    s_cmp_ge_u32 s19, 2
    s_cbranch_scc1 L0_h2
    v_perm_b32 v180, v92, v88, s55
    v_perm_b32 v181, v93, v89, s55
    v_perm_b32 v182, v94, v90, s55
    v_perm_b32 v183, v95, v91, s55
    buffer_store_dwordx4 v[180:183], v2, s[12:15], s58 offen sc1
    v_perm_b32 v184, v100, v96, s56
    v_perm_b32 v185, v101, v97, s56
    v_perm_b32 v186, v102, v98, s56
    v_perm_b32 v187, v103, v99, s56
    buffer_store_dwordx4 v[184:187], v3, s[12:15], s58 offen sc1
    s_add_u32 s58, s58, 16384
    s_branch L0_done
L0_h2:
    s_cmp_lg_u32 s19, 3
    s_cbranch_scc1 L0_done
    s_mov_b32 exec_hi, 0
    v_and_b32 v1, 31, v0
    v_mul_u32_u24 v2, 592, v1
    s_add_u32 s53, s53, 98304
    v_add_u32 v2, s53, v2
    ds_read_u16 v16, v2 offset:576
    ds_read_u16 v17, v2 offset:21056
    v_lshrrev_b32 v3, 2, v1
    v_lshlrev_b32 v3, 8, v3
    v_and_b32 v4, 3, v1
    v_lshl_add_u32 v3, v4, 2, v3
    s_lshr_b32 s57, s49, 4
    s_lshl_b32 s57, s57, 12
    s_and_b32 s58, s49, 15
    s_lshl_b32 s58, s58, 4
    s_add_u32 s57, s57, s58
    s_lshl_b32 s58, s48, 11
    s_add_u32 s57, s57, s58
    s_add_u32 s57, s57, 48496640
    s_waitcnt lgkmcnt(0)
    v_lshl_or_b32 v16, v17, 16, v16
    buffer_store_dword v16, v3, s[12:15], s57 offen sc1
    s_mov_b64 exec, -1
L0_done:
    s_mov_b32 s16, s26
    s_mov_b32 s17, s27
    s_mov_b32 s18, 49029120
    s_mov_b32 s19, 0x20000
    s_mov_b32 s8, s28
    s_mov_b32 s9, s29
    s_mov_b32 s10, 5308416
    s_mov_b32 s11, 0x20000
    s_sub_u32 s12, s30, 2048
    s_subb_u32 s13, s31, 0
    s_mov_b32 s14, 5310464
    s_mov_b32 s15, 0x20000
    v_lshrrev_b32 v4, 6, v0
    s_nop 0
    v_readfirstlane_b32 s28, v4
    s_bfe_u32 s31, s2, 0x10003
    s_and_b32 s29, s2, 6
    s_bfe_u32 s30, s2, 0x10004
    s_add_u32 s29, s29, s30
    s_and_b32 s30, s2, 1
    s_lshl_b32 s30, s30, 3
    s_lshr_b32 s39, s2, 5
    s_add_u32 s30, s30, s39
    s_lshr_b32 s32, s28, 1
    s_and_b32 s33, s28, 1
    s_xor_b32 s34, s33, s31
    s_lshl_b32 s48, s31, 10
    s_mul_i32 s35, s29, 1152
    s_add_u32 s35, s35, s48
    s_lshl_b32 s36, s31, 8
    s_sub_u32 s36, 128, s36
    s_mul_i32 s37, s28, 3072
    s_lshl_b32 s38, s30, 2
    s_add_u32 s38, s38, s28
    s_mul_i32 s38, s38, 36864
    v_and_b32 v224, 63, v0
    v_lshlrev_b32 v1, 4, v224
    v_bfe_u32 v225, v0, 4, 1
    v_lshlrev_b32 v225, 2, v225
    v_and_b32 v226, 7, v0
    v_xor_b32 v225, v225, v226
    v_bfe_u32 v226, v0, 3, 3
    s_mul_i32 s39, s28, 24
    v_add_u32 v227, s39, v226
    v_mul_u32_u24 v9, 9216, v227
    v_lshl_add_u32 v9, v225, 4, v9
    v_add_u32 v10, 72704, v9
    v_add_u32 v11, 145408, v9
    s_mov_b32 s24, 48824320
    s_waitcnt vmcnt(4)
    v_accvgpr_read_b32 v238, a2
    v_cmp_ne_u32 vcc, v252, v238
    s_nop 0
    s_cmp_eq_u64 vcc, -1
    s_cbranch_scc0 L2_xspin
L2_xok:
    s_add_u32 m0, s37, 86016
    s_add_u32 s40, s38, 0
    buffer_load_dwordx4 v1, s[16:19], s40 offen offset:0 sc1 lds
    buffer_load_dwordx4 v1, s[16:19], s40 offen offset:1024 sc1 lds
    buffer_load_dwordx4 v1, s[16:19], s40 offen offset:2048 sc1 lds
    s_add_u32 m0, s37, 36864
    s_add_u32 s40, s38, 3072
    buffer_load_dwordx4 v1, s[16:19], s40 offen offset:0 sc1 lds
    buffer_load_dwordx4 v1, s[16:19], s40 offen offset:1024 sc1 lds
    buffer_load_dwordx4 v1, s[16:19], s40 offen offset:2048 sc1 lds
    s_add_u32 m0, s37, 49152
    s_add_u32 s40, s38, 6144
    buffer_load_dwordx4 v1, s[16:19], s40 offen offset:0 sc1 lds
    buffer_load_dwordx4 v1, s[16:19], s40 offen offset:1024 sc1 lds
    buffer_load_dwordx4 v1, s[16:19], s40 offen offset:2048 sc1 lds
    v_accvgpr_read_b32 v236, a4
    v_lshlrev_b32 v224, 16, v236
    v_and_b32 v225, 0xffff0000, v236
    v_mul_f32 v224, 0x3fb8aa3b, v224
    v_mul_f32 v225, 0x3fb8aa3b, v225
    v_lshlrev_b32 v226, 3, v0
    v_add_u32 v226, 159744, v226
    v_cmp_gt_u32 vcc, 144, v0
    s_nop 0
    s_and_saveexec_b64 s[4:5], vcc
    ds_write_b64 v226, v[224:225]
    s_mov_b64 exec, s[4:5]
    v_bfe_u32 v230, v0, 2, 2
    v_bfe_u32 v231, v0, 5, 1
    v_bfe_u32 v232, v0, 4, 1
    v_and_b32 v233, 3, v0
    v_lshl_add_u32 v234, v231, 3, v230
    v_lshlrev_b32 v234, 7, v234
    v_lshl_add_u32 v234, v233, 3, v234
    v_and_b32 v235, 2, v230
    v_or_b32 v235, v235, v232
    v_lshl_add_u32 v234, v235, 5, v234
    s_lshl_b32 s39, s33, 6
    v_xor_b32 v21, s39, v234
    v_add_u32 v36, s37, v1
    s_xor_b32 s39, s28, 1
    s_mul_i32 s39, s39, 3072
    v_add_u32 v39, s39, v1
    v_add_u32 v22, 0x10000, v21
    v_add_u32 v23, 0x20000, v21
    v_add_u32 v37, 0x10000, v36
    v_add_u32 v38, 0x20000, v36
    v_add_u32 v40, 0x10000, v39
    v_add_u32 v41, 0x20000, v39
    v_lshlrev_b32 v3, 4, v231
    v_add_u32 v3, 159744, v3
    s_lshl_b32 s39, s34, 7
    v_add_u32 v2, s39, v3
    v_accvgpr_read_b32 v220, a0
    v_accvgpr_read_b32 v221, a1
    v_accvgpr_read_b32 v237, a3
    v_lshrrev_b32 v238, 6, v0
    v_cmp_eq_u32 vcc, 3, v238
    s_nop 1
    v_cndmask_b32 v221, v237, v221, vcc
    v_cndmask_b32 v222, v254, v249, vcc
    v_add_u32 v221, 2, v221
    s_lshr_b32 s58, s28, 1
    s_lshl_b32 s98, s58, 13
    s_add_u32 s98, s98, 122880
    s_lshl_b32 s58, s58, 8
    s_add_u32 s58, s58, s2
    s_mul_i32 s59, s58, 7282
    s_lshr_b32 s59, s59, 16
    s_mul_i32 s60, s59, 9
    s_sub_u32 s60, s58, s60
    s_lshl_b32 s60, s60, 7
    s_mul_i32 s61, s59, 73728
    s_add_u32 s61, s61, s60
    s_add_u32 s61, s61, 2359296
    s_mul_i32 s96, s59, 1152
    s_add_u32 s96, s96, s60
    s_add_u32 s96, s96, 4784128
    s_cmp_eq_u32 s58, 288
    s_cselect_b32 s61, 4718592, s61
    s_cselect_b32 s96, 4726784, s96
    s_mov_b32 s62, 1152
    s_mov_b32 s97, 36864
    s_cselect_b32 s62, 128, s62
    s_cselect_b32 s97, 128, s97
    s_and_b32 s60, s28, 1
    s_lshl_b32 s99, s58, 1
    s_add_u32 s99, s99, s60
    s_lshl_b32 s99, s99, 12
    s_add_u32 s99, s99, 46137344
    s_cmp_gt_u32 s58, 288
    s_cselect_b32 s61, 0x40000000, s61
    s_cselect_b32 s96, 0x40000000, s96
    s_cselect_b32 s99, 0x40000000, s99
    s_lshl_b32 s100, s60, 5
    s_lshl_b32 s59, s60, 12
    s_add_u32 s59, s59, s98
    s_lshl_b32 s58, s28, 12
    s_add_u32 s58, s58, 139264
    s_cmp_eq_u32 s3, -1
    s_cbranch_scc1 L2_nopuba
    s_waitcnt vmcnt(9)
    v_mov_b32 v251, 1
    v_accvgpr_read_b32 v255, a1
    s_mov_b64 exec, 1
    ds_add_rtn_u32 v251, v250, v251
    v_add_u32 v255, 1, v255
    s_waitcnt lgkmcnt(0)
    v_readfirstlane_b32 s25, v251
    s_nop 0
    s_cmp_lg_u32 s25, s3
    s_cbranch_scc1 L2_nopub1a
    buffer_store_dword v255, v249, s[16:19], s24 offen sc1
L2_nopub1a:
    s_mov_b64 exec, -1
    s_mov_b32 s3, -1
L2_nopuba:
    s_barrier
    v_and_b32 v164, 15, v0
    v_bfe_u32 v165, v0, 4, 2
    v_and_b32 v166, 1, v0
    v_mul_u32_u24 v166, 0x8000, v166
    v_lshl_add_u32 v166, v166, 16, v166
    v_cvt_f32_u32 v169, v165
    s_add_u32 m0, s37, 61440
    s_add_u32 s40, s38, 9216
    buffer_load_dwordx4 v1, s[16:19], s40 offen offset:0 sc1 lds
    v_mul_f32 v169, 4.0, v169
    v_add_u32 v167, 0, v164
    v_cvt_f32_u32 v167, v167
    v_mul_f32 v167, 0x3c800000, v167
    v_mul_f32 v168, v169, v167
    v_mov_b32 v140, v168
    buffer_load_dwordx4 v1, s[16:19], s40 offen offset:1024 sc1 lds
    v_fmamk_f32 v141, v167, 0x3f800000, v168
    v_fmamk_f32 v142, v167, 0x40000000, v168
    v_fmamk_f32 v143, v167, 0x40400000, v168
    v_fmamk_f32 v144, v167, 0x41800000, v168
    v_fmamk_f32 v145, v167, 0x41880000, v168
    v_fmamk_f32 v146, v167, 0x41900000, v168
    buffer_load_dwordx4 v1, s[16:19], s40 offen offset:2048 sc1 lds
    v_fmamk_f32 v147, v167, 0x41980000, v168
    v_cos_f32 v148, v140
    v_sin_f32 v156, v140
    v_cos_f32 v149, v141
    v_sin_f32 v157, v141
    v_cos_f32 v150, v142
    s_add_u32 m0, s37, 73728
    s_add_u32 s40, s38, 12288
    buffer_load_dwordx4 v1, s[16:19], s40 offen offset:0 sc1 lds
    v_sin_f32 v158, v142
    v_cos_f32 v151, v143
    v_sin_f32 v159, v143
    v_cos_f32 v152, v144
    v_sin_f32 v160, v144
    v_cos_f32 v153, v145
    buffer_load_dwordx4 v1, s[16:19], s40 offen offset:1024 sc1 lds
    v_sin_f32 v161, v145
    v_cos_f32 v154, v146
    v_sin_f32 v162, v146
    v_cos_f32 v155, v147
    v_sin_f32 v163, v147
    v_cvt_pk_bf16_f32 v188, v148, v149
    buffer_load_dwordx4 v1, s[16:19], s40 offen offset:2048 sc1 lds
    v_cvt_pk_bf16_f32 v204, v156, v157
    v_cvt_pk_bf16_f32 v189, v150, v151
    v_cvt_pk_bf16_f32 v205, v158, v159
    v_cvt_pk_bf16_f32 v190, v152, v153
    v_cvt_pk_bf16_f32 v206, v160, v161
    v_cvt_pk_bf16_f32 v191, v154, v155
    s_add_u32 m0, s37, 98304
    s_add_u32 s40, s38, 15360
    buffer_load_dwordx4 v1, s[16:19], s40 offen offset:0 sc1 lds
    v_cvt_pk_bf16_f32 v207, v162, v163
    v_add_u32 v167, 16, v164
    v_cvt_f32_u32 v167, v167
    v_mul_f32 v167, 0x3c800000, v167
    v_mul_f32 v168, v169, v167
    v_mov_b32 v140, v168
    buffer_load_dwordx4 v1, s[16:19], s40 offen offset:1024 sc1 lds
    v_fmamk_f32 v141, v167, 0x3f800000, v168
    v_fmamk_f32 v142, v167, 0x40000000, v168
    v_fmamk_f32 v143, v167, 0x40400000, v168
    v_fmamk_f32 v144, v167, 0x41800000, v168
    v_fmamk_f32 v145, v167, 0x41880000, v168
    v_fmamk_f32 v146, v167, 0x41900000, v168
    buffer_load_dwordx4 v1, s[16:19], s40 offen offset:2048 sc1 lds
    v_fmamk_f32 v147, v167, 0x41980000, v168
    v_cos_f32 v148, v140
    v_sin_f32 v156, v140
    v_cos_f32 v149, v141
    v_sin_f32 v157, v141
    v_cos_f32 v150, v142
    s_add_u32 m0, s37, 110592
    s_add_u32 s40, s38, 18432
    buffer_load_dwordx4 v1, s[16:19], s40 offen offset:0 sc1 lds
    v_sin_f32 v158, v142
    v_cos_f32 v151, v143
    v_sin_f32 v159, v143
    v_cos_f32 v152, v144
    v_sin_f32 v160, v144
    v_cos_f32 v153, v145
    buffer_load_dwordx4 v1, s[16:19], s40 offen offset:1024 sc1 lds
    v_sin_f32 v161, v145
    v_cos_f32 v154, v146
    v_sin_f32 v162, v146
    v_cos_f32 v155, v147
    v_sin_f32 v163, v147
    v_cvt_pk_bf16_f32 v196, v148, v149
    buffer_load_dwordx4 v1, s[16:19], s40 offen offset:2048 sc1 lds
    v_cvt_pk_bf16_f32 v212, v156, v157
    v_cvt_pk_bf16_f32 v197, v150, v151
    v_cvt_pk_bf16_f32 v213, v158, v159
    v_cvt_pk_bf16_f32 v198, v152, v153
    v_cvt_pk_bf16_f32 v214, v160, v161
    v_cvt_pk_bf16_f32 v199, v154, v155
    s_add_u32 m0, s37, 122880
    s_add_u32 s40, s38, 21504
    buffer_load_dwordx4 v1, s[16:19], s40 offen offset:0 sc1 lds
    v_cvt_pk_bf16_f32 v215, v162, v163
    v_xor_b32 v192, v166, v188
    v_xor_b32 v193, v166, v189
    v_xor_b32 v194, v166, v190
    v_xor_b32 v195, v166, v191
    v_xor_b32 v200, v166, v196
    buffer_load_dwordx4 v1, s[16:19], s40 offen offset:1024 sc1 lds
    v_xor_b32 v201, v166, v197
    v_xor_b32 v202, v166, v198
    v_xor_b32 v203, v166, v199
    v_xor_b32 v208, v166, v204
    v_xor_b32 v209, v166, v205
    v_xor_b32 v210, v166, v206
    buffer_load_dwordx4 v1, s[16:19], s40 offen offset:2048 sc1 lds
    v_xor_b32 v211, v166, v207
    v_xor_b32 v216, v166, v212
    v_xor_b32 v217, v166, v213
    v_xor_b32 v218, v166, v214
    v_xor_b32 v219, v166, v215
    s_lshl_b32 s49, s36, 5
    s_add_u32 m0, s37, 135168
    s_add_u32 s40, s35, 2654208
    buffer_load_dwordx4 v9, s[8:11], s40 offen offset:0 lds
    s_mul_i32 s41, s2, 73728
    s_add_u32 s41, s41, 27262976
    s_lshl_b32 s39, s34, 11
    s_sub_u32 s42, s41, s39
    s_add_u32 s42, s42, 16384
    s_xor_b32 s47, s2, 8
    buffer_load_dwordx4 v10, s[8:11], s40 offen offset:1024 lds
    s_mul_i32 s43, s47, 73728
    s_mul_i32 s39, s32, 18432
    s_add_u32 s43, s43, s39
    s_mul_i32 s39, s33, 3072
    s_add_u32 s43, s43, s39
    s_add_u32 s43, s43, 27262976
    buffer_load_dwordx4 v11, s[8:11], s40 offen offset:2048 lds
    s_lshl_b32 s47, s47, 10
    s_add_u32 s47, s47, 48562176
    s_lshl_b32 s46, s2, 2
    s_add_u32 s46, s46, s28
    s_lshl_b32 s46, s46, 8
    s_add_u32 s46, s46, 48562176
    s_mul_i32 s44, s29, 2359296
    s_lshl_b32 s39, s30, 1
    s_add_u32 s39, s39, s32
    s_mul_i32 s39, s39, 73728
    s_add_u32 s44, s44, s39
    s_add_u32 s44, s44, 7340032
    s_lshl_b32 s39, s31, 1
    s_add_u32 s51, s39, s33
    s_lshl_b32 s39, s51, 10
    s_add_u32 s45, s44, s39
    s_add_u32 s45, s45, 16384
    s_lshl_b32 s39, s31, 15
    s_add_u32 s44, s44, s39
    s_lshl_b32 s39, s33, 11
    s_add_u32 s44, s44, s39
    s_mul_i32 s39, s29, 663552
    s_mul_i32 s50, s31, 552960
    s_add_u32 s52, s39, s50
    s_add_u32 s52, s52, 0
    s_sub_u32 s55, s39, s50
    s_add_u32 s55, s55, 552960
    s_waitcnt lgkmcnt(0)
    s_branch L2_skip0
.p2align 12
L2_pad0:
    s_branch L2_ret0
    s_nop 0
L2_skip0:
    s_waitcnt vmcnt(21)
    s_barrier
    ds_read_b128 v[172:175], v2 offset:0
    ds_read_b128 v[176:179], v2 offset:32
    ds_read_b128 v[180:183], v2 offset:64
    ds_read_b128 v[184:187], v2 offset:96
    ds_read_b128 a[144:147], v37 offset:20480
    ds_read_b128 a[0:3], v40 offset:20480
    ds_read_b64_tr_b16 v[76:77], v21 offset:0
    ds_read_b64_tr_b16 v[78:79], v21 offset:512
    ds_read_b128 a[148:151], v37 offset:21504
    ds_read_b128 a[4:7], v40 offset:21504
    ds_read_b64_tr_b16 v[80:81], v21 offset:2048
    ds_read_b64_tr_b16 v[82:83], v21 offset:2560
    ds_read_b128 a[152:155], v37 offset:22528
    ds_read_b128 a[8:11], v40 offset:22528
    ds_read_b64_tr_b16 v[84:85], v21 offset:4096
    ds_read_b64_tr_b16 v[86:87], v21 offset:4608
    ds_read_b128 a[156:159], v36 offset:36864
    ds_read_b128 a[12:15], v39 offset:36864
    ds_read_b64_tr_b16 v[88:89], v21 offset:6144
    ds_read_b64_tr_b16 v[90:91], v21 offset:6656
    ds_read_b128 a[160:163], v36 offset:37888
    ds_read_b128 a[16:19], v39 offset:37888
    ds_read_b64_tr_b16 v[92:93], v21 offset:8192
    ds_read_b64_tr_b16 v[94:95], v21 offset:8704
    s_waitcnt lgkmcnt(14)
    v_mfma_f32_32x32x16_bf16 v[108:123], v[76:79], a[144:147], v[172:187]
    ds_read_b128 a[164:167], v36 offset:38912
    ds_read_b128 a[20:23], v39 offset:38912
    v_mfma_f32_32x32x16_bf16 v[124:139], v[76:79], a[0:3], v[172:187]
    ds_read_b64_tr_b16 v[96:97], v21 offset:10240
    ds_read_b64_tr_b16 v[98:99], v21 offset:10752
    s_add_u32 m0, s37, 147456
    s_add_u32 s40, s38, 24576
    buffer_load_dwordx4 v1, s[16:19], s40 offen offset:0 sc1 lds
    s_waitcnt lgkmcnt(12)
    v_mfma_f32_32x32x16_bf16 v[108:123], v[80:83], a[148:151], v[108:123]
    buffer_load_dwordx4 v1, s[16:19], s40 offen offset:1024 sc1 lds
    s_mul_i32 s50, s31, 331776
    s_add_u32 s53, s39, s50
    s_add_u32 s53, s53, 110592
    s_sub_u32 s56, s39, s50
    v_mfma_f32_32x32x16_bf16 v[124:139], v[80:83], a[4:7], v[124:139]
    buffer_load_dwordx4 v1, s[16:19], s40 offen offset:2048 sc1 lds
    s_add_u32 s56, s56, 442368
    s_mul_i32 s50, s31, 110592
    s_add_u32 s54, s39, s50
    s_add_u32 s54, s54, 221184
    s_sub_u32 s57, s39, s50
    v_mfma_f32_32x32x16_bf16 v[108:123], v[84:87], a[152:155], v[108:123]
    s_waitcnt vmcnt(18) lgkmcnt(0)
    s_barrier
    v_mfma_f32_32x32x16_bf16 v[124:139], v[84:87], a[8:11], v[124:139]
    ds_read_b128 a[168:171], v36 offset:49152
    ds_read_b128 a[24:27], v39 offset:49152
    ds_read_b64_tr_b16 v[100:101], v21 offset:12288
    s_add_u32 m0, s37, 86016
    s_add_u32 s40, s38, 27648
    buffer_load_dwordx4 v1, s[16:19], s40 offen offset:0 sc1 lds
    v_mfma_f32_32x32x16_bf16 v[108:123], v[88:91], a[156:159], v[108:123]
    ds_read_b64_tr_b16 v[102:103], v21 offset:12800
    ds_read_b128 a[172:175], v36 offset:50176
    ds_read_b128 a[28:31], v39 offset:50176
    buffer_load_dwordx4 v1, s[16:19], s40 offen offset:1024 sc1 lds
    v_mfma_f32_32x32x16_bf16 v[124:139], v[88:91], a[12:15], v[124:139]
    ds_read_b64_tr_b16 v[104:105], v21 offset:14336
    ds_read_b64_tr_b16 v[106:107], v21 offset:14848
    ds_read_b128 a[176:179], v36 offset:51200
    buffer_load_dwordx4 v1, s[16:19], s40 offen offset:2048 sc1 lds
    v_mfma_f32_32x32x16_bf16 v[108:123], v[92:95], a[160:163], v[108:123]
    ds_read_b128 a[32:35], v39 offset:51200
    ds_read_b64_tr_b16 v[76:77], v21 offset:16384
    ds_read_b64_tr_b16 v[78:79], v21 offset:16896
    s_add_u32 m0, s37, 0
    s_add_u32 s40, s35, 3538944
    buffer_load_dwordx4 v9, s[8:11], s40 offen offset:0 lds
    v_mfma_f32_32x32x16_bf16 v[124:139], v[92:95], a[16:19], v[124:139]
    ds_read_b128 a[180:183], v36 offset:61440
    ds_read_b128 a[36:39], v39 offset:61440
    ds_read_b64_tr_b16 v[80:81], v21 offset:18432
    buffer_load_dwordx4 v10, s[8:11], s40 offen offset:1024 lds
    v_mfma_f32_32x32x16_bf16 v[108:123], v[96:99], a[164:167], v[108:123]
    ds_read_b64_tr_b16 v[82:83], v21 offset:18944
    ds_read_b128 a[184:187], v36 offset:62464
    ds_read_b128 a[40:43], v39 offset:62464
    s_add_u32 s57, s57, 331776
    v_mfma_f32_32x32x16_bf16 v[124:139], v[96:99], a[20:23], v[124:139]
    ds_read_b64_tr_b16 v[84:85], v21 offset:20480
    ds_read_b64_tr_b16 v[86:87], v21 offset:20992
    buffer_load_dwordx4 v11, s[8:11], s40 offen offset:2048 lds
    v_bfe_u32 v140, v0, 2, 4
    s_mul_i32 s39, s28, 48
    v_add_u32 v140, s39, v140
    s_waitcnt lgkmcnt(12)
    v_mfma_f32_32x32x16_bf16 v[108:123], v[100:103], a[168:171], v[108:123]
    ds_read_b128 a[188:191], v36 offset:63488
    ds_read_b128 a[44:47], v39 offset:63488
    s_add_u32 m0, s37, 36864
    s_add_u32 s40, s38, 30720
    buffer_load_dwordx4 v1, s[16:19], s40 offen offset:0 sc1 lds
    v_mfma_f32_32x32x16_bf16 v[124:139], v[100:103], a[24:27], v[124:139]
    ds_read_b64_tr_b16 v[88:89], v21 offset:22528
    ds_read_b64_tr_b16 v[90:91], v21 offset:23040
    buffer_load_dwordx4 v1, s[16:19], s40 offen offset:1024 sc1 lds
    v_mul_u32_u24 v12, 9216, v140
    v_mfma_f32_32x32x16_bf16 v[108:123], v[104:107], a[172:175], v[108:123]
    buffer_load_dwordx4 v1, s[16:19], s40 offen offset:2048 sc1 lds
    v_bfe_u32 v146, v0, 2, 2
    v_bfe_u32 v147, v0, 5, 1
    v_bfe_u32 v148, v0, 4, 1
    v_and_b32 v149, 3, v0
    v_lshl_add_u32 v12, v149, 4, v12
    v_mfma_f32_32x32x16_bf16 v[124:139], v[104:107], a[28:31], v[124:139]
    s_lshl_b32 s39, s31, 6
    v_add_u32 v12, s39, v12
    v_add_u32 v13, 146432, v12
    v_add_u32 v14, 292864, v12
    v_lshlrev_b32 v141, 2, v148
    v_lshl_or_b32 v141, v147, 1, v141
    s_waitcnt vmcnt(21) lgkmcnt(0)
    v_mfma_f32_32x32x16_bf16 v[108:123], v[76:79], a[176:179], v[108:123]
    s_barrier
    v_and_b32 v142, 7, v0
    v_mfma_f32_32x32x16_bf16 v[124:139], v[76:79], a[32:35], v[124:139]
    ds_read_b128 a[192:195], v37 offset:8192
    ds_read_b128 a[48:51], v40 offset:8192
    ds_read_b64_tr_b16 v[92:93], v21 offset:24576
    s_add_u32 m0, s37, 12288
    s_add_u32 s40, s38, 33792
    buffer_load_dwordx4 v1, s[16:19], s40 offen offset:0 sc1 lds
    v_mfma_f32_32x32x16_bf16 v[108:123], v[80:83], a[180:183], v[108:123]
    ds_read_b64_tr_b16 v[94:95], v21 offset:25088
    ds_read_b128 a[196:199], v37 offset:9216
    ds_read_b128 a[52:55], v40 offset:9216
    buffer_load_dwordx4 v1, s[16:19], s40 offen offset:1024 sc1 lds
    v_mfma_f32_32x32x16_bf16 v[124:139], v[80:83], a[36:39], v[124:139]
    ds_read_b64_tr_b16 v[96:97], v21 offset:26624
    ds_read_b64_tr_b16 v[98:99], v21 offset:27136
    ds_read_b128 a[200:203], v37 offset:10240
    buffer_load_dwordx4 v1, s[16:19], s40 offen offset:2048 sc1 lds
    v_mfma_f32_32x32x16_bf16 v[108:123], v[84:87], a[184:187], v[108:123]
    ds_read_b128 a[56:59], v40 offset:10240
    ds_read_b64_tr_b16 v[100:101], v21 offset:28672
    ds_read_b64_tr_b16 v[102:103], v21 offset:29184
    s_add_u32 m0, s37, 49152
    s_add_u32 s40, s35, 4423680
    buffer_load_dwordx4 v9, s[8:11], s40 offen offset:0 lds
    v_mfma_f32_32x32x16_bf16 v[124:139], v[84:87], a[40:43], v[124:139]
    ds_read_b128 a[204:207], v37 offset:32768
    ds_read_b128 a[60:63], v40 offset:32768
    ds_read_b64_tr_b16 v[104:105], v21 offset:30720
    buffer_load_dwordx4 v10, s[8:11], s40 offen offset:1024 lds
    v_mfma_f32_32x32x16_bf16 v[108:123], v[88:91], a[188:191], v[108:123]
    ds_read_b64_tr_b16 v[106:107], v21 offset:31232
    ds_read_b128 a[208:211], v37 offset:33792
    ds_read_b128 a[64:67], v40 offset:33792
    v_xor_b32 v141, v141, v142
    v_mfma_f32_32x32x16_bf16 v[124:139], v[88:91], a[44:47], v[124:139]
    ds_read_b64_tr_b16 v[76:77], v21 offset:32768
    ds_read_b64_tr_b16 v[78:79], v21 offset:33280
    buffer_load_dwordx4 v11, s[8:11], s40 offen offset:2048 lds
    v_lshlrev_b32 v141, 4, v141
    v_bfe_u32 v142, v0, 3, 3
    s_mul_i32 s39, s28, 24
    s_waitcnt lgkmcnt(12)
    v_mfma_f32_32x32x16_bf16 v[108:123], v[92:95], a[192:195], v[108:123]
    ds_read_b128 a[212:215], v37 offset:34816
    ds_read_b128 a[68:71], v40 offset:34816
    s_add_u32 m0, s37, 61440
    s_add_u32 s35, s35, s36
    s_add_u32 s40, s35, 0
    buffer_load_dwordx4 v9, s[8:11], s40 offen offset:0 lds
    v_mfma_f32_32x32x16_bf16 v[124:139], v[92:95], a[48:51], v[124:139]
    ds_read_b64_tr_b16 v[80:81], v21 offset:34816
    ds_read_b64_tr_b16 v[82:83], v21 offset:35328
    buffer_load_dwordx4 v10, s[8:11], s40 offen offset:1024 lds
    v_add_u32 v143, s39, v142
    v_mfma_f32_32x32x16_bf16 v[108:123], v[96:99], a[196:199], v[108:123]
    buffer_load_dwordx4 v11, s[8:11], s40 offen offset:2048 lds
    v_mov_b32 v140, s31
    v_cmp_eq_u32 vcc, 1, v140
    v_add_u32 v140, 0, v143
    v_and_b32 v142, 0x60, v140
    v_mfma_f32_32x32x16_bf16 v[124:139], v[96:99], a[52:55], v[124:139]
    v_lshlrev_b32 v142, 1, v142
    v_sub_u32 v142, v140, v142
    v_add_u32 v142, 64, v142
    v_cndmask_b32 v144, v140, v142, vcc
    v_cndmask_b32 v145, v142, v140, vcc
    v_mul_u32_u24 v144, 1152, v144
    v_mul_u32_u24 v145, 1152, v145
    s_waitcnt vmcnt(21) lgkmcnt(0)
    v_mfma_f32_32x32x16_bf16 v[108:123], v[100:103], a[200:203], v[108:123]
    s_barrier
    v_add_u32 v152, 2048, v141
    v_mfma_f32_32x32x16_bf16 v[124:139], v[100:103], a[56:59], v[124:139]
    ds_read_b128 a[216:219], v37 offset:45056
    ds_read_b128 a[72:75], v40 offset:45056
    ds_read_b64_tr_b16 v[84:85], v23 offset:4096
    s_add_u32 m0, s37, 24576
    s_add_u32 s40, s35, 884736
    buffer_load_dwordx4 v9, s[8:11], s40 offen offset:0 lds
    v_mfma_f32_32x32x16_bf16 v[108:123], v[104:107], a[204:207], v[108:123]
    ds_read_b64_tr_b16 v[86:87], v23 offset:4608
    ds_read_b128 a[220:223], v37 offset:46080
    ds_read_b128 a[76:79], v40 offset:46080
    v_add_u32 v15, v144, v152
    v_mfma_f32_32x32x16_bf16 v[124:139], v[104:107], a[60:63], v[124:139]
    ds_read_b64_tr_b16 v[88:89], v23 offset:6144
    ds_read_b64_tr_b16 v[90:91], v23 offset:6656
    ds_read_b128 a[224:227], v37 offset:47104
    buffer_load_dwordx4 v10, s[8:11], s40 offen offset:1024 lds
    v_add_u32 v18, v145, v152
    v_mfma_f32_32x32x16_bf16 v[108:123], v[76:79], a[208:211], v[108:123]
    ds_read_b128 a[80:83], v40 offset:47104
    ds_read_b64_tr_b16 v[92:93], v23 offset:8192
    ds_read_b64_tr_b16 v[94:95], v23 offset:8704
    buffer_load_dwordx4 v11, s[8:11], s40 offen offset:2048 lds
    v_mfma_f32_32x32x16_bf16 v[124:139], v[76:79], a[64:67], v[124:139]
    ds_read_b128 a[228:231], v37 offset:57344
    ds_read_b128 a[84:87], v40 offset:57344
    ds_read_b64_tr_b16 v[96:97], v23 offset:10240
    v_add_u32 v140, 8, v143
    v_and_b32 v142, 0x60, v140
    v_lshlrev_b32 v142, 1, v142
    v_mfma_f32_32x32x16_bf16 v[108:123], v[80:83], a[212:215], v[108:123]
    ds_read_b64_tr_b16 v[98:99], v23 offset:10752
    ds_read_b128 a[232:235], v37 offset:58368
    ds_read_b128 a[88:91], v40 offset:58368
    v_sub_u32 v142, v140, v142
    v_add_u32 v142, 64, v142
    v_cndmask_b32 v144, v140, v142, vcc
    v_mfma_f32_32x32x16_bf16 v[124:139], v[80:83], a[68:71], v[124:139]
    ds_read_b64_tr_b16 v[100:101], v23 offset:12288
    ds_read_b64_tr_b16 v[102:103], v23 offset:12800
    s_add_u32 m0, s37, 73728
    s_add_u32 s40, s35, 1769472
    buffer_load_dwordx4 v9, s[8:11], s40 offen offset:0 lds
    s_waitcnt lgkmcnt(12)
    v_mfma_f32_32x32x16_bf16 v[108:123], v[84:87], a[216:219], v[108:123]
    ds_read_b128 a[236:239], v37 offset:59392
    ds_read_b128 a[92:95], v40 offset:59392
    v_cndmask_b32 v145, v142, v140, vcc
    v_mul_u32_u24 v144, 1152, v144
    v_mul_u32_u24 v145, 1152, v145
    v_add_u32 v152, 1024, v141
    v_mfma_f32_32x32x16_bf16 v[124:139], v[84:87], a[72:75], v[124:139]
    ds_read_b64_tr_b16 v[104:105], v23 offset:14336
    ds_read_b64_tr_b16 v[106:107], v23 offset:14848
    buffer_load_dwordx4 v10, s[8:11], s40 offen offset:1024 lds
    v_add_u32 v16, v144, v152
    v_add_u32 v19, v145, v152
    v_mfma_f32_32x32x16_bf16 v[108:123], v[88:91], a[220:223], v[108:123]
    buffer_load_dwordx4 v11, s[8:11], s40 offen offset:2048 lds
    v_add_u32 v140, 16, v143
    v_and_b32 v142, 0x60, v140
    v_lshlrev_b32 v142, 1, v142
    v_sub_u32 v142, v140, v142
    v_add_u32 v142, 64, v142
    v_mfma_f32_32x32x16_bf16 v[124:139], v[88:91], a[76:79], v[124:139]
    v_cndmask_b32 v144, v140, v142, vcc
    v_cndmask_b32 v145, v142, v140, vcc
    v_mul_u32_u24 v144, 1152, v144
    v_mul_u32_u24 v145, 1152, v145
    v_add_u32 v152, 0, v141
    v_add_u32 v17, v144, v152
    s_waitcnt vmcnt(18) lgkmcnt(0)
    v_mfma_f32_32x32x16_bf16 v[108:123], v[92:95], a[224:227], v[108:123]
    s_barrier
    v_add_u32 v20, v145, v152
    v_mfma_f32_32x32x16_bf16 v[124:139], v[92:95], a[80:83], v[124:139]
    ds_read_b128 a[240:243], v38 offset:16384
    ds_read_b128 a[96:99], v41 offset:16384
    ds_read_b64_tr_b16 v[76:77], v21 offset:0
    v_lshl_add_u32 v150, v147, 3, v146
    v_lshlrev_b32 v24, 6, v150
    v_lshl_add_u32 v24, v148, 5, v24
    v_mfma_f32_32x32x16_bf16 v[108:123], v[96:99], a[228:231], v[108:123]
    ds_read_b64_tr_b16 v[78:79], v21 offset:512
    ds_read_b128 a[244:247], v38 offset:17408
    ds_read_b128 a[100:103], v41 offset:17408
    v_lshl_add_u32 v24, v149, 3, v24
    v_and_b32 v151, 2, v146
    v_or_b32 v151, v151, v148
    v_mfma_f32_32x32x16_bf16 v[124:139], v[96:99], a[84:87], v[124:139]
    ds_read_b64_tr_b16 v[80:81], v21 offset:2048
    ds_read_b64_tr_b16 v[82:83], v21 offset:2560
    ds_read_b128 v[172:175], v2 offset:256
    s_add_u32 m0, s37, 110592
    s_add_u32 s40, s35, 2654208
    buffer_load_dwordx4 v9, s[8:11], s40 offen offset:0 lds
    v_mfma_f32_32x32x16_bf16 v[108:123], v[100:103], a[232:235], v[108:123]
    ds_read_b128 a[248:251], v38 offset:18432
    ds_read_b128 a[104:107], v41 offset:18432
    ds_read_b64_tr_b16 v[84:85], v21 offset:4096
    v_lshlrev_b32 v150, 4, v147
    v_mfma_f32_32x32x16_bf16 v[124:139], v[100:103], a[88:91], v[124:139]
    ds_read_b64_tr_b16 v[86:87], v21 offset:4608
    ds_read_b128 a[252:255], v37 offset:20480
    ds_read_b128 a[108:111], v40 offset:20480
    v_lshl_add_u32 v150, v148, 2, v150
    v_add_u32 v150, v150, v146
    v_lshlrev_b32 v150, 7, v150
    v_mfma_f32_32x32x16_bf16 v[108:123], v[104:107], a[236:239], v[108:123]
    ds_read_b64_tr_b16 v[88:89], v21 offset:6144
    ds_read_b64_tr_b16 v[90:91], v21 offset:6656
    ds_read_b128 v[176:179], v2 offset:288
    buffer_load_dwordx4 v10, s[8:11], s40 offen offset:1024 lds
    v_lshl_add_u32 v150, v149, 3, v150
    v_mfma_f32_32x32x16_bf16 v[124:139], v[104:107], a[92:95], v[124:139]
    ds_read_b128 v[224:227], v37 offset:21504
    ds_read_b128 a[112:115], v40 offset:21504
    ds_read_b64_tr_b16 v[92:93], v21 offset:8192
    v_lshl_add_u32 v150, v151, 5, v150
    s_lshl_b32 s39, s33, 6
    v_xor_b32 v27, s39, v150
    s_waitcnt lgkmcnt(13)
    v_mfma_f32_32x32x16_bf16 v[108:123], v[76:79], a[240:243], v[108:123]
    ds_read_b64_tr_b16 v[94:95], v21 offset:8704
    ds_read_b128 v[228:231], v37 offset:22528
    ds_read_b128 a[116:119], v40 offset:22528
    v_xor_b32 v30, 32, v27
    s_lshl_b32 s39, s51, 5
    v_mfma_f32_32x32x16_bf16 v[124:139], v[76:79], a[96:99], v[124:139]
    ds_read_b64_tr_b16 v[96:97], v21 offset:10240
    ds_read_b64_tr_b16 v[98:99], v21 offset:10752
    v_xor_b32 v33, s39, v150
    v_add_u32 v25, 0x10000, v24
    v_add_u32 v26, 0x20000, v24
    v_add_u32 v28, 0x10000, v27
    v_add_u32 v29, 0x20000, v27
    v_mfma_f32_32x32x16_bf16 v[108:123], v[80:83], a[244:247], v[108:123]
    buffer_load_dwordx4 v11, s[8:11], s40 offen offset:2048 lds
    v_add_u32 v31, 0x10000, v30
    v_add_u32 v32, 0x20000, v30
    v_add_u32 v34, 0x10000, v33
    v_add_u32 v35, 0x20000, v33
    v_mfma_f32_32x32x16_bf16 v[124:139], v[80:83], a[100:103], v[124:139]
    s_lshl_b32 s39, s28, 10
    s_add_u32 s39, s39, 86016
    v_add_u32 v44, s39, v1
    s_lshl_b32 s39, s34, 13
    v_add_u32 v42, s39, v44
    v_xor_b32 v43, 1024, v42
    v_add_u32 v44, 0x10000, v44
    s_waitcnt vmcnt(12) lgkmcnt(0)
    v_mfma_f32_32x32x16_bf16 v[108:123], v[84:87], a[248:251], v[108:123]
    s_barrier
    s_lshl_b32 s51, s34, 11
    v_mfma_f32_32x32x16_bf16 v[124:139], v[84:87], a[104:107], v[124:139]
    ds_read_b128 v[180:183], v2 offset:320
    ds_read_b128 v[232:235], v36 offset:36864
    ds_read_b128 a[120:123], v39 offset:36864
    s_xor_b32 s39, s28, 0
    s_mul_i32 s39, s39, 18432
    v_mfma_f32_32x32x16_bf16 v[108:123], v[88:91], a[252:255], v[108:123]
    ds_read_b64_tr_b16 v[100:101], v21 offset:49152
    ds_read_b64_tr_b16 v[102:103], v21 offset:49664
    ds_read_b128 v[236:239], v36 offset:37888
    v_lshlrev_b32 v58, 4, v0
    buffer_load_dword v7, v58, s[16:19], s24 offen sc1
    s_add_u32 s39, s39, s51
    v_mfma_f32_32x32x16_bf16 v[124:139], v[88:91], a[108:111], v[124:139]
    ds_read_b128 a[124:127], v39 offset:37888
    ds_read_b64_tr_b16 v[104:105], v21 offset:51200
    ds_read_b64_tr_b16 v[106:107], v21 offset:51712
    s_add_u32 m0, s37, 0
    s_add_u32 s40, s35, 3538944
    buffer_load_dwordx4 v9, s[8:11], s40 offen offset:0 lds
    v_mfma_f32_32x32x16_bf16 v[108:123], v[92:95], v[224:227], v[108:123]
    ds_read_b128 v[184:187], v2 offset:352
    ds_read_b128 v[240:243], v36 offset:38912
    ds_read_b128 a[128:131], v39 offset:38912
    v_add_u32 v45, s39, v1
    v_mfma_f32_32x32x16_bf16 v[124:139], v[92:95], a[112:115], v[124:139]
    ds_read_b64_tr_b16 v[76:77], v21 offset:53248
    ds_read_b64_tr_b16 v[78:79], v21 offset:53760
    ds_read_b128 v[244:247], v36 offset:12288
    s_xor_b32 s39, s28, 1
    s_mul_i32 s39, s39, 18432
    s_add_u32 s39, s39, s51
    v_mfma_f32_32x32x16_bf16 v[108:123], v[96:99], v[228:231], v[108:123]
    ds_read_b128 a[132:135], v39 offset:12288
    ds_read_b64_tr_b16 v[80:81], v21 offset:55296
    ds_read_b64_tr_b16 v[82:83], v21 offset:55808
    buffer_load_dwordx4 v10, s[8:11], s40 offen offset:1024 lds
    v_add_u32 v46, s39, v1
    v_mfma_f32_32x32x16_bf16 v[124:139], v[96:99], a[116:119], v[124:139]
    ds_read_b128 v[248:251], v36 offset:13312
    ds_read_b128 a[136:139], v39 offset:13312
    ds_read_b64_tr_b16 v[84:85], v21 offset:57344
    v_and_b32 v150, 15, v0
    v_lshlrev_b32 v150, 4, v150
    v_lshl_add_u32 v150, v148, 9, v150
    s_waitcnt lgkmcnt(12)
    v_mfma_f32_32x32x16_bf16 v[108:123], v[100:103], v[232:235], v[108:123]
    ds_read_b64_tr_b16 v[86:87], v21 offset:57856
    ds_read_b128 v[252:255], v36 offset:14336
    ds_read_b128 a[140:143], v39 offset:14336
    v_lshl_add_u32 v50, v147, 10, v150
    v_lshl_add_u32 v47, v147, 12, v150
    s_lshl_b32 s39, s32, 11
    v_mfma_f32_32x32x16_bf16 v[124:139], v[100:103], a[120:123], v[124:139]
    ds_read_b64_tr_b16 v[88:89], v21 offset:59392
    ds_read_b64_tr_b16 v[90:91], v21 offset:59904
    s_add_u32 s39, s39, 86016
    v_add_u32 v47, s39, v47
    v_add_u32 v48, 0x10000, v47
    v_mov_b32 v4, 0x3f3504f3
    v_mfma_f32_32x32x16_bf16 v[108:123], v[104:107], v[236:239], v[108:123]
    buffer_load_dwordx4 v11, s[8:11], s40 offen offset:2048 lds
    v_lshlrev_b32 v6, 8, v149
    v_lshrrev_b32 v59, 2, v1
    s_sub_u32 s5, 3, s28
    s_lshl_b32 s5, s5, 28
    s_lshl_b32 s101, s2, 8
    v_mfma_f32_32x32x16_bf16 v[124:139], v[104:107], a[124:127], v[124:139]
    s_add_u32 s101, s101, s5
    s_add_u32 s101, s101, 48963584
    s_lshl_b32 s4, s2, 4
    s_add_u32 s4, s4, s5
    s_add_u32 s4, s4, 48959488
    s_and_b32 s25, s2, 7
    s_waitcnt vmcnt(10) lgkmcnt(0)
    v_mfma_f32_32x32x16_bf16 v[108:123], v[76:79], v[240:243], v[108:123]
    s_barrier
    s_mul_i32 s25, s25, 663552
    v_mfma_f32_32x32x16_bf16 v[124:139], v[76:79], a[128:131], v[124:139]
    ds_read_b64_tr_b16 v[92:93], v21 offset:61440
    ds_read_b64_tr_b16 v[94:95], v21 offset:61952
    ds_read_b64_tr_b16 v[96:97], v21 offset:63488
    s_lshr_b32 s6, s2, 3
    s_mul_i32 s6, s6, 20736
    s_add_u32 s25, s25, s6
    s_add_u32 s25, s25, 2048
    v_mfma_f32_32x32x16_bf16 v[108:123], v[80:83], v[244:247], v[108:123]
    ds_read_b64_tr_b16 v[98:99], v21 offset:64000
    ds_read_b64_tr_b16 v[100:101], v22 offset:0
    s_add_u32 m0, s37, 12288
    s_add_u32 s40, s35, 4423680
    buffer_load_dwordx4 v9, s[8:11], s40 offen offset:0 lds
    v_mfma_f32_32x32x16_bf16 v[124:139], v[80:83], a[132:135], v[124:139]
    ds_read_b64_tr_b16 v[102:103], v22 offset:512
    buffer_load_dwordx4 v10, s[8:11], s40 offen offset:1024 lds
    v_bfe_u32 v5, v0, 4, 1
    v_lshlrev_b32 v5, 2, v5
    v_bfe_u32 v8, v0, 5, 1
    v_mfma_f32_32x32x16_bf16 v[108:123], v[84:87], v[248:251], v[108:123]
    ds_read_b64_tr_b16 v[104:105], v22 offset:2048
    v_lshl_or_b32 v5, v8, 1, v5
    v_and_b32 v8, 7, v0
    v_xor_b32 v5, v5, v8
    v_lshlrev_b32 v5, 4, v5
    v_bfe_u32 v8, v0, 3, 3
    v_mfma_f32_32x32x16_bf16 v[124:139], v[84:87], a[136:139], v[124:139]
    ds_read_b64_tr_b16 v[106:107], v22 offset:2560
    buffer_load_dwordx4 v11, s[8:11], s40 offen offset:2048 lds
    v_add_u32 v8, s100, v8
    v_mad_u32_u24 v41, v8, s62, v5
    v_mad_u32_u24 v36, v8, s97, v5
    v_mfma_f32_32x32x16_bf16 v[108:123], v[88:91], v[252:255], v[108:123]
    ds_read_b64_tr_b16 v[76:77], v22 offset:4096
    s_lshl_b32 s62, s62, 3
    s_lshl_b32 s97, s97, 3
    v_bfe_u32 v5, v0, 2, 4
    v_lshlrev_b32 v37, 7, v5
    v_and_b32 v8, 3, v0
    v_mfma_f32_32x32x16_bf16 v[124:139], v[88:91], a[140:143], v[124:139]
    ds_read_b64_tr_b16 v[78:79], v22 offset:4608
    s_waitcnt vmcnt(6)
    v_cmp_ne_u32 vcc, v220, v7
    s_nop 0
    s_cmp_eq_u64 vcc, -1
    s_cbranch_scc0 L2_gspin
L2_gok:
    v_lshl_add_u32 v37, v8, 3, v37
    v_and_b32 v8, 2, v5
    v_bfe_u32 v5, v5, 2, 1
    s_waitcnt lgkmcnt(6)
    v_mfma_f32_32x32x16_bf16 v[140:155], v[92:95], a[144:147], v[172:187]
    ds_read_b64_tr_b16 v[80:81], v22 offset:6144
    v_or_b32 v5, v5, v8
    v_xor_b32 v5, s60, v5
    v_lshl_add_u32 v37, v5, 5, v37
    v_add_u32 v37, s98, v37
    v_xor_b32 v38, 64, v37
    v_mfma_f32_32x32x16_bf16 v[156:171], v[92:95], a[0:3], v[172:187]
    ds_read_b64_tr_b16 v[82:83], v22 offset:6656
    v_and_b32 v5, 15, v0
    v_lshlrev_b32 v39, 7, v5
    v_bfe_u32 v8, v0, 4, 2
    v_lshl_add_u32 v39, v8, 3, v39
    v_and_b32 v8, 2, v0
    v_mfma_f32_32x32x16_bf16 v[140:155], v[96:99], a[148:151], v[140:155]
    ds_read_b64_tr_b16 v[84:85], v21 offset:24576
    s_add_u32 m0, s37, 36864
    s_add_u32 s35, s35, s36
    s_add_u32 s40, s35, 0
    buffer_load_dwordx4 v9, s[8:11], s40 offen offset:0 lds
    v_bfe_u32 v5, v0, 2, 1
    v_mfma_f32_32x32x16_bf16 v[156:171], v[96:99], a[4:7], v[156:171]
    s_branch L2_skip1
.p2align 12
L2_pad1:
    s_branch L2_ret1
    s_nop 0
L2_skip1:
    ds_read_b64_tr_b16 v[86:87], v21 offset:25088
    v_or_b32 v5, v5, v8
    v_xor_b32 v5, s60, v5
    v_lshl_add_u32 v39, v5, 5, v39
    v_add_u32 v39, s98, v39
    v_xor_b32 v40, 64, v39
    s_waitcnt lgkmcnt(6)
    v_mfma_f32_32x32x16_bf16 v[140:155], v[100:103], a[152:155], v[140:155]
    ds_read_b64_tr_b16 v[88:89], v21 offset:26624
    buffer_load_dwordx4 v10, s[8:11], s40 offen offset:1024 lds
    s_add_u32 s50, s41, 0
    v_exp_f32 v52, v108
    v_mfma_f32_32x32x16_bf16 v[156:171], v[100:103], a[8:11], v[156:171]
    ds_read_b64_tr_b16 v[90:91], v21 offset:27136
    v_exp_f32 v53, v109
    v_fma_f32 v52, v52, v4, v4
    v_fma_f32 v53, v53, v4, v4
    v_fma_f32 v52, v52, v52, 0.5
    v_fma_f32 v53, v53, v53, 0.5
    v_mfma_f32_32x32x16_bf16 v[140:155], v[104:107], a[156:159], v[140:155]
    ds_read_b64_tr_b16 v[92:93], v21 offset:28672
    buffer_load_dwordx4 v11, s[8:11], s40 offen offset:2048 lds
    v_rcp_f32 v52, v52
    v_rcp_f32 v53, v53
    v_mfma_f32_32x32x16_bf16 v[156:171], v[104:107], a[12:15], v[156:171]
    ds_read_b64_tr_b16 v[94:95], v21 offset:29184
    v_exp_f32 v54, v110
    v_exp_f32 v55, v111
    v_fma_f32 v52, -v108, v52, v108
    s_waitcnt lgkmcnt(6)
    v_mfma_f32_32x32x16_bf16 v[140:155], v[76:79], a[160:163], v[140:155]
    ds_read_b64_tr_b16 v[96:97], v21 offset:30720
    v_fma_f32 v53, -v109, v53, v109
    v_fma_f32 v54, v54, v4, v4
    v_fma_f32 v55, v55, v4, v4
    v_cvt_pk_bf16_f32 v60, v52, v53
    v_fma_f32 v54, v54, v54, 0.5
    v_fma_f32 v55, v55, v55, 0.5
    v_mfma_f32_32x32x16_bf16 v[156:171], v[76:79], a[16:19], v[156:171]
    ds_read_b64_tr_b16 v[98:99], v21 offset:31232
    s_add_u32 m0, s37, 49152
    s_add_u32 s40, s35, 884736
    buffer_load_dwordx4 v9, s[8:11], s40 offen offset:0 lds
    v_rcp_f32 v54, v54
    v_mfma_f32_32x32x16_bf16 v[140:155], v[80:83], a[164:167], v[140:155]
    ds_read_b64_tr_b16 v[100:101], v21 offset:32768
    v_rcp_f32 v55, v55
    v_exp_f32 v52, v112
    v_mfma_f32_32x32x16_bf16 v[156:171], v[80:83], a[20:23], v[156:171]
    ds_read_b64_tr_b16 v[102:103], v21 offset:33280
    buffer_load_dwordx4 v10, s[8:11], s40 offen offset:1024 lds
    v_exp_f32 v53, v113
    v_fma_f32 v54, -v110, v54, v110
    v_fma_f32 v55, -v111, v55, v111
    s_waitcnt lgkmcnt(6)
    v_mfma_f32_32x32x16_bf16 v[140:155], v[84:87], a[168:171], v[140:155]
    ds_read_b64_tr_b16 v[104:105], v21 offset:34816
    v_fma_f32 v52, v52, v4, v4
    v_fma_f32 v53, v53, v4, v4
    v_cvt_pk_bf16_f32 v61, v54, v55
    v_fma_f32 v52, v52, v52, 0.5
    v_fma_f32 v53, v53, v53, 0.5
    v_mfma_f32_32x32x16_bf16 v[156:171], v[84:87], a[24:27], v[156:171]
    ds_read_b64_tr_b16 v[106:107], v21 offset:35328
    v_rcp_f32 v52, v52
    v_rcp_f32 v53, v53
    v_exp_f32 v54, v114
    v_mfma_f32_32x32x16_bf16 v[140:155], v[88:91], a[172:175], v[140:155]
    buffer_load_dwordx4 v11, s[8:11], s40 offen offset:2048 lds
    v_exp_f32 v55, v115
    v_fma_f32 v52, -v112, v52, v112
    v_fma_f32 v53, -v113, v53, v113
    v_fma_f32 v54, v54, v4, v4
    v_mfma_f32_32x32x16_bf16 v[156:171], v[88:91], a[28:31], v[156:171]
    v_fma_f32 v55, v55, v4, v4
    v_cvt_pk_bf16_f32 v62, v52, v53
    v_fma_f32 v54, v54, v54, 0.5
    v_fma_f32 v55, v55, v55, 0.5
    v_rcp_f32 v54, v54
    s_waitcnt lgkmcnt(0)
    v_mfma_f32_32x32x16_bf16 v[140:155], v[92:95], a[176:179], v[140:155]
    s_barrier
    v_rcp_f32 v55, v55
    v_mfma_f32_32x32x16_bf16 v[156:171], v[92:95], a[32:35], v[156:171]
    ds_read_b64_tr_b16 v[76:77], v22 offset:8192
    ds_read_b64_tr_b16 v[78:79], v22 offset:8704
    s_mov_b64 exec, 1
    buffer_store_dword v221, v222, s[16:19], s24 offen sc1
    s_mov_b64 exec, -1
    v_exp_f32 v52, v116
    v_mfma_f32_32x32x16_bf16 v[140:155], v[96:99], a[180:183], v[140:155]
    ds_read_b64_tr_b16 v[80:81], v22 offset:10240
    ds_read_b64_tr_b16 v[82:83], v22 offset:10752
    s_add_u32 m0, s59, 0
    s_nop 0
    buffer_load_dwordx4 v41, s[16:19], s61 offen sc1 lds
    s_add_u32 s61, s61, s62
    v_exp_f32 v53, v117
    v_mfma_f32_32x32x16_bf16 v[156:171], v[96:99], a[36:39], v[156:171]
    ds_read_b64_tr_b16 v[84:85], v22 offset:12288
    ds_read_b64_tr_b16 v[86:87], v22 offset:12800
    v_fma_f32 v54, -v114, v54, v114
    v_fma_f32 v55, -v115, v55, v115
    v_fma_f32 v52, v52, v4, v4
    v_fma_f32 v53, v53, v4, v4
    v_cvt_pk_bf16_f32 v63, v54, v55
    v_mfma_f32_32x32x16_bf16 v[140:155], v[100:103], a[184:187], v[140:155]
    ds_read_b64_tr_b16 v[88:89], v22 offset:14336
    s_add_u32 m0, s59, 1024
    s_nop 0
    buffer_load_dwordx4 v41, s[16:19], s61 offen sc1 lds
    s_add_u32 s61, s61, s62
    v_fma_f32 v52, v52, v52, 0.5
    v_fma_f32 v53, v53, v53, 0.5
    v_mfma_f32_32x32x16_bf16 v[156:171], v[100:103], a[40:43], v[156:171]
    ds_read_b64_tr_b16 v[90:91], v22 offset:14848
    s_add_u32 m0, s59, 2048
    s_nop 0
    buffer_load_dwordx4 v41, s[16:19], s61 offen sc1 lds
    s_add_u32 s61, s61, s62
    ds_write_b128 v42, v[60:63] offset:0
    v_mfma_f32_32x32x16_bf16 v[140:155], v[104:107], a[188:191], v[140:155]
    ds_read_b64_tr_b16 v[92:93], v22 offset:16384
    v_rcp_f32 v52, v52
    v_rcp_f32 v53, v53
    v_mfma_f32_32x32x16_bf16 v[156:171], v[104:107], a[44:47], v[156:171]
    ds_read_b64_tr_b16 v[94:95], v22 offset:16896
    s_add_u32 m0, s59, 3072
    s_nop 0
    buffer_load_dwordx4 v41, s[16:19], s61 offen sc1 lds
    buffer_store_dwordx4 v[60:63], v45, s[16:19], s50 offen offset:0 sc1
    s_waitcnt lgkmcnt(7)
    v_mfma_f32_32x32x16_bf16 v[140:155], v[76:79], a[192:195], v[140:155]
    ds_read_b64_tr_b16 v[96:97], v22 offset:18432
    s_mov_b32 m0, s58
    s_nop 0
    buffer_load_dwordx4 v1, s[16:19], s99 offen offset:0 sc1 lds
    v_exp_f32 v54, v118
    v_mfma_f32_32x32x16_bf16 v[156:171], v[76:79], a[48:51], v[156:171]
    ds_read_b64_tr_b16 v[98:99], v22 offset:18944
    v_exp_f32 v55, v119
    v_fma_f32 v52, -v116, v52, v116
    v_fma_f32 v53, -v117, v53, v117
    v_fma_f32 v54, v54, v4, v4
    v_fma_f32 v55, v55, v4, v4
    v_mfma_f32_32x32x16_bf16 v[140:155], v[80:83], a[196:199], v[140:155]
    ds_read_b64_tr_b16 v[100:101], v22 offset:45056
    buffer_load_dwordx4 v1, s[16:19], s99 offen offset:1024 sc1 lds
    v_cvt_pk_bf16_f32 v64, v52, v53
    v_fma_f32 v54, v54, v54, 0.5
    v_fma_f32 v55, v55, v55, 0.5
    v_mfma_f32_32x32x16_bf16 v[156:171], v[80:83], a[52:55], v[156:171]
    ds_read_b64_tr_b16 v[102:103], v22 offset:45568
    buffer_load_dwordx4 v1, s[16:19], s99 offen offset:2048 sc1 lds
    v_rcp_f32 v54, v54
    v_rcp_f32 v55, v55
    s_waitcnt lgkmcnt(7)
    v_mfma_f32_32x32x16_bf16 v[140:155], v[84:87], a[200:203], v[140:155]
    ds_read_b64_tr_b16 v[104:105], v22 offset:47104
    v_exp_f32 v52, v120
    v_exp_f32 v53, v121
    v_fma_f32 v54, -v118, v54, v118
    v_fma_f32 v55, -v119, v55, v119
    v_mfma_f32_32x32x16_bf16 v[156:171], v[84:87], a[56:59], v[156:171]
    ds_read_b64_tr_b16 v[106:107], v22 offset:47616
    buffer_load_dwordx4 v1, s[16:19], s99 offen offset:3072 sc1 lds
    v_add_u32 v41, s59, v1
    v_add_u32 v5, s58, v1
    v_fma_f32 v52, v52, v4, v4
    v_fma_f32 v53, v53, v4, v4
    v_cvt_pk_bf16_f32 v65, v54, v55
    v_mfma_f32_32x32x16_bf16 v[140:155], v[88:91], a[204:207], v[140:155]
    ds_read_b64_tr_b16 v[76:77], v22 offset:49152
    s_add_u32 m0, s37, 24576
    s_add_u32 s40, s35, 1769472
    buffer_load_dwordx4 v9, s[8:11], s40 offen offset:0 lds
    v_fma_f32 v52, v52, v52, 0.5
    v_mfma_f32_32x32x16_bf16 v[156:171], v[88:91], a[60:63], v[156:171]
    ds_read_b64_tr_b16 v[78:79], v22 offset:49664
    v_fma_f32 v53, v53, v53, 0.5
    v_rcp_f32 v52, v52
    v_rcp_f32 v53, v53
    s_waitcnt lgkmcnt(6)
    v_mfma_f32_32x32x16_bf16 v[140:155], v[92:95], a[208:211], v[140:155]
    ds_read_b64_tr_b16 v[80:81], v22 offset:51200
    buffer_load_dwordx4 v10, s[8:11], s40 offen offset:1024 lds
    v_exp_f32 v54, v122
    v_exp_f32 v55, v123
    v_mfma_f32_32x32x16_bf16 v[156:171], v[92:95], a[64:67], v[156:171]
    ds_read_b64_tr_b16 v[82:83], v22 offset:51712
    buffer_load_dwordx4 v11, s[8:11], s40 offen offset:2048 lds
    v_fma_f32 v52, -v120, v52, v120
    v_fma_f32 v53, -v121, v53, v121
    v_fma_f32 v54, v54, v4, v4
    v_mfma_f32_32x32x16_bf16 v[140:155], v[96:99], a[212:215], v[140:155]
    ds_read_b64_tr_b16 v[84:85], v22 offset:53248
    v_fma_f32 v55, v55, v4, v4
    v_cvt_pk_bf16_f32 v66, v52, v53
    v_fma_f32 v54, v54, v54, 0.5
    v_fma_f32 v55, v55, v55, 0.5
    v_rcp_f32 v54, v54
    v_mfma_f32_32x32x16_bf16 v[156:171], v[96:99], a[68:71], v[156:171]
    ds_read_b64_tr_b16 v[86:87], v22 offset:53760
    s_add_u32 m0, s37, 61440
    s_add_u32 s40, s35, 2654208
    buffer_load_dwordx4 v9, s[8:11], s40 offen offset:0 lds
    v_rcp_f32 v55, v55
    s_waitcnt lgkmcnt(6)
    v_mfma_f32_32x32x16_bf16 v[140:155], v[100:103], a[216:219], v[140:155]
    ds_read_b64_tr_b16 v[88:89], v22 offset:55296
    buffer_load_dwordx4 v10, s[8:11], s40 offen offset:1024 lds
    v_exp_f32 v52, v124
    v_mfma_f32_32x32x16_bf16 v[156:171], v[100:103], a[72:75], v[156:171]
    ds_read_b64_tr_b16 v[90:91], v22 offset:55808
    v_exp_f32 v53, v125
    v_fma_f32 v54, -v122, v54, v122
    v_fma_f32 v55, -v123, v55, v123
    v_fma_f32 v52, v52, v4, v4
    v_fma_f32 v53, v53, v4, v4
    v_cvt_pk_bf16_f32 v67, v54, v55
    v_mfma_f32_32x32x16_bf16 v[140:155], v[104:107], a[220:223], v[140:155]
    buffer_load_dwordx4 v11, s[8:11], s40 offen offset:2048 lds
    v_fma_f32 v52, v52, v52, 0.5
    v_fma_f32 v53, v53, v53, 0.5
    v_mfma_f32_32x32x16_bf16 v[156:171], v[104:107], a[76:79], v[156:171]
    ds_write_b128 v42, v[64:67] offset:4096
    v_rcp_f32 v52, v52
    v_rcp_f32 v53, v53
    s_waitcnt vmcnt(22) lgkmcnt(1)
    v_mfma_f32_32x32x16_bf16 v[140:155], v[76:79], a[224:227], v[140:155]
    s_barrier
    v_mfma_f32_32x32x16_bf16 v[156:171], v[76:79], a[80:83], v[156:171]
    ds_read_b64_tr_b16 v[92:93], v21 offset:0
    ds_read_b64_tr_b16 v[94:95], v21 offset:512
    buffer_store_dwordx4 v[64:67], v45, s[16:19], s50 offen offset:1024 sc1
    v_mfma_f32_32x32x16_bf16 v[140:155], v[80:83], a[228:231], v[140:155]
    ds_read_b64_tr_b16 v[96:97], v21 offset:2048
    ds_read_b64_tr_b16 v[98:99], v21 offset:2560
    v_exp_f32 v54, v126
    v_exp_f32 v55, v127
    v_fma_f32 v52, -v124, v52, v124
    v_mfma_f32_32x32x16_bf16 v[156:171], v[80:83], a[84:87], v[156:171]
    ds_read_b64_tr_b16 v[100:101], v21 offset:4096
    ds_read_b64_tr_b16 v[102:103], v21 offset:4608
    v_fma_f32 v53, -v125, v53, v125
    v_fma_f32 v54, v54, v4, v4
    v_fma_f32 v55, v55, v4, v4
    v_cvt_pk_bf16_f32 v68, v52, v53
    v_fma_f32 v54, v54, v54, 0.5
    v_mfma_f32_32x32x16_bf16 v[140:155], v[84:87], a[232:235], v[140:155]
    ds_read_b64_tr_b16 v[104:105], v21 offset:6144
    s_add_u32 m0, s37, 73728
    s_add_u32 s40, s35, 3538944
    buffer_load_dwordx4 v9, s[8:11], s40 offen offset:0 lds
    v_fma_f32 v55, v55, v55, 0.5
    v_mfma_f32_32x32x16_bf16 v[156:171], v[84:87], a[88:91], v[156:171]
    ds_read_b64_tr_b16 v[106:107], v21 offset:6656
    v_rcp_f32 v54, v54
    v_rcp_f32 v55, v55
    v_exp_f32 v52, v128
    v_mfma_f32_32x32x16_bf16 v[140:155], v[88:91], a[236:239], v[140:155]
    ds_read_b64_tr_b16 v[76:77], v21 offset:8192
    v_exp_f32 v53, v129
    v_fma_f32 v54, -v126, v54, v126
    v_fma_f32 v55, -v127, v55, v127
    v_fma_f32 v52, v52, v4, v4
    v_mfma_f32_32x32x16_bf16 v[156:171], v[88:91], a[92:95], v[156:171]
    ds_read_b64_tr_b16 v[78:79], v21 offset:8704
    v_fma_f32 v53, v53, v4, v4
    v_cvt_pk_bf16_f32 v69, v54, v55
    v_fma_f32 v52, v52, v52, 0.5
    v_fma_f32 v53, v53, v53, 0.5
    v_rcp_f32 v52, v52
    s_waitcnt lgkmcnt(6)
    v_mfma_f32_32x32x16_bf16 v[140:155], v[92:95], a[240:243], v[140:155]
    ds_read_b64_tr_b16 v[80:81], v21 offset:10240
    buffer_load_dwordx4 v10, s[8:11], s40 offen offset:1024 lds
    v_rcp_f32 v53, v53
    v_exp_f32 v54, v130
    v_mfma_f32_32x32x16_bf16 v[156:171], v[92:95], a[96:99], v[156:171]
    ds_read_b64_tr_b16 v[82:83], v21 offset:10752
    v_exp_f32 v55, v131
    v_fma_f32 v52, -v128, v52, v128
    v_fma_f32 v53, -v129, v53, v129
    v_fma_f32 v54, v54, v4, v4
    v_mfma_f32_32x32x16_bf16 v[140:155], v[96:99], a[244:247], v[140:155]
    ds_read_b64_tr_b16 v[84:85], v21 offset:12288
    v_fma_f32 v55, v55, v4, v4
    v_cvt_pk_bf16_f32 v70, v52, v53
    v_fma_f32 v54, v54, v54, 0.5
    v_fma_f32 v55, v55, v55, 0.5
    v_rcp_f32 v54, v54
    v_mfma_f32_32x32x16_bf16 v[156:171], v[96:99], a[100:103], v[156:171]
    ds_read_b64_tr_b16 v[86:87], v21 offset:12800
    v_rcp_f32 v55, v55
    v_exp_f32 v52, v132
    v_exp_f32 v53, v133
    s_waitcnt lgkmcnt(6)
    v_mfma_f32_32x32x16_bf16 v[140:155], v[100:103], a[248:251], v[140:155]
    ds_read_b64_tr_b16 v[88:89], v21 offset:14336
    v_fma_f32 v54, -v130, v54, v130
    v_fma_f32 v55, -v131, v55, v131
    v_fma_f32 v52, v52, v4, v4
    v_fma_f32 v53, v53, v4, v4
    v_cvt_pk_bf16_f32 v71, v54, v55
    v_fma_f32 v52, v52, v52, 0.5
    v_mfma_f32_32x32x16_bf16 v[156:171], v[100:103], a[104:107], v[156:171]
    ds_read_b64_tr_b16 v[90:91], v21 offset:14848
    v_fma_f32 v53, v53, v53, 0.5
    ds_write_b128 v43, v[68:71] offset:0
    v_mfma_f32_32x32x16_bf16 v[140:155], v[104:107], a[252:255], v[140:155]
    ds_read_b64_tr_b16 v[92:93], v21 offset:16384
    v_rcp_f32 v52, v52
    v_rcp_f32 v53, v53
    v_mfma_f32_32x32x16_bf16 v[156:171], v[104:107], a[108:111], v[156:171]
    ds_read_b64_tr_b16 v[94:95], v21 offset:16896
    buffer_store_dwordx4 v[68:71], v46, s[16:19], s50 offen offset:0 sc1
    v_exp_f32 v54, v134
    s_waitcnt lgkmcnt(7)
    v_mfma_f32_32x32x16_bf16 v[140:155], v[76:79], v[224:227], v[140:155]
    ds_read_b64_tr_b16 v[96:97], v21 offset:18432
    v_exp_f32 v55, v135
    v_fma_f32 v52, -v132, v52, v132
    v_fma_f32 v53, -v133, v53, v133
    v_fma_f32 v54, v54, v4, v4
    v_fma_f32 v55, v55, v4, v4
    v_mfma_f32_32x32x16_bf16 v[156:171], v[76:79], a[112:115], v[156:171]
    ds_read_b64_tr_b16 v[98:99], v21 offset:18944
    v_cvt_pk_bf16_f32 v72, v52, v53
    v_fma_f32 v54, v54, v54, 0.5
    v_fma_f32 v55, v55, v55, 0.5
    v_rcp_f32 v54, v54
    v_mfma_f32_32x32x16_bf16 v[140:155], v[80:83], v[228:231], v[140:155]
    ds_read_b64_tr_b16 v[100:101], v21 offset:20480
    v_rcp_f32 v55, v55
    v_exp_f32 v52, v136
    v_exp_f32 v53, v137
    v_mfma_f32_32x32x16_bf16 v[156:171], v[80:83], a[116:119], v[156:171]
    ds_read_b64_tr_b16 v[102:103], v21 offset:20992
    v_fma_f32 v54, -v134, v54, v134
    v_fma_f32 v55, -v135, v55, v135
    v_fma_f32 v52, v52, v4, v4
    v_fma_f32 v53, v53, v4, v4
    v_cvt_pk_bf16_f32 v73, v54, v55
    v_fma_f32 v52, v52, v52, 0.5
    s_waitcnt lgkmcnt(7)
    v_mfma_f32_32x32x16_bf16 v[140:155], v[84:87], v[232:235], v[140:155]
    ds_read_b64_tr_b16 v[104:105], v21 offset:22528
    v_fma_f32 v53, v53, v53, 0.5
    v_rcp_f32 v52, v52
    v_rcp_f32 v53, v53
    v_mfma_f32_32x32x16_bf16 v[156:171], v[84:87], a[120:123], v[156:171]
    ds_read_b64_tr_b16 v[106:107], v21 offset:23040
    v_exp_f32 v54, v138
    v_exp_f32 v55, v139
    v_fma_f32 v52, -v136, v52, v136
    v_fma_f32 v53, -v137, v53, v137
    v_mfma_f32_32x32x16_bf16 v[140:155], v[88:91], v[236:239], v[140:155]
    buffer_load_dwordx4 v11, s[8:11], s40 offen offset:2048 lds
    v_fma_f32 v54, v54, v4, v4
    v_fma_f32 v55, v55, v4, v4
    v_cvt_pk_bf16_f32 v74, v52, v53
    v_fma_f32 v54, v54, v54, 0.5
    v_fma_f32 v55, v55, v55, 0.5
    v_mfma_f32_32x32x16_bf16 v[156:171], v[88:91], a[124:127], v[156:171]
    v_rcp_f32 v54, v54
    v_rcp_f32 v55, v55
    v_fma_f32 v54, -v138, v54, v138
    v_fma_f32 v55, -v139, v55, v139
    s_waitcnt vmcnt(11) lgkmcnt(0)
    v_mfma_f32_32x32x16_bf16 v[140:155], v[92:95], v[240:243], v[140:155]
    s_barrier
    v_cvt_pk_bf16_f32 v75, v54, v55
    v_mfma_f32_32x32x16_bf16 v[156:171], v[92:95], a[128:131], v[156:171]
    ds_read_b64_tr_b16 v[76:77], v21 offset:36864
    ds_read_b64_tr_b16 v[78:79], v21 offset:37376
    s_add_u32 m0, s37, 0
    s_add_u32 s40, s35, 4423680
    buffer_load_dwordx4 v9, s[8:11], s40 offen offset:0 lds
    v_mfma_f32_32x32x16_bf16 v[140:155], v[96:99], v[244:247], v[140:155]
    ds_read_b64_tr_b16 v[80:81], v21 offset:38912
    ds_read_b64_tr_b16 v[82:83], v21 offset:39424
    ds_write_b128 v43, v[72:75] offset:4096
    v_mfma_f32_32x32x16_bf16 v[156:171], v[96:99], a[132:135], v[156:171]
    ds_read_b64_tr_b16 v[84:85], v21 offset:40960
    ds_read_b64_tr_b16 v[86:87], v21 offset:41472
    buffer_store_dwordx4 v[72:75], v46, s[16:19], s50 offen offset:1024 sc1
    v_mfma_f32_32x32x16_bf16 v[140:155], v[100:103], v[248:251], v[140:155]
    ds_read_b64_tr_b16 v[88:89], v21 offset:43008
    buffer_load_dwordx4 v10, s[8:11], s40 offen offset:1024 lds
    ds_read_b64_tr_b16 v[172:173], v37 offset:0
    v_mfma_f32_32x32x16_bf16 v[156:171], v[100:103], a[136:139], v[156:171]
    ds_read_b64_tr_b16 v[90:91], v21 offset:43520
    ds_read_b64_tr_b16 v[180:181], v38 offset:0
    ds_read_b64_tr_b16 v[174:175], v37 offset:2048
    ds_read_b64_tr_b16 v[182:183], v38 offset:2048
    ds_read_b64_tr_b16 v[176:177], v37 offset:4096
    v_mfma_f32_32x32x16_bf16 v[140:155], v[104:107], v[252:255], v[140:155]
    ds_read_b64_tr_b16 v[92:93], v21 offset:45056
    ds_read_b64_tr_b16 v[184:185], v38 offset:4096
    ds_read_b64_tr_b16 v[178:179], v37 offset:6144
    ds_read_b64_tr_b16 v[186:187], v38 offset:6144
    v_mfma_f32_32x32x16_bf16 v[156:171], v[104:107], a[140:143], v[156:171]
    ds_read_b64_tr_b16 v[94:95], v21 offset:45568
    ds_read_b128 v[60:63], v5 offset:0
    ds_read_b128 v[64:67], v5 offset:1024
    ds_read_b128 v[68:71], v5 offset:2048
    ds_read_b128 v[72:75], v5 offset:3072
    s_mov_b32 s6, m0
    s_mov_b32 m0, 160896
    v_lshlrev_b32 v58, 4, v0
    buffer_load_dwordx4 v58, s[12:15], s25 offen lds
    s_add_u32 s25, s25, 4096
    buffer_load_dwordx4 v58, s[12:15], s25 offen lds
    s_add_u32 s25, s25, 4096
    buffer_load_dwordx4 v58, s[12:15], s25 offen lds
    s_add_u32 s25, s25, 4096
    buffer_load_dwordx4 v58, s[12:15], s25 offen lds
    s_add_u32 s25, s25, 4096
    buffer_load_dwordx4 v58, s[12:15], s25 offen lds
    s_add_u32 s25, s25, 4096
    v_and_b32 v58, 0xff, v58
    buffer_load_dwordx4 v58, s[12:15], s25 offen lds
    s_add_u32 s25, s25, 4096
    s_mov_b32 m0, s6
    s_waitcnt lgkmcnt(0)
    v_mfma_f32_16x16x32_bf16 v[108:111], v[188:191], v[172:175], 0
    v_xor_b32 v100, 0x80008000, v172
    v_xor_b32 v101, 0x80008000, v173
    v_xor_b32 v102, 0x80008000, v174
    v_mfma_f32_16x16x32_bf16 v[112:115], v[188:191], v[180:183], 0
    v_xor_b32 v103, 0x80008000, v175
    v_xor_b32 v104, 0x80008000, v176
    v_xor_b32 v105, 0x80008000, v177
    v_mfma_f32_16x16x32_bf16 v[108:111], v[192:195], v[176:179], v[108:111]
    v_xor_b32 v106, 0x80008000, v178
    v_xor_b32 v107, 0x80008000, v179
    v_mfma_f32_16x16x32_bf16 v[112:115], v[192:195], v[184:187], v[112:115]
    v_mfma_f32_16x16x32_bf16 v[108:111], v[204:207], v[180:183], v[108:111]
    v_mfma_f32_16x16x32_bf16 v[112:115], v[204:207], v[100:103], v[112:115]
    v_mfma_f32_16x16x32_bf16 v[108:111], v[208:211], v[184:187], v[108:111]
    v_mfma_f32_16x16x32_bf16 v[112:115], v[208:211], v[104:107], v[112:115]
    v_mfma_f32_16x16x32_bf16 v[116:119], v[196:199], v[172:175], 0
    v_mfma_f32_16x16x32_bf16 v[120:123], v[196:199], v[180:183], 0
    v_mfma_f32_16x16x32_bf16 v[116:119], v[200:203], v[176:179], v[116:119]
    v_mfma_f32_16x16x32_bf16 v[120:123], v[200:203], v[184:187], v[120:123]
    v_mfma_f32_16x16x32_bf16 v[116:119], v[212:215], v[180:183], v[116:119]
    v_mfma_f32_16x16x32_bf16 v[120:123], v[212:215], v[100:103], v[120:123]
    v_mfma_f32_16x16x32_bf16 v[116:119], v[216:219], v[184:187], v[116:119]
    v_mfma_f32_16x16x32_bf16 v[120:123], v[216:219], v[104:107], v[120:123]
    v_xor_b32 v172, 0x80000000, v172
    v_xor_b32 v173, 0x80000000, v173
    v_xor_b32 v174, 0x80000000, v174
    v_xor_b32 v175, 0x80000000, v175
    v_xor_b32 v176, 0x80000000, v176
    v_xor_b32 v177, 0x80000000, v177
    v_xor_b32 v178, 0x80000000, v178
    v_xor_b32 v179, 0x80000000, v179
    v_xor_b32 v180, 0x80000000, v180
    v_xor_b32 v181, 0x80000000, v181
    v_xor_b32 v182, 0x80000000, v182
    v_xor_b32 v183, 0x80000000, v183
    v_xor_b32 v184, 0x80000000, v184
    v_xor_b32 v185, 0x80000000, v185
    v_xor_b32 v186, 0x80000000, v186
    v_xor_b32 v187, 0x80000000, v187
    v_mfma_f32_16x16x32_bf16 v[124:127], v[188:191], v[172:175], 0
    v_xor_b32 v100, 0x80000000, v100
    v_xor_b32 v101, 0x80000000, v101
    v_xor_b32 v102, 0x80000000, v102
    v_mfma_f32_16x16x32_bf16 v[128:131], v[188:191], v[180:183], 0
    v_xor_b32 v103, 0x80000000, v103
    v_xor_b32 v104, 0x80000000, v104
    v_xor_b32 v105, 0x80000000, v105
    v_mfma_f32_16x16x32_bf16 v[124:127], v[192:195], v[176:179], v[124:127]
    v_xor_b32 v106, 0x80000000, v106
    v_xor_b32 v107, 0x80000000, v107
    v_lshlrev_b32 v52, 16, v60
    v_mfma_f32_16x16x32_bf16 v[128:131], v[192:195], v[184:187], v[128:131]
    v_and_b32 v53, 0xffff0000, v60
    v_mul_f32 v60, v108, v53
    v_mul_f32 v108, v108, v52
    v_mfma_f32_16x16x32_bf16 v[124:127], v[204:207], v[180:183], v[124:127]
    v_fma_f32 v108, -v112, v53, v108
    v_fma_f32 v112, v112, v52, v60
    v_lshlrev_b32 v54, 16, v61
    v_mfma_f32_16x16x32_bf16 v[128:131], v[204:207], v[100:103], v[128:131]
    v_and_b32 v55, 0xffff0000, v61
    v_mul_f32 v61, v109, v55
    v_mul_f32 v109, v109, v54
    v_mfma_f32_16x16x32_bf16 v[124:127], v[208:211], v[184:187], v[124:127]
    v_fma_f32 v109, -v113, v55, v109
    v_fma_f32 v113, v113, v54, v61
    v_lshlrev_b32 v52, 16, v62
    v_mfma_f32_16x16x32_bf16 v[128:131], v[208:211], v[104:107], v[128:131]
    v_and_b32 v53, 0xffff0000, v62
    v_mul_f32 v62, v110, v53
    v_mul_f32 v110, v110, v52
    v_mfma_f32_16x16x32_bf16 v[132:135], v[196:199], v[172:175], 0
    v_fma_f32 v110, -v114, v53, v110
    v_fma_f32 v114, v114, v52, v62
    v_lshlrev_b32 v54, 16, v63
    v_mfma_f32_16x16x32_bf16 v[136:139], v[196:199], v[180:183], 0
    v_and_b32 v55, 0xffff0000, v63
    v_mul_f32 v63, v111, v55
    v_mul_f32 v111, v111, v54
    v_mfma_f32_16x16x32_bf16 v[132:135], v[200:203], v[176:179], v[132:135]
    v_fma_f32 v111, -v115, v55, v111
    v_fma_f32 v115, v115, v54, v63
    v_lshlrev_b32 v52, 16, v64
    v_mfma_f32_16x16x32_bf16 v[136:139], v[200:203], v[184:187], v[136:139]
    v_and_b32 v53, 0xffff0000, v64
    v_mul_f32 v64, v116, v53
    v_mul_f32 v116, v116, v52
    v_mfma_f32_16x16x32_bf16 v[132:135], v[212:215], v[180:183], v[132:135]
    v_fma_f32 v116, -v120, v53, v116
    v_fma_f32 v120, v120, v52, v64
    v_lshlrev_b32 v54, 16, v65
    v_mfma_f32_16x16x32_bf16 v[136:139], v[212:215], v[100:103], v[136:139]
    v_and_b32 v55, 0xffff0000, v65
    v_mul_f32 v65, v117, v55
    v_mul_f32 v117, v117, v54
    v_mfma_f32_16x16x32_bf16 v[132:135], v[216:219], v[184:187], v[132:135]
    v_fma_f32 v117, -v121, v55, v117
    v_fma_f32 v121, v121, v54, v65
    v_lshlrev_b32 v52, 16, v66
    v_mfma_f32_16x16x32_bf16 v[136:139], v[216:219], v[104:107], v[136:139]
    v_and_b32 v53, 0xffff0000, v66
    v_mul_f32 v66, v118, v53
    v_mul_f32 v118, v118, v52
    v_fma_f32 v118, -v122, v53, v118
    v_fma_f32 v122, v122, v52, v66
    v_lshlrev_b32 v54, 16, v67
    v_and_b32 v55, 0xffff0000, v67
    v_mul_f32 v67, v119, v55
    v_mul_f32 v119, v119, v54
    v_fma_f32 v119, -v123, v55, v119
    v_fma_f32 v123, v123, v54, v67
    v_cvt_pk_bf16_f32 v60, v108, v109
    v_cvt_pk_bf16_f32 v64, v112, v113
    v_cvt_pk_bf16_f32 v61, v110, v111
    s_branch L2_skip2
.p2align 12
L2_pad2:
    s_branch L2_ret2
    s_nop 0
L2_skip2:
    v_cvt_pk_bf16_f32 v65, v114, v115
    v_cvt_pk_bf16_f32 v62, v116, v117
    v_cvt_pk_bf16_f32 v66, v120, v121
    v_cvt_pk_bf16_f32 v63, v118, v119
    v_cvt_pk_bf16_f32 v67, v122, v123
    v_xor_b32 v100, 0x80008000, v64
    v_xor_b32 v101, 0x80008000, v65
    v_xor_b32 v102, 0x80008000, v66
    v_xor_b32 v103, 0x80008000, v67
    v_mfma_f32_16x16x32_bf16 v[172:175], v[60:63], v[188:191], 0
    v_lshlrev_b32 v52, 16, v68
    v_and_b32 v53, 0xffff0000, v68
    v_mul_f32 v68, v124, v53
    v_mfma_f32_16x16x32_bf16 v[176:179], v[64:67], v[188:191], 0
    v_mul_f32 v124, v124, v52
    v_fma_f32 v124, -v128, v53, v124
    v_fma_f32 v128, v128, v52, v68
    v_mfma_f32_16x16x32_bf16 v[172:175], v[100:103], v[204:207], v[172:175]
    v_lshlrev_b32 v54, 16, v69
    v_and_b32 v55, 0xffff0000, v69
    v_mul_f32 v69, v125, v55
    v_mfma_f32_16x16x32_bf16 v[176:179], v[60:63], v[204:207], v[176:179]
    v_mul_f32 v125, v125, v54
    v_fma_f32 v125, -v129, v55, v125
    v_fma_f32 v129, v129, v54, v69
    v_mfma_f32_16x16x32_bf16 v[180:183], v[60:63], v[196:199], 0
    v_lshlrev_b32 v52, 16, v70
    v_and_b32 v53, 0xffff0000, v70
    v_mul_f32 v70, v126, v53
    v_mfma_f32_16x16x32_bf16 v[184:187], v[64:67], v[196:199], 0
    v_mul_f32 v126, v126, v52
    v_fma_f32 v126, -v130, v53, v126
    v_fma_f32 v130, v130, v52, v70
    v_mfma_f32_16x16x32_bf16 v[180:183], v[100:103], v[212:215], v[180:183]
    v_lshlrev_b32 v54, 16, v71
    v_and_b32 v55, 0xffff0000, v71
    v_mul_f32 v71, v127, v55
    v_mfma_f32_16x16x32_bf16 v[184:187], v[60:63], v[212:215], v[184:187]
    v_mul_f32 v127, v127, v54
    v_fma_f32 v127, -v131, v55, v127
    v_fma_f32 v131, v131, v54, v71
    v_xor_b32 v60, 0x80000000, v60
    v_xor_b32 v61, 0x80000000, v61
    v_xor_b32 v62, 0x80000000, v62
    v_xor_b32 v63, 0x80000000, v63
    v_xor_b32 v64, 0x80000000, v64
    v_xor_b32 v65, 0x80000000, v65
    v_xor_b32 v66, 0x80000000, v66
    v_xor_b32 v67, 0x80000000, v67
    v_xor_b32 v100, 0x80000000, v100
    v_xor_b32 v101, 0x80000000, v101
    v_xor_b32 v102, 0x80000000, v102
    v_xor_b32 v103, 0x80000000, v103
    v_mfma_f32_16x16x32_bf16 v[108:111], v[60:63], v[188:191], 0
    v_lshlrev_b32 v52, 16, v72
    v_and_b32 v53, 0xffff0000, v72
    v_mul_f32 v72, v132, v53
    v_mfma_f32_16x16x32_bf16 v[112:115], v[64:67], v[188:191], 0
    v_mul_f32 v132, v132, v52
    v_fma_f32 v132, -v136, v53, v132
    v_fma_f32 v136, v136, v52, v72
    v_mfma_f32_16x16x32_bf16 v[108:111], v[100:103], v[204:207], v[108:111]
    v_lshlrev_b32 v54, 16, v73
    v_and_b32 v55, 0xffff0000, v73
    v_mul_f32 v73, v133, v55
    v_mfma_f32_16x16x32_bf16 v[112:115], v[60:63], v[204:207], v[112:115]
    v_mul_f32 v133, v133, v54
    v_fma_f32 v133, -v137, v55, v133
    v_fma_f32 v137, v137, v54, v73
    v_mfma_f32_16x16x32_bf16 v[116:119], v[60:63], v[196:199], 0
    v_lshlrev_b32 v52, 16, v74
    v_and_b32 v53, 0xffff0000, v74
    v_mul_f32 v74, v134, v53
    v_mfma_f32_16x16x32_bf16 v[120:123], v[64:67], v[196:199], 0
    v_mul_f32 v134, v134, v52
    v_fma_f32 v134, -v138, v53, v134
    v_fma_f32 v138, v138, v52, v74
    v_mfma_f32_16x16x32_bf16 v[116:119], v[100:103], v[212:215], v[116:119]
    v_lshlrev_b32 v54, 16, v75
    v_and_b32 v55, 0xffff0000, v75
    v_mul_f32 v75, v135, v55
    v_mfma_f32_16x16x32_bf16 v[120:123], v[60:63], v[212:215], v[120:123]
    v_mul_f32 v135, v135, v54
    v_fma_f32 v135, -v139, v55, v135
    v_fma_f32 v139, v139, v54, v75
    v_cvt_pk_bf16_f32 v68, v124, v125
    v_cvt_pk_bf16_f32 v72, v128, v129
    v_cvt_pk_bf16_f32 v69, v126, v127
    v_cvt_pk_bf16_f32 v73, v130, v131
    v_cvt_pk_bf16_f32 v70, v132, v133
    v_cvt_pk_bf16_f32 v74, v136, v137
    v_cvt_pk_bf16_f32 v71, v134, v135
    v_cvt_pk_bf16_f32 v75, v138, v139
    v_xor_b32 v104, 0x80008000, v72
    v_xor_b32 v105, 0x80008000, v73
    v_xor_b32 v106, 0x80008000, v74
    v_xor_b32 v107, 0x80008000, v75
    v_mfma_f32_16x16x32_bf16 v[172:175], v[68:71], v[192:195], v[172:175]
    v_mfma_f32_16x16x32_bf16 v[176:179], v[72:75], v[192:195], v[176:179]
    v_mfma_f32_16x16x32_bf16 v[172:175], v[104:107], v[208:211], v[172:175]
    v_mfma_f32_16x16x32_bf16 v[176:179], v[68:71], v[208:211], v[176:179]
    v_mfma_f32_16x16x32_bf16 v[180:183], v[68:71], v[200:203], v[180:183]
    v_mfma_f32_16x16x32_bf16 v[184:187], v[72:75], v[200:203], v[184:187]
    v_mfma_f32_16x16x32_bf16 v[180:183], v[104:107], v[216:219], v[180:183]
    v_mfma_f32_16x16x32_bf16 v[184:187], v[68:71], v[216:219], v[184:187]
    v_xor_b32 v68, 0x80000000, v68
    v_xor_b32 v69, 0x80000000, v69
    v_xor_b32 v70, 0x80000000, v70
    v_xor_b32 v71, 0x80000000, v71
    v_xor_b32 v72, 0x80000000, v72
    v_xor_b32 v73, 0x80000000, v73
    v_xor_b32 v74, 0x80000000, v74
    v_xor_b32 v75, 0x80000000, v75
    v_xor_b32 v104, 0x80000000, v104
    v_xor_b32 v105, 0x80000000, v105
    v_xor_b32 v106, 0x80000000, v106
    v_xor_b32 v107, 0x80000000, v107
    v_mfma_f32_16x16x32_bf16 v[108:111], v[68:71], v[192:195], v[108:111]
    v_cvt_pk_bf16_f32 v124, v172, v173
    v_cvt_pk_bf16_f32 v125, v174, v175
    v_mfma_f32_16x16x32_bf16 v[112:115], v[72:75], v[192:195], v[112:115]
    ds_write_b64 v39, v[124:125] offset:0
    v_cvt_pk_bf16_f32 v126, v176, v177
    v_mfma_f32_16x16x32_bf16 v[108:111], v[104:107], v[208:211], v[108:111]
    v_cvt_pk_bf16_f32 v127, v178, v179
    ds_write_b64 v40, v[126:127] offset:0
    v_mfma_f32_16x16x32_bf16 v[112:115], v[68:71], v[208:211], v[112:115]
    v_cvt_pk_bf16_f32 v128, v180, v181
    v_cvt_pk_bf16_f32 v129, v182, v183
    v_mfma_f32_16x16x32_bf16 v[116:119], v[68:71], v[200:203], v[116:119]
    ds_write_b64 v39, v[128:129] offset:2048
    v_cvt_pk_bf16_f32 v130, v184, v185
    v_mfma_f32_16x16x32_bf16 v[120:123], v[72:75], v[200:203], v[120:123]
    v_cvt_pk_bf16_f32 v131, v186, v187
    ds_write_b64 v40, v[130:131] offset:2048
    v_mfma_f32_16x16x32_bf16 v[116:119], v[104:107], v[216:219], v[116:119]
    v_mfma_f32_16x16x32_bf16 v[120:123], v[68:71], v[216:219], v[120:123]
    ds_read_b128 v[172:175], v2 offset:512
    ds_read_b128 v[176:179], v2 offset:544
    ds_read_b128 v[180:183], v2 offset:576
    ds_read_b128 v[184:187], v2 offset:608
    v_cvt_pk_bf16_f32 v132, v108, v109
    v_cvt_pk_bf16_f32 v133, v110, v111
    ds_write_b64 v39, v[132:133] offset:4096
    v_cvt_pk_bf16_f32 v134, v112, v113
    v_cvt_pk_bf16_f32 v135, v114, v115
    ds_write_b64 v40, v[134:135] offset:4096
    v_cvt_pk_bf16_f32 v136, v116, v117
    v_cvt_pk_bf16_f32 v137, v118, v119
    ds_write_b64 v39, v[136:137] offset:6144
    v_cvt_pk_bf16_f32 v138, v120, v121
    v_cvt_pk_bf16_f32 v139, v122, v123
    ds_write_b64 v40, v[138:139] offset:6144
    s_waitcnt lgkmcnt(4)
    v_mfma_f32_32x32x16_bf16 v[188:203], v[76:79], a[144:147], v[172:187]
    ds_read_b64_tr_b16 v[96:97], v21 offset:47104
    buffer_load_dwordx4 v11, s[8:11], s40 offen offset:2048 lds
    s_add_u32 s50, s41, 4096
    v_exp_f32 v52, v140
    v_mfma_f32_32x32x16_bf16 v[204:219], v[76:79], a[0:3], v[172:187]
    ds_read_b64_tr_b16 v[98:99], v21 offset:47616
    v_exp_f32 v53, v141
    v_fma_f32 v52, v52, v4, v4
    v_fma_f32 v53, v53, v4, v4
    v_fma_f32 v52, v52, v52, 0.5
    v_mfma_f32_32x32x16_bf16 v[188:203], v[80:83], a[148:151], v[188:203]
    ds_read_b64_tr_b16 v[100:101], v21 offset:49152
    v_fma_f32 v53, v53, v53, 0.5
    v_rcp_f32 v52, v52
    v_rcp_f32 v53, v53
    v_mfma_f32_32x32x16_bf16 v[204:219], v[80:83], a[4:7], v[204:219]
    ds_read_b64_tr_b16 v[102:103], v21 offset:49664
    v_exp_f32 v54, v142
    v_exp_f32 v55, v143
    v_fma_f32 v52, -v140, v52, v140
    v_fma_f32 v53, -v141, v53, v141
    v_mfma_f32_32x32x16_bf16 v[188:203], v[84:87], a[152:155], v[188:203]
    ds_read_b64_tr_b16 v[104:105], v21 offset:51200
    s_add_u32 m0, s37, 12288
    s_add_u32 s35, s35, s36
    s_add_u32 s40, s35, 0
    buffer_load_dwordx4 v9, s[8:11], s40 offen offset:0 lds
    v_mfma_f32_32x32x16_bf16 v[204:219], v[84:87], a[8:11], v[204:219]
    ds_read_b64_tr_b16 v[106:107], v21 offset:51712
    v_fma_f32 v54, v54, v4, v4
    v_fma_f32 v55, v55, v4, v4
    v_cvt_pk_bf16_f32 v60, v52, v53
    v_fma_f32 v54, v54, v54, 0.5
    v_fma_f32 v55, v55, v55, 0.5
    v_mfma_f32_32x32x16_bf16 v[188:203], v[88:91], a[156:159], v[188:203]
    ds_read_b64_tr_b16 v[76:77], v21 offset:53248
    v_rcp_f32 v54, v54
    v_rcp_f32 v55, v55
    v_exp_f32 v52, v144
    v_mfma_f32_32x32x16_bf16 v[204:219], v[88:91], a[12:15], v[204:219]
    ds_read_b64_tr_b16 v[78:79], v21 offset:53760
    v_exp_f32 v53, v145
    v_fma_f32 v54, -v142, v54, v142
    v_fma_f32 v55, -v143, v55, v143
    v_fma_f32 v52, v52, v4, v4
    v_mfma_f32_32x32x16_bf16 v[188:203], v[92:95], a[160:163], v[188:203]
    ds_read_b64_tr_b16 v[80:81], v21 offset:55296
    buffer_load_dwordx4 v10, s[8:11], s40 offen offset:1024 lds
    v_fma_f32 v53, v53, v4, v4
    v_cvt_pk_bf16_f32 v61, v54, v55
    v_fma_f32 v52, v52, v52, 0.5
    v_mfma_f32_32x32x16_bf16 v[204:219], v[92:95], a[16:19], v[204:219]
    ds_read_b64_tr_b16 v[82:83], v21 offset:55808
    v_fma_f32 v53, v53, v53, 0.5
    v_rcp_f32 v52, v52
    v_rcp_f32 v53, v53
    s_waitcnt lgkmcnt(6)
    v_mfma_f32_32x32x16_bf16 v[188:203], v[96:99], a[164:167], v[188:203]
    ds_read_b64_tr_b16 v[84:85], v21 offset:57344
    v_exp_f32 v54, v146
    v_exp_f32 v55, v147
    v_fma_f32 v52, -v144, v52, v144
    v_fma_f32 v53, -v145, v53, v145
    v_mfma_f32_32x32x16_bf16 v[204:219], v[96:99], a[20:23], v[204:219]
    ds_read_b64_tr_b16 v[86:87], v21 offset:57856
    v_fma_f32 v54, v54, v4, v4
    v_fma_f32 v55, v55, v4, v4
    v_cvt_pk_bf16_f32 v62, v52, v53
    v_fma_f32 v54, v54, v54, 0.5
    v_fma_f32 v55, v55, v55, 0.5
    v_mfma_f32_32x32x16_bf16 v[188:203], v[100:103], a[168:171], v[188:203]
    ds_read_b64_tr_b16 v[88:89], v21 offset:59392
    v_rcp_f32 v54, v54
    v_rcp_f32 v55, v55
    v_exp_f32 v52, v148
    v_mfma_f32_32x32x16_bf16 v[204:219], v[100:103], a[24:27], v[204:219]
    ds_read_b64_tr_b16 v[90:91], v21 offset:59904
    v_exp_f32 v53, v149
    v_fma_f32 v54, -v146, v54, v146
    v_fma_f32 v55, -v147, v55, v147
    s_waitcnt lgkmcnt(6)
    v_mfma_f32_32x32x16_bf16 v[188:203], v[104:107], a[172:175], v[188:203]
    buffer_load_dwordx4 v11, s[8:11], s40 offen offset:2048 lds
    v_fma_f32 v52, v52, v4, v4
    v_fma_f32 v53, v53, v4, v4
    v_cvt_pk_bf16_f32 v63, v54, v55
    v_fma_f32 v52, v52, v52, 0.5
    v_mfma_f32_32x32x16_bf16 v[204:219], v[104:107], a[28:31], v[204:219]
    v_fma_f32 v53, v53, v53, 0.5
    ds_write_b128 v42, v[60:63] offset:16384
    v_rcp_f32 v52, v52
    v_mfma_f32_32x32x16_bf16 v[188:203], v[76:79], a[176:179], v[188:203]
    s_waitcnt vmcnt(18) lgkmcnt(1)
    s_barrier
    v_mfma_f32_32x32x16_bf16 v[204:219], v[76:79], a[32:35], v[204:219]
    ds_read_b64_tr_b16 v[92:93], v21 offset:24576
    ds_read_b64_tr_b16 v[94:95], v21 offset:25088
    ds_read_b128 v[108:111], v41 offset:0
    ds_read_b128 v[112:115], v41 offset:1024
    ds_read_b128 v[116:119], v41 offset:2048
    ds_read_b128 v[120:123], v41 offset:3072
    v_rcp_f32 v53, v53
    v_mfma_f32_32x32x16_bf16 v[188:203], v[80:83], a[180:183], v[188:203]
    ds_read_b64_tr_b16 v[96:97], v21 offset:26624
    ds_read_b64_tr_b16 v[98:99], v21 offset:27136
    buffer_store_dwordx4 v[60:63], v45, s[16:19], s50 offen offset:0 sc1
    v_mfma_f32_32x32x16_bf16 v[204:219], v[80:83], a[36:39], v[204:219]
    ds_read_b64_tr_b16 v[100:101], v21 offset:28672
    ds_read_b64_tr_b16 v[102:103], v21 offset:29184
    v_exp_f32 v54, v150
    v_mfma_f32_32x32x16_bf16 v[188:203], v[84:87], a[184:187], v[188:203]
    ds_read_b64_tr_b16 v[104:105], v21 offset:30720
    s_add_u32 m0, s37, 36864
    s_add_u32 s40, s35, 884736
    buffer_load_dwordx4 v9, s[8:11], s40 offen offset:0 lds
    v_mfma_f32_32x32x16_bf16 v[204:219], v[84:87], a[40:43], v[204:219]
    ds_read_b64_tr_b16 v[106:107], v21 offset:31232
    v_exp_f32 v55, v151
    v_fma_f32 v52, -v148, v52, v148
    v_fma_f32 v53, -v149, v53, v149
    v_fma_f32 v54, v54, v4, v4
    v_fma_f32 v55, v55, v4, v4
    v_mfma_f32_32x32x16_bf16 v[188:203], v[88:91], a[188:191], v[188:203]
    ds_read_b64_tr_b16 v[76:77], v21 offset:32768
    buffer_load_dwordx4 v10, s[8:11], s40 offen offset:1024 lds
    v_cvt_pk_bf16_f32 v64, v52, v53
    v_fma_f32 v54, v54, v54, 0.5
    v_fma_f32 v55, v55, v55, 0.5
    v_mfma_f32_32x32x16_bf16 v[204:219], v[88:91], a[44:47], v[204:219]
    ds_read_b64_tr_b16 v[78:79], v21 offset:33280
    v_rcp_f32 v54, v54
    v_rcp_f32 v55, v55
    v_exp_f32 v52, v152
    s_waitcnt lgkmcnt(6)
    v_mfma_f32_32x32x16_bf16 v[188:203], v[92:95], a[192:195], v[188:203]
    ds_read_b64_tr_b16 v[80:81], v21 offset:34816
    buffer_load_dwordx4 v11, s[8:11], s40 offen offset:2048 lds
    v_exp_f32 v53, v153
    v_mfma_f32_32x32x16_bf16 v[204:219], v[92:95], a[48:51], v[204:219]
    ds_read_b64_tr_b16 v[82:83], v21 offset:35328
    v_fma_f32 v54, -v150, v54, v150
    v_fma_f32 v55, -v151, v55, v151
    v_fma_f32 v52, v52, v4, v4
    v_fma_f32 v53, v53, v4, v4
    v_cvt_pk_bf16_f32 v65, v54, v55
    v_mfma_f32_32x32x16_bf16 v[188:203], v[96:99], a[196:199], v[188:203]
    ds_read_b64_tr_b16 v[84:85], v21 offset:61440
    v_fma_f32 v52, v52, v52, 0.5
    v_fma_f32 v53, v53, v53, 0.5
    v_rcp_f32 v52, v52
    v_rcp_f32 v53, v53
    v_mfma_f32_32x32x16_bf16 v[204:219], v[96:99], a[52:55], v[204:219]
    ds_read_b64_tr_b16 v[86:87], v21 offset:61952
    buffer_store_dwordx4 v[108:111], v36, s[16:19], s96 offen sc1
    s_add_u32 s96, s96, s97
    v_exp_f32 v54, v154
    s_waitcnt lgkmcnt(6)
    v_mfma_f32_32x32x16_bf16 v[188:203], v[100:103], a[200:203], v[188:203]
    ds_read_b64_tr_b16 v[88:89], v21 offset:63488
    v_exp_f32 v55, v155
    v_fma_f32 v52, -v152, v52, v152
    v_fma_f32 v53, -v153, v53, v153
    v_fma_f32 v54, v54, v4, v4
    v_fma_f32 v55, v55, v4, v4
    v_mfma_f32_32x32x16_bf16 v[204:219], v[100:103], a[56:59], v[204:219]
    ds_read_b64_tr_b16 v[90:91], v21 offset:64000
    s_add_u32 m0, s37, 49152
    s_add_u32 s40, s35, 1769472
    buffer_load_dwordx4 v9, s[8:11], s40 offen offset:0 lds
    v_cvt_pk_bf16_f32 v66, v52, v53
    v_mfma_f32_32x32x16_bf16 v[188:203], v[104:107], a[204:207], v[188:203]
    ds_read_b64_tr_b16 v[92:93], v22 offset:0
    v_fma_f32 v54, v54, v54, 0.5
    v_fma_f32 v55, v55, v55, 0.5
    v_rcp_f32 v54, v54
    v_mfma_f32_32x32x16_bf16 v[204:219], v[104:107], a[60:63], v[204:219]
    ds_read_b64_tr_b16 v[94:95], v22 offset:512
    v_rcp_f32 v55, v55
    v_exp_f32 v52, v156
    v_exp_f32 v53, v157
    s_waitcnt lgkmcnt(6)
    v_mfma_f32_32x32x16_bf16 v[188:203], v[76:79], a[208:211], v[188:203]
    ds_read_b64_tr_b16 v[96:97], v22 offset:2048
    buffer_load_dwordx4 v10, s[8:11], s40 offen offset:1024 lds
    v_fma_f32 v54, -v154, v54, v154
    v_fma_f32 v55, -v155, v55, v155
    v_fma_f32 v52, v52, v4, v4
    v_mfma_f32_32x32x16_bf16 v[204:219], v[76:79], a[64:67], v[204:219]
    ds_read_b64_tr_b16 v[98:99], v22 offset:2560
    v_fma_f32 v53, v53, v4, v4
    v_cvt_pk_bf16_f32 v67, v54, v55
    v_fma_f32 v52, v52, v52, 0.5
    v_fma_f32 v53, v53, v53, 0.5
    v_mfma_f32_32x32x16_bf16 v[188:203], v[80:83], a[212:215], v[188:203]
    ds_read_b64_tr_b16 v[100:101], v22 offset:4096
    buffer_load_dwordx4 v11, s[8:11], s40 offen offset:2048 lds
    ds_write_b128 v42, v[64:67] offset:20480
    v_mfma_f32_32x32x16_bf16 v[204:219], v[80:83], a[68:71], v[204:219]
    ds_read_b64_tr_b16 v[102:103], v22 offset:4608
    v_rcp_f32 v52, v52
    v_rcp_f32 v53, v53
    s_waitcnt lgkmcnt(7)
    v_mfma_f32_32x32x16_bf16 v[188:203], v[84:87], a[216:219], v[188:203]
    ds_read_b64_tr_b16 v[104:105], v22 offset:6144
    buffer_store_dwordx4 v[64:67], v45, s[16:19], s50 offen offset:1024 sc1
    v_mfma_f32_32x32x16_bf16 v[204:219], v[84:87], a[72:75], v[204:219]
    ds_read_b64_tr_b16 v[106:107], v22 offset:6656
    v_exp_f32 v54, v158
    v_exp_f32 v55, v159
    v_fma_f32 v52, -v156, v52, v156
    v_fma_f32 v53, -v157, v53, v157
    v_mfma_f32_32x32x16_bf16 v[188:203], v[88:91], a[220:223], v[188:203]
    buffer_store_dwordx4 v[112:115], v36, s[16:19], s96 offen sc1
    s_add_u32 s96, s96, s97
    v_fma_f32 v54, v54, v4, v4
    v_fma_f32 v55, v55, v4, v4
    v_cvt_pk_bf16_f32 v68, v52, v53
    v_fma_f32 v54, v54, v54, 0.5
    v_mfma_f32_32x32x16_bf16 v[204:219], v[88:91], a[76:79], v[204:219]
    v_fma_f32 v55, v55, v55, 0.5
    v_rcp_f32 v54, v54
    v_rcp_f32 v55, v55
    s_waitcnt vmcnt(13) lgkmcnt(0)
    v_mfma_f32_32x32x16_bf16 v[188:203], v[92:95], a[224:227], v[188:203]
    s_barrier
    v_exp_f32 v52, v160
    v_mfma_f32_32x32x16_bf16 v[204:219], v[92:95], a[80:83], v[204:219]
    ds_read_b64_tr_b16 v[76:77], v22 offset:8192
    ds_read_b64_tr_b16 v[78:79], v22 offset:8704
    s_add_u32 m0, s37, 135168
    s_add_u32 s40, s35, 2654208
    buffer_load_dwordx4 v9, s[8:11], s40 offen offset:0 lds
    v_mfma_f32_32x32x16_bf16 v[188:203], v[96:99], a[228:231], v[188:203]
    ds_read_b64_tr_b16 v[80:81], v22 offset:10240
    ds_read_b64_tr_b16 v[82:83], v22 offset:10752
    v_exp_f32 v53, v161
    v_fma_f32 v54, -v158, v54, v158
    v_mfma_f32_32x32x16_bf16 v[204:219], v[96:99], a[84:87], v[204:219]
    ds_read_b128 v[172:175], v2 offset:768
    ds_read_b64_tr_b16 v[84:85], v22 offset:12288
    v_fma_f32 v55, -v159, v55, v159
    v_fma_f32 v52, v52, v4, v4
    v_fma_f32 v53, v53, v4, v4
    v_cvt_pk_bf16_f32 v69, v54, v55
    v_mfma_f32_32x32x16_bf16 v[188:203], v[100:103], a[232:235], v[188:203]
    ds_read_b64_tr_b16 v[86:87], v22 offset:12800
    ds_read_b64_tr_b16 v[88:89], v22 offset:14336
    buffer_load_dwordx4 v10, s[8:11], s40 offen offset:1024 lds
    v_fma_f32 v52, v52, v52, 0.5
    v_fma_f32 v53, v53, v53, 0.5
    v_mfma_f32_32x32x16_bf16 v[204:219], v[100:103], a[88:91], v[204:219]
    ds_read_b64_tr_b16 v[90:91], v22 offset:14848
    buffer_load_dwordx4 v11, s[8:11], s40 offen offset:2048 lds
    v_rcp_f32 v52, v52
    v_mfma_f32_32x32x16_bf16 v[188:203], v[104:107], a[236:239], v[188:203]
    ds_read_b128 v[176:179], v2 offset:800
    ds_read_b64_tr_b16 v[92:93], v22 offset:16384
    v_rcp_f32 v53, v53
    v_exp_f32 v54, v162
    v_mfma_f32_32x32x16_bf16 v[204:219], v[104:107], a[92:95], v[204:219]
    ds_read_b64_tr_b16 v[94:95], v22 offset:16896
    buffer_store_dwordx4 v[116:119], v36, s[16:19], s96 offen sc1
    s_add_u32 s96, s96, s97
    v_exp_f32 v55, v163
    v_fma_f32 v52, -v160, v52, v160
    s_waitcnt lgkmcnt(8)
    v_mfma_f32_32x32x16_bf16 v[188:203], v[76:79], a[240:243], v[188:203]
    ds_read_b64_tr_b16 v[96:97], v22 offset:18432
    v_fma_f32 v53, -v161, v53, v161
    v_fma_f32 v54, v54, v4, v4
    v_fma_f32 v55, v55, v4, v4
    v_cvt_pk_bf16_f32 v70, v52, v53
    v_fma_f32 v54, v54, v54, 0.5
    v_mfma_f32_32x32x16_bf16 v[204:219], v[76:79], a[96:99], v[204:219]
    ds_read_b64_tr_b16 v[98:99], v22 offset:18944
    s_add_u32 m0, s37, 147456
    s_add_u32 s40, s35, 3538944
    buffer_load_dwordx4 v9, s[8:11], s40 offen offset:0 lds
    v_fma_f32 v55, v55, v55, 0.5
    v_mfma_f32_32x32x16_bf16 v[188:203], v[80:83], a[244:247], v[188:203]
    ds_read_b128 v[180:183], v2 offset:832
    ds_read_b64_tr_b16 v[100:101], v21 offset:0
    v_rcp_f32 v54, v54
    v_rcp_f32 v55, v55
    v_mfma_f32_32x32x16_bf16 v[204:219], v[80:83], a[100:103], v[204:219]
    ds_read_b64_tr_b16 v[102:103], v21 offset:512
    buffer_load_dwordx4 v10, s[8:11], s40 offen offset:1024 lds
    v_exp_f32 v52, v164
    s_waitcnt lgkmcnt(8)
    v_mfma_f32_32x32x16_bf16 v[188:203], v[84:87], a[248:251], v[188:203]
    ds_read_b64_tr_b16 v[104:105], v21 offset:2048
    v_exp_f32 v53, v165
    v_fma_f32 v54, -v162, v54, v162
    v_fma_f32 v55, -v163, v55, v163
    v_fma_f32 v52, v52, v4, v4
    v_fma_f32 v53, v53, v4, v4
    v_mfma_f32_32x32x16_bf16 v[204:219], v[84:87], a[104:107], v[204:219]
    ds_read_b64_tr_b16 v[106:107], v21 offset:2560
    buffer_load_dwordx4 v11, s[8:11], s40 offen offset:2048 lds
    v_cvt_pk_bf16_f32 v71, v54, v55
    v_fma_f32 v52, v52, v52, 0.5
    v_fma_f32 v53, v53, v53, 0.5
    v_mfma_f32_32x32x16_bf16 v[188:203], v[88:91], a[252:255], v[188:203]
    ds_read_b128 v[184:187], v2 offset:864
    ds_read_b64_tr_b16 v[76:77], v21 offset:4096
    ds_write_b128 v43, v[68:71] offset:16384
    v_mfma_f32_32x32x16_bf16 v[204:219], v[88:91], a[108:111], v[204:219]
    ds_read_b64_tr_b16 v[78:79], v21 offset:4608
    s_add_u32 m0, s37, 24576
    s_add_u32 s40, s35, 4423680
    buffer_load_dwordx4 v9, s[8:11], s40 offen offset:0 lds
    s_waitcnt lgkmcnt(9)
    v_mfma_f32_32x32x16_bf16 v[188:203], v[92:95], v[224:227], v[188:203]
    ds_read_b64_tr_b16 v[80:81], v21 offset:6144
    v_rcp_f32 v52, v52
    v_rcp_f32 v53, v53
    v_mfma_f32_32x32x16_bf16 v[204:219], v[92:95], a[112:115], v[204:219]
    ds_read_b64_tr_b16 v[82:83], v21 offset:6656
    buffer_load_dwordx4 v10, s[8:11], s40 offen offset:1024 lds
    buffer_store_dwordx4 v[68:71], v46, s[16:19], s50 offen offset:0 sc1
    v_mfma_f32_32x32x16_bf16 v[188:203], v[96:99], v[228:231], v[188:203]
    ds_read_b64_tr_b16 v[84:85], v21 offset:8192
    v_exp_f32 v54, v166
    v_exp_f32 v55, v167
    v_mfma_f32_32x32x16_bf16 v[204:219], v[96:99], a[116:119], v[204:219]
    ds_read_b64_tr_b16 v[86:87], v21 offset:8704
    buffer_load_dwordx4 v11, s[8:11], s40 offen offset:2048 lds
    v_fma_f32 v52, -v164, v52, v164
    v_fma_f32 v53, -v165, v53, v165
    v_fma_f32 v54, v54, v4, v4
    s_waitcnt lgkmcnt(8)
    v_mfma_f32_32x32x16_bf16 v[188:203], v[100:103], v[232:235], v[188:203]
    ds_read_b64_tr_b16 v[88:89], v21 offset:10240
    v_fma_f32 v55, v55, v4, v4
    v_cvt_pk_bf16_f32 v72, v52, v53
    v_fma_f32 v54, v54, v54, 0.5
    v_fma_f32 v55, v55, v55, 0.5
    v_mfma_f32_32x32x16_bf16 v[204:219], v[100:103], a[120:123], v[204:219]
    ds_read_b64_tr_b16 v[90:91], v21 offset:10752
    v_rcp_f32 v54, v54
    v_rcp_f32 v55, v55
    v_exp_f32 v52, v168
    v_mfma_f32_32x32x16_bf16 v[188:203], v[104:107], v[236:239], v[188:203]
    buffer_store_dwordx4 v[120:123], v36, s[16:19], s96 offen sc1
    v_exp_f32 v53, v169
    v_fma_f32 v54, -v166, v54, v166
    v_fma_f32 v55, -v167, v55, v167
    v_mfma_f32_32x32x16_bf16 v[204:219], v[104:107], a[124:127], v[204:219]
    v_fma_f32 v52, v52, v4, v4
    v_fma_f32 v53, v53, v4, v4
    v_cvt_pk_bf16_f32 v73, v54, v55
    v_fma_f32 v52, v52, v52, 0.5
    v_fma_f32 v53, v53, v53, 0.5
    v_rcp_f32 v52, v52
    s_waitcnt vmcnt(18) lgkmcnt(0)
    v_mfma_f32_32x32x16_bf16 v[188:203], v[76:79], v[240:243], v[188:203]
    s_barrier
    v_mfma_f32_32x32x16_bf16 v[204:219], v[76:79], a[128:131], v[204:219]
    ds_read_b64_tr_b16 v[92:93], v21 offset:12288
    ds_read_b64_tr_b16 v[94:95], v21 offset:12800
    s_add_u32 m0, s37, 0
    s_add_u32 s35, s35, s36
    s_add_u32 s40, s35, 0
    buffer_load_dwordx4 v12, s[8:11], s40 offen offset:0 lds
    v_mfma_f32_32x32x16_bf16 v[188:203], v[80:83], v[244:247], v[188:203]
    ds_read_b64_tr_b16 v[96:97], v21 offset:14336
    ds_read_b64_tr_b16 v[98:99], v21 offset:14848
    v_rcp_f32 v53, v53
    v_exp_f32 v54, v170
    v_mfma_f32_32x32x16_bf16 v[204:219], v[80:83], a[132:135], v[204:219]
    s_branch L2_skip3
.p2align 12
L2_pad3:
    s_branch L2_ret3
    s_nop 0
L2_skip3:
    ds_read_b64_tr_b16 v[100:101], v21 offset:16384
    ds_read_b64_tr_b16 v[102:103], v21 offset:16896
    v_exp_f32 v55, v171
    v_fma_f32 v52, -v168, v52, v168
    v_fma_f32 v53, -v169, v53, v169
    v_mfma_f32_32x32x16_bf16 v[188:203], v[84:87], v[248:251], v[188:203]
    ds_read_b64_tr_b16 v[104:105], v21 offset:18432
    buffer_load_dwordx4 v13, s[8:11], s40 offen offset:1024 lds
    v_fma_f32 v54, v54, v4, v4
    v_fma_f32 v55, v55, v4, v4
    v_cvt_pk_bf16_f32 v74, v52, v53
    v_mfma_f32_32x32x16_bf16 v[204:219], v[84:87], a[136:139], v[204:219]
    ds_read_b64_tr_b16 v[106:107], v21 offset:18944
    v_fma_f32 v54, v54, v54, 0.5
    v_fma_f32 v55, v55, v55, 0.5
    v_rcp_f32 v54, v54
    v_mfma_f32_32x32x16_bf16 v[188:203], v[88:91], v[252:255], v[188:203]
    ds_read_b64_tr_b16 v[76:77], v21 offset:20480
    buffer_load_dwordx4 v14, s[8:11], s40 offen offset:2048 lds
    v_rcp_f32 v55, v55
    v_fma_f32 v54, -v170, v54, v170
    v_fma_f32 v55, -v171, v55, v171
    v_mfma_f32_32x32x16_bf16 v[204:219], v[88:91], a[140:143], v[204:219]
    ds_read_b64_tr_b16 v[78:79], v21 offset:20992
    v_cvt_pk_bf16_f32 v75, v54, v55
    ds_write_b128 v43, v[72:75] offset:20480
    s_waitcnt lgkmcnt(7)
    v_mfma_f32_32x32x16_bf16 v[108:123], v[92:95], a[144:147], v[172:187]
    ds_read_b64_tr_b16 v[80:81], v21 offset:22528
    s_add_u32 m0, s37, 61440
    s_add_u32 s40, s35, 1769472
    buffer_load_dwordx4 v12, s[8:11], s40 offen offset:0 lds
    v_mfma_f32_32x32x16_bf16 v[124:139], v[92:95], a[0:3], v[172:187]
    ds_read_b64_tr_b16 v[82:83], v21 offset:23040
    buffer_store_dwordx4 v[72:75], v46, s[16:19], s50 offen offset:1024 sc1
    v_mfma_f32_32x32x16_bf16 v[108:123], v[96:99], a[148:151], v[108:123]
    ds_read_b64_tr_b16 v[84:85], v21 offset:36864
    s_add_u32 s50, s41, 8192
    v_exp_f32 v52, v188
    v_exp_f32 v53, v189
    v_fma_f32 v52, v52, v4, v4
    v_mfma_f32_32x32x16_bf16 v[124:139], v[96:99], a[4:7], v[124:139]
    ds_read_b64_tr_b16 v[86:87], v21 offset:37376
    buffer_load_dwordx4 v13, s[8:11], s40 offen offset:1024 lds
    v_fma_f32 v53, v53, v4, v4
    v_fma_f32 v52, v52, v52, 0.5
    v_fma_f32 v53, v53, v53, 0.5
    s_waitcnt lgkmcnt(7)
    v_mfma_f32_32x32x16_bf16 v[108:123], v[100:103], a[152:155], v[108:123]
    ds_read_b64_tr_b16 v[88:89], v21 offset:38912
    v_rcp_f32 v52, v52
    v_rcp_f32 v53, v53
    v_exp_f32 v54, v190
    v_mfma_f32_32x32x16_bf16 v[124:139], v[100:103], a[8:11], v[124:139]
    ds_read_b64_tr_b16 v[90:91], v21 offset:39424
    buffer_load_dwordx4 v14, s[8:11], s40 offen offset:2048 lds
    v_exp_f32 v55, v191
    v_fma_f32 v52, -v188, v52, v188
    v_mfma_f32_32x32x16_bf16 v[108:123], v[104:107], a[156:159], v[108:123]
    ds_read_b64_tr_b16 v[92:93], v21 offset:40960
    v_fma_f32 v53, -v189, v53, v189
    v_fma_f32 v54, v54, v4, v4
    v_fma_f32 v55, v55, v4, v4
    v_cvt_pk_bf16_f32 v60, v52, v53
    v_fma_f32 v54, v54, v54, 0.5
    v_fma_f32 v55, v55, v55, 0.5
    v_mfma_f32_32x32x16_bf16 v[124:139], v[104:107], a[12:15], v[124:139]
    ds_read_b64_tr_b16 v[94:95], v21 offset:41472
    v_rcp_f32 v54, v54
    v_rcp_f32 v55, v55
    v_exp_f32 v52, v192
    s_waitcnt lgkmcnt(6)
    v_mfma_f32_32x32x16_bf16 v[108:123], v[76:79], a[160:163], v[108:123]
    ds_read_b64_tr_b16 v[96:97], v21 offset:43008
    s_add_u32 m0, s37, 73728
    s_add_u32 s40, s35, 3538944
    buffer_load_dwordx4 v12, s[8:11], s40 offen offset:0 lds
    v_exp_f32 v53, v193
    v_mfma_f32_32x32x16_bf16 v[124:139], v[76:79], a[16:19], v[124:139]
    ds_read_b64_tr_b16 v[98:99], v21 offset:43520
    v_fma_f32 v54, -v190, v54, v190
    v_fma_f32 v55, -v191, v55, v191
    v_fma_f32 v52, v52, v4, v4
    v_fma_f32 v53, v53, v4, v4
    v_cvt_pk_bf16_f32 v61, v54, v55
    v_mfma_f32_32x32x16_bf16 v[108:123], v[80:83], a[164:167], v[108:123]
    ds_read_b64_tr_b16 v[100:101], v21 offset:45056
    buffer_load_dwordx4 v13, s[8:11], s40 offen offset:1024 lds
    v_fma_f32 v52, v52, v52, 0.5
    v_fma_f32 v53, v53, v53, 0.5
    v_rcp_f32 v52, v52
    v_mfma_f32_32x32x16_bf16 v[124:139], v[80:83], a[20:23], v[124:139]
    ds_read_b64_tr_b16 v[102:103], v21 offset:45568
    v_rcp_f32 v53, v53
    v_exp_f32 v54, v194
    v_exp_f32 v55, v195
    s_waitcnt lgkmcnt(6)
    v_mfma_f32_32x32x16_bf16 v[108:123], v[84:87], a[168:171], v[108:123]
    ds_read_b64_tr_b16 v[104:105], v21 offset:47104
    v_fma_f32 v52, -v192, v52, v192
    v_fma_f32 v53, -v193, v53, v193
    v_fma_f32 v54, v54, v4, v4
    v_fma_f32 v55, v55, v4, v4
    v_cvt_pk_bf16_f32 v62, v52, v53
    v_mfma_f32_32x32x16_bf16 v[124:139], v[84:87], a[24:27], v[124:139]
    ds_read_b64_tr_b16 v[106:107], v21 offset:47616
    v_fma_f32 v54, v54, v54, 0.5
    v_fma_f32 v55, v55, v55, 0.5
    v_rcp_f32 v54, v54
    v_rcp_f32 v55, v55
    v_mfma_f32_32x32x16_bf16 v[108:123], v[88:91], a[172:175], v[108:123]
    buffer_load_dwordx4 v14, s[8:11], s40 offen offset:2048 lds
    v_exp_f32 v52, v196
    v_exp_f32 v53, v197
    v_fma_f32 v54, -v194, v54, v194
    v_mfma_f32_32x32x16_bf16 v[124:139], v[88:91], a[28:31], v[124:139]
    v_fma_f32 v55, -v195, v55, v195
    v_fma_f32 v52, v52, v4, v4
    v_fma_f32 v53, v53, v4, v4
    v_cvt_pk_bf16_f32 v63, v54, v55
    v_fma_f32 v52, v52, v52, 0.5
    v_fma_f32 v53, v53, v53, 0.5
    s_waitcnt vmcnt(10) lgkmcnt(0)
    v_mfma_f32_32x32x16_bf16 v[108:123], v[92:95], a[176:179], v[108:123]
    s_barrier
    v_mov_b32 v58, 1
    s_mov_b64 exec, 1
    buffer_store_dword v58, off, s[16:19], s4 sc1
    s_mov_b64 exec, -1
    v_mfma_f32_32x32x16_bf16 v[124:139], v[92:95], a[32:35], v[124:139]
    ds_read_b128 a[0:3], v47 offset:0
    ds_read_b64_tr_b16 v[76:77], v21 offset:49152
    ds_write_b128 v42, v[60:63] offset:32768
    v_rcp_f32 v52, v52
    v_mfma_f32_32x32x16_bf16 v[108:123], v[96:99], a[180:183], v[108:123]
    ds_read_b64_tr_b16 v[78:79], v21 offset:49664
    ds_read_b128 a[4:7], v47 offset:256
    v_rcp_f32 v53, v53
    v_mfma_f32_32x32x16_bf16 v[124:139], v[96:99], a[36:39], v[124:139]
    ds_read_b64_tr_b16 v[80:81], v21 offset:51200
    ds_read_b64_tr_b16 v[82:83], v21 offset:51712
    s_add_u32 m0, s37, 12288
    s_add_u32 s40, s52, s48
    buffer_load_dwordx4 v15, s[12:15], s40 offen offset:0 lds
    v_mfma_f32_32x32x16_bf16 v[108:123], v[100:103], a[184:187], v[108:123]
    ds_read_b128 a[8:11], v47 offset:1024
    ds_read_b64_tr_b16 v[84:85], v21 offset:53248
    buffer_store_dwordx4 v[60:63], v45, s[16:19], s50 offen offset:0 sc1
    v_mfma_f32_32x32x16_bf16 v[124:139], v[100:103], a[40:43], v[124:139]
    ds_read_b64_tr_b16 v[86:87], v21 offset:53760
    ds_read_b128 a[12:15], v47 offset:1280
    v_exp_f32 v54, v198
    v_exp_f32 v55, v199
    v_fma_f32 v52, -v196, v52, v196
    v_mfma_f32_32x32x16_bf16 v[108:123], v[104:107], a[188:191], v[108:123]
    ds_read_b64_tr_b16 v[88:89], v21 offset:55296
    ds_read_b64_tr_b16 v[90:91], v21 offset:55808
    buffer_load_dwordx4 v16, s[12:15], s40 offen offset:1024 lds
    v_fma_f32 v53, -v197, v53, v197
    v_fma_f32 v54, v54, v4, v4
    v_fma_f32 v55, v55, v4, v4
    v_mfma_f32_32x32x16_bf16 v[124:139], v[104:107], a[44:47], v[124:139]
    ds_read_b128 a[16:19], v47 offset:8192
    ds_read_b64_tr_b16 v[92:93], v21 offset:57344
    v_cvt_pk_bf16_f32 v64, v52, v53
    v_fma_f32 v54, v54, v54, 0.5
    v_fma_f32 v55, v55, v55, 0.5
    s_waitcnt lgkmcnt(8)
    v_mfma_f32_32x32x16_bf16 v[108:123], v[76:79], a[192:195], v[108:123]
    ds_read_b64_tr_b16 v[94:95], v21 offset:57856
    ds_read_b128 a[20:23], v47 offset:8448
    v_rcp_f32 v54, v54
    v_rcp_f32 v55, v55
    v_exp_f32 v52, v200
    v_mfma_f32_32x32x16_bf16 v[124:139], v[76:79], a[48:51], v[124:139]
    ds_read_b64_tr_b16 v[96:97], v21 offset:59392
    ds_read_b64_tr_b16 v[98:99], v21 offset:59904
    v_exp_f32 v53, v201
    v_fma_f32 v54, -v198, v54, v198
    v_fma_f32 v55, -v199, v55, v199
    v_mfma_f32_32x32x16_bf16 v[108:123], v[80:83], a[196:199], v[108:123]
    ds_read_b128 a[24:27], v47 offset:9216
    ds_read_b64_tr_b16 v[100:101], v23 offset:4096
    v_fma_f32 v52, v52, v4, v4
    v_fma_f32 v53, v53, v4, v4
    v_cvt_pk_bf16_f32 v65, v54, v55
    v_fma_f32 v52, v52, v52, 0.5
    v_mfma_f32_32x32x16_bf16 v[124:139], v[80:83], a[52:55], v[124:139]
    ds_read_b64_tr_b16 v[102:103], v23 offset:4608
    buffer_load_dwordx4 v17, s[12:15], s40 offen offset:2048 lds
    v_fma_f32 v53, v53, v53, 0.5
    v_rcp_f32 v52, v52
    s_waitcnt lgkmcnt(9)
    v_mfma_f32_32x32x16_bf16 v[108:123], v[84:87], a[200:203], v[108:123]
    ds_read_b128 a[28:31], v47 offset:9472
    ds_read_b64_tr_b16 v[104:105], v23 offset:6144
    v_rcp_f32 v53, v53
    v_exp_f32 v54, v202
    v_exp_f32 v55, v203
    v_mfma_f32_32x32x16_bf16 v[124:139], v[84:87], a[56:59], v[124:139]
    ds_read_b64_tr_b16 v[106:107], v23 offset:6656
    s_add_u32 m0, s37, 36864
    s_add_u32 s48, s48, s36
    s_add_u32 s40, s52, s48
    buffer_load_dwordx4 v15, s[12:15], s40 offen offset:0 lds
    v_fma_f32 v52, -v200, v52, v200
    v_mfma_f32_32x32x16_bf16 v[108:123], v[88:91], a[204:207], v[108:123]
    ds_read_b128 a[32:35], v47 offset:16384
    ds_read_b64_tr_b16 v[76:77], v23 offset:8192
    v_fma_f32 v53, -v201, v53, v201
    v_fma_f32 v54, v54, v4, v4
    v_fma_f32 v55, v55, v4, v4
    v_cvt_pk_bf16_f32 v66, v52, v53
    v_mfma_f32_32x32x16_bf16 v[124:139], v[88:91], a[60:63], v[124:139]
    ds_read_b64_tr_b16 v[78:79], v23 offset:8704
    v_fma_f32 v54, v54, v54, 0.5
    v_fma_f32 v55, v55, v55, 0.5
    v_rcp_f32 v54, v54
    v_rcp_f32 v55, v55
    s_waitcnt lgkmcnt(9)
    v_mfma_f32_32x32x16_bf16 v[108:123], v[92:95], a[208:211], v[108:123]
    ds_read_b128 a[36:39], v47 offset:16640
    ds_read_b64_tr_b16 v[80:81], v23 offset:10240
    v_exp_f32 v52, v204
    v_exp_f32 v53, v205
    v_mfma_f32_32x32x16_bf16 v[124:139], v[92:95], a[64:67], v[124:139]
    ds_read_b64_tr_b16 v[82:83], v23 offset:10752
    buffer_load_dwordx4 v16, s[12:15], s40 offen offset:1024 lds
    v_fma_f32 v54, -v202, v54, v202
    v_fma_f32 v55, -v203, v55, v203
    v_fma_f32 v52, v52, v4, v4
    v_fma_f32 v53, v53, v4, v4
    s_waitcnt vmcnt(12)
    v_mov_b32 v58, 1
    buffer_store_dword v58, v59, s[16:19], s46 offen sc1
    v_mfma_f32_32x32x16_bf16 v[108:123], v[96:99], a[212:215], v[108:123]
    ds_read_b128 a[40:43], v47 offset:17408
    ds_read_b64_tr_b16 v[84:85], v23 offset:12288
    v_cvt_pk_bf16_f32 v67, v54, v55
    v_fma_f32 v52, v52, v52, 0.5
    v_fma_f32 v53, v53, v53, 0.5
    v_mfma_f32_32x32x16_bf16 v[124:139], v[96:99], a[68:71], v[124:139]
    ds_read_b64_tr_b16 v[86:87], v23 offset:12800
    ds_write_b128 v42, v[64:67] offset:36864
    v_rcp_f32 v52, v52
    s_waitcnt lgkmcnt(10)
    v_mfma_f32_32x32x16_bf16 v[108:123], v[100:103], a[216:219], v[108:123]
    ds_read_b128 a[44:47], v47 offset:17664
    ds_read_b64_tr_b16 v[88:89], v23 offset:14336
    v_rcp_f32 v53, v53
    buffer_store_dwordx4 v[64:67], v45, s[16:19], s50 offen offset:1024 sc1
    v_mfma_f32_32x32x16_bf16 v[124:139], v[100:103], a[72:75], v[124:139]
    ds_read_b64_tr_b16 v[90:91], v23 offset:14848
    v_exp_f32 v54, v206
    v_mfma_f32_32x32x16_bf16 v[108:123], v[104:107], a[220:223], v[108:123]
    buffer_load_dwordx4 v17, s[12:15], s40 offen offset:2048 lds
    v_exp_f32 v55, v207
    v_fma_f32 v52, -v204, v52, v204
    v_fma_f32 v53, -v205, v53, v205
    v_fma_f32 v54, v54, v4, v4
    v_mfma_f32_32x32x16_bf16 v[124:139], v[104:107], a[76:79], v[124:139]
    v_fma_f32 v55, v55, v4, v4
    v_cvt_pk_bf16_f32 v68, v52, v53
    v_fma_f32 v54, v54, v54, 0.5
    v_fma_f32 v55, v55, v55, 0.5
    v_rcp_f32 v54, v54
    v_rcp_f32 v55, v55
    s_waitcnt lgkmcnt(0)
    v_mfma_f32_32x32x16_bf16 v[108:123], v[76:79], a[224:227], v[108:123]
    s_barrier
    v_mfma_f32_32x32x16_bf16 v[124:139], v[76:79], a[80:83], v[124:139]
    ds_read_b64_tr_b16 v[92:93], v23 offset:16384
    ds_read_b64_tr_b16 v[94:95], v23 offset:16896
    s_add_u32 m0, s37, 86016
    s_sub_u32 s48, s48, s36
    s_add_u32 s40, s53, s48
    buffer_load_dwordx4 v15, s[12:15], s40 offen offset:0 lds
    v_mfma_f32_32x32x16_bf16 v[108:123], v[80:83], a[228:231], v[108:123]
    ds_read_b64_tr_b16 v[96:97], v23 offset:18432
    ds_read_b64_tr_b16 v[98:99], v23 offset:18944
    v_exp_f32 v52, v208
    v_exp_f32 v53, v209
    v_fma_f32 v54, -v206, v54, v206
    v_mfma_f32_32x32x16_bf16 v[124:139], v[80:83], a[84:87], v[124:139]
    ds_read_b128 v[172:175], v3 offset:1024
    ds_read_b64_tr_b16 v[100:101], v23 offset:20480
    v_fma_f32 v55, -v207, v55, v207
    v_fma_f32 v52, v52, v4, v4
    v_fma_f32 v53, v53, v4, v4
    v_cvt_pk_bf16_f32 v69, v54, v55
    v_fma_f32 v52, v52, v52, 0.5
    v_mfma_f32_32x32x16_bf16 v[108:123], v[84:87], a[232:235], v[108:123]
    ds_read_b64_tr_b16 v[102:103], v23 offset:20992
    ds_read_b64_tr_b16 v[104:105], v23 offset:22528
    v_fma_f32 v53, v53, v53, 0.5
    v_rcp_f32 v52, v52
    v_rcp_f32 v53, v53
    v_mfma_f32_32x32x16_bf16 v[124:139], v[84:87], a[88:91], v[124:139]
    ds_read_b64_tr_b16 v[106:107], v23 offset:23040
    buffer_load_dwordx4 v16, s[12:15], s40 offen offset:1024 lds
    v_exp_f32 v54, v210
    v_mfma_f32_32x32x16_bf16 v[108:123], v[88:91], a[236:239], v[108:123]
    ds_read_b128 v[176:179], v3 offset:1056
    ds_read_b64_tr_b16 v[76:77], v23 offset:24576
    v_exp_f32 v55, v211
    v_fma_f32 v52, -v208, v52, v208
    v_fma_f32 v53, -v209, v53, v209
    v_fma_f32 v54, v54, v4, v4
    v_mfma_f32_32x32x16_bf16 v[124:139], v[88:91], a[92:95], v[124:139]
    ds_read_b64_tr_b16 v[78:79], v23 offset:25088
    buffer_load_dwordx4 v17, s[12:15], s40 offen offset:2048 lds
    v_fma_f32 v55, v55, v4, v4
    v_cvt_pk_bf16_f32 v70, v52, v53
    v_fma_f32 v54, v54, v54, 0.5
    v_fma_f32 v55, v55, v55, 0.5
    s_waitcnt lgkmcnt(8)
    v_mfma_f32_32x32x16_bf16 v[108:123], v[92:95], a[240:243], v[108:123]
    ds_read_b64_tr_b16 v[80:81], v23 offset:26624
    v_rcp_f32 v54, v54
    v_rcp_f32 v55, v55
    v_exp_f32 v52, v212
    v_mfma_f32_32x32x16_bf16 v[124:139], v[92:95], a[96:99], v[124:139]
    ds_read_b64_tr_b16 v[82:83], v23 offset:27136
    s_add_u32 m0, s37, 98304
    s_add_u32 s48, s48, s36
    s_add_u32 s40, s53, s48
    buffer_load_dwordx4 v15, s[12:15], s40 offen offset:0 lds
    v_mfma_f32_32x32x16_bf16 v[108:123], v[96:99], a[244:247], v[108:123]
    ds_read_b128 v[180:183], v3 offset:1088
    ds_read_b64_tr_b16 v[84:85], v21 offset:24576
    v_exp_f32 v53, v213
    v_fma_f32 v54, -v210, v54, v210
    v_fma_f32 v55, -v211, v55, v211
    v_fma_f32 v52, v52, v4, v4
    v_mfma_f32_32x32x16_bf16 v[124:139], v[96:99], a[100:103], v[124:139]
    ds_read_b64_tr_b16 v[86:87], v21 offset:25088
    v_fma_f32 v53, v53, v4, v4
    v_cvt_pk_bf16_f32 v71, v54, v55
    v_fma_f32 v52, v52, v52, 0.5
    v_fma_f32 v53, v53, v53, 0.5
    s_waitcnt lgkmcnt(8)
    v_mfma_f32_32x32x16_bf16 v[108:123], v[100:103], a[248:251], v[108:123]
    ds_read_b64_tr_b16 v[88:89], v21 offset:26624
    buffer_load_dwordx4 v16, s[12:15], s40 offen offset:1024 lds
    ds_write_b128 v43, v[68:71] offset:32768
    v_rcp_f32 v52, v52
    v_mfma_f32_32x32x16_bf16 v[124:139], v[100:103], a[104:107], v[124:139]
    ds_read_b64_tr_b16 v[90:91], v21 offset:27136
    v_rcp_f32 v53, v53
    buffer_store_dwordx4 v[68:71], v46, s[16:19], s50 offen offset:0 sc1
    v_mfma_f32_32x32x16_bf16 v[108:123], v[104:107], a[252:255], v[108:123]
    ds_read_b128 v[184:187], v3 offset:1120
    ds_read_b64_tr_b16 v[92:93], v21 offset:28672
    v_exp_f32 v54, v214
    v_mfma_f32_32x32x16_bf16 v[124:139], v[104:107], a[108:111], v[124:139]
    ds_read_b64_tr_b16 v[94:95], v21 offset:29184
    buffer_load_dwordx4 v17, s[12:15], s40 offen offset:2048 lds
    v_exp_f32 v55, v215
    v_fma_f32 v52, -v212, v52, v212
    s_waitcnt lgkmcnt(9)
    v_mfma_f32_32x32x16_bf16 v[108:123], v[76:79], v[224:227], v[108:123]
    ds_read_b64_tr_b16 v[96:97], v21 offset:30720
    v_fma_f32 v53, -v213, v53, v213
    v_fma_f32 v54, v54, v4, v4
    v_fma_f32 v55, v55, v4, v4
    v_cvt_pk_bf16_f32 v72, v52, v53
    v_fma_f32 v54, v54, v54, 0.5
    v_fma_f32 v55, v55, v55, 0.5
    v_mfma_f32_32x32x16_bf16 v[124:139], v[76:79], a[112:115], v[124:139]
    ds_read_b64_tr_b16 v[98:99], v21 offset:31232
    s_add_u32 m0, s37, 49152
    s_sub_u32 s48, s48, s36
    s_add_u32 s40, s55, s48
    buffer_load_dwordx4 v18, s[12:15], s40 offen offset:0 lds
    v_rcp_f32 v54, v54
    v_mfma_f32_32x32x16_bf16 v[108:123], v[80:83], v[228:231], v[108:123]
    ds_read_b64_tr_b16 v[100:101], v21 offset:32768
    v_rcp_f32 v55, v55
    v_exp_f32 v52, v216
    v_mfma_f32_32x32x16_bf16 v[124:139], v[80:83], a[116:119], v[124:139]
    ds_read_b64_tr_b16 v[102:103], v21 offset:33280
    v_exp_f32 v53, v217
    v_fma_f32 v54, -v214, v54, v214
    v_fma_f32 v55, -v215, v55, v215
    v_fma_f32 v52, v52, v4, v4
    v_fma_f32 v53, v53, v4, v4
    v_cvt_pk_bf16_f32 v73, v54, v55
    s_waitcnt lgkmcnt(7)
    v_mfma_f32_32x32x16_bf16 v[108:123], v[84:87], v[232:235], v[108:123]
    ds_read_b64_tr_b16 v[104:105], v21 offset:34816
    v_fma_f32 v52, v52, v52, 0.5
    v_fma_f32 v53, v53, v53, 0.5
    v_rcp_f32 v52, v52
    v_rcp_f32 v53, v53
    v_mfma_f32_32x32x16_bf16 v[124:139], v[84:87], a[120:123], v[124:139]
    ds_read_b64_tr_b16 v[106:107], v21 offset:35328
    v_exp_f32 v54, v218
    v_exp_f32 v55, v219
    v_fma_f32 v52, -v216, v52, v216
    v_fma_f32 v53, -v217, v53, v217
    v_mfma_f32_32x32x16_bf16 v[108:123], v[88:91], v[236:239], v[108:123]
    buffer_load_dwordx4 v19, s[12:15], s40 offen offset:1024 lds
    v_fma_f32 v54, v54, v4, v4
    v_fma_f32 v55, v55, v4, v4
    v_cvt_pk_bf16_f32 v74, v52, v53
    v_fma_f32 v54, v54, v54, 0.5
    v_mfma_f32_32x32x16_bf16 v[124:139], v[88:91], a[124:127], v[124:139]
    buffer_load_dwordx4 v20, s[12:15], s40 offen offset:2048 lds
    v_fma_f32 v55, v55, v55, 0.5
    v_rcp_f32 v54, v54
    v_rcp_f32 v55, v55
    s_waitcnt lgkmcnt(4)
    v_mfma_f32_32x32x16_bf16 v[108:123], v[92:95], v[240:243], v[108:123]
    v_fma_f32 v54, -v218, v54, v218
    v_fma_f32 v55, -v219, v55, v219
    v_cvt_pk_bf16_f32 v75, v54, v55
    ds_write_b128 v43, v[72:75] offset:36864
    v_mfma_f32_32x32x16_bf16 v[124:139], v[92:95], a[128:131], v[124:139]
    buffer_store_dwordx4 v[72:75], v46, s[16:19], s50 offen offset:1024 sc1
    v_mfma_f32_32x32x16_bf16 v[108:123], v[96:99], v[244:247], v[108:123]
    s_waitcnt vmcnt(21) lgkmcnt(0)
    s_barrier
    v_mfma_f32_32x32x16_bf16 v[124:139], v[96:99], a[132:135], v[124:139]
    ds_read_b64_tr_b16 v[76:77], v24 offset:0
    ds_read_b64_tr_b16 v[78:79], v24 offset:256
    buffer_load_dword v7, v6, s[16:19], s47 offen sc1
    v_mfma_f32_32x32x16_bf16 v[108:123], v[100:103], v[248:251], v[108:123]
    ds_read_b64_tr_b16 v[80:81], v24 offset:1024
    ds_read_b64_tr_b16 v[82:83], v24 offset:1280
    v_mfma_f32_32x32x16_bf16 v[124:139], v[100:103], a[136:139], v[124:139]
    ds_read_b64_tr_b16 v[84:85], v24 offset:2048
    ds_read_b64_tr_b16 v[86:87], v24 offset:2304
    v_mfma_f32_32x32x16_bf16 v[108:123], v[104:107], v[252:255], v[108:123]
    ds_read_b64_tr_b16 v[88:89], v24 offset:3072
    ds_read_b64_tr_b16 v[90:91], v24 offset:3328
    v_mfma_f32_32x32x16_bf16 v[124:139], v[104:107], a[140:143], v[124:139]
    ds_read_b64_tr_b16 v[92:93], v24 offset:4096
    ds_read_b64_tr_b16 v[94:95], v24 offset:4352
    s_waitcnt lgkmcnt(6)
    v_mfma_f32_32x32x16_bf16 v[172:187], v[76:79], a[144:147], v[172:187]
    ds_read_b64_tr_b16 v[96:97], v24 offset:5120
    ds_read_b64_tr_b16 v[98:99], v24 offset:5376
    ds_read_b64_tr_b16 v[100:101], v24 offset:6144
    v_mfma_f32_32x32x16_bf16 v[172:187], v[80:83], a[148:151], v[172:187]
    ds_read_b64_tr_b16 v[102:103], v24 offset:6400
    ds_read_b64_tr_b16 v[104:105], v24 offset:7168
    ds_read_b64_tr_b16 v[106:107], v24 offset:7424
    s_waitcnt lgkmcnt(8)
    v_mfma_f32_32x32x16_bf16 v[172:187], v[84:87], a[152:155], v[172:187]
    ds_read_b64_tr_b16 v[76:77], v24 offset:8192
    ds_read_b64_tr_b16 v[78:79], v24 offset:8448
    ds_read_b64_tr_b16 v[80:81], v24 offset:9216
    s_add_u32 s50, s41, 12288
    v_exp_f32 v52, v108
    v_exp_f32 v53, v109
    v_fma_f32 v52, v52, v4, v4
    v_fma_f32 v53, v53, v4, v4
    v_fma_f32 v52, v52, v52, 0.5
    v_mfma_f32_32x32x16_bf16 v[172:187], v[88:91], a[156:159], v[172:187]
    ds_read_b64_tr_b16 v[82:83], v24 offset:9472
    ds_read_b64_tr_b16 v[84:85], v24 offset:10240
    ds_read_b64_tr_b16 v[86:87], v24 offset:10496
    v_fma_f32 v53, v53, v53, 0.5
    v_rcp_f32 v52, v52
    v_rcp_f32 v53, v53
    v_exp_f32 v54, v110
    s_waitcnt lgkmcnt(10)
    v_mfma_f32_32x32x16_bf16 v[172:187], v[92:95], a[160:163], v[172:187]
    ds_read_b64_tr_b16 v[88:89], v24 offset:11264
    ds_read_b64_tr_b16 v[90:91], v24 offset:11520
    v_exp_f32 v55, v111
    v_fma_f32 v52, -v108, v52, v108
    v_fma_f32 v53, -v109, v53, v109
    v_fma_f32 v54, v54, v4, v4
    v_fma_f32 v55, v55, v4, v4
    v_cvt_pk_bf16_f32 v60, v52, v53
    v_fma_f32 v54, v54, v54, 0.5
    v_fma_f32 v55, v55, v55, 0.5
    v_mfma_f32_32x32x16_bf16 v[172:187], v[96:99], a[164:167], v[172:187]
    ds_read_b128 a[48:51], v47 offset:24576
    ds_read_b64_tr_b16 v[92:93], v24 offset:61440
    ds_read_b64_tr_b16 v[94:95], v24 offset:61696
    v_rcp_f32 v54, v54
    v_rcp_f32 v55, v55
    v_exp_f32 v52, v112
    v_exp_f32 v53, v113
    s_waitcnt lgkmcnt(11)
    v_mfma_f32_32x32x16_bf16 v[172:187], v[100:103], a[168:171], v[172:187]
    ds_read_b64_tr_b16 v[96:97], v24 offset:62464
    ds_read_b64_tr_b16 v[98:99], v24 offset:62720
    v_fma_f32 v54, -v110, v54, v110
    v_fma_f32 v55, -v111, v55, v111
    v_fma_f32 v52, v52, v4, v4
    v_fma_f32 v53, v53, v4, v4
    v_cvt_pk_bf16_f32 v61, v54, v55
    v_fma_f32 v52, v52, v52, 0.5
    v_fma_f32 v53, v53, v53, 0.5
    v_rcp_f32 v52, v52
    v_mfma_f32_32x32x16_bf16 v[172:187], v[104:107], a[172:175], v[172:187]
    ds_read_b128 a[52:55], v47 offset:24832
    ds_read_b64_tr_b16 v[100:101], v24 offset:63488
    ds_read_b64_tr_b16 v[102:103], v24 offset:63744
    v_rcp_f32 v53, v53
    v_exp_f32 v54, v114
    v_exp_f32 v55, v115
    v_fma_f32 v52, -v112, v52, v112
    s_waitcnt lgkmcnt(12)
    v_mfma_f32_32x32x16_bf16 v[172:187], v[76:79], a[176:179], v[172:187]
    ds_read_b64_tr_b16 v[104:105], v24 offset:64512
    ds_read_b64_tr_b16 v[106:107], v24 offset:64768
    v_fma_f32 v53, -v113, v53, v113
    v_fma_f32 v54, v54, v4, v4
    v_fma_f32 v55, v55, v4, v4
    v_cvt_pk_bf16_f32 v62, v52, v53
    v_fma_f32 v54, v54, v54, 0.5
    v_fma_f32 v55, v55, v55, 0.5
    v_rcp_f32 v54, v54
    v_mfma_f32_32x32x16_bf16 v[172:187], v[80:83], a[180:183], v[172:187]
    ds_read_b128 a[56:59], v47 offset:25600
    ds_read_b64_tr_b16 v[76:77], v25 offset:0
    ds_read_b64_tr_b16 v[78:79], v25 offset:256
    v_rcp_f32 v55, v55
    v_exp_f32 v52, v116
    v_exp_f32 v53, v117
    v_fma_f32 v54, -v114, v54, v114
    v_fma_f32 v55, -v115, v55, v115
    s_waitcnt lgkmcnt(13)
    v_mfma_f32_32x32x16_bf16 v[172:187], v[84:87], a[184:187], v[172:187]
    ds_read_b64_tr_b16 v[80:81], v25 offset:1024
    ds_read_b64_tr_b16 v[82:83], v25 offset:1280
    v_fma_f32 v52, v52, v4, v4
    v_fma_f32 v53, v53, v4, v4
    v_cvt_pk_bf16_f32 v63, v54, v55
    v_fma_f32 v52, v52, v52, 0.5
    v_fma_f32 v53, v53, v53, 0.5
    ds_write_b128 v42, v[60:63] offset:49152
    v_mfma_f32_32x32x16_bf16 v[172:187], v[88:91], a[188:191], v[172:187]
    ds_read_b128 a[60:63], v47 offset:25856
    ds_read_b64_tr_b16 v[84:85], v25 offset:2048
    ds_read_b64_tr_b16 v[86:87], v25 offset:2304
    v_rcp_f32 v52, v52
    v_rcp_f32 v53, v53
    buffer_store_dwordx4 v[60:63], v45, s[16:19], s50 offen offset:0 sc1
    s_waitcnt lgkmcnt(14)
    v_mfma_f32_32x32x16_bf16 v[172:187], v[92:95], a[192:195], v[172:187]
    s_branch L2_skip4
.p2align 12
L2_pad4:
    s_branch L2_ret4
    s_nop 0
L2_skip4:
    ds_read_b64_tr_b16 v[88:89], v25 offset:3072
    ds_read_b64_tr_b16 v[90:91], v25 offset:3328
    v_exp_f32 v54, v118
    v_exp_f32 v55, v119
    v_fma_f32 v52, -v116, v52, v116
    v_fma_f32 v53, -v117, v53, v117
    v_mfma_f32_32x32x16_bf16 v[172:187], v[96:99], a[196:199], v[172:187]
    ds_read_b128 a[64:67], v47 offset:32768
    ds_read_b64_tr_b16 v[92:93], v25 offset:4096
    ds_read_b64_tr_b16 v[94:95], v25 offset:4352
    v_fma_f32 v54, v54, v4, v4
    v_fma_f32 v55, v55, v4, v4
    v_cvt_pk_bf16_f32 v64, v52, v53
    v_fma_f32 v54, v54, v54, 0.5
    v_fma_f32 v55, v55, v55, 0.5
    v_rcp_f32 v54, v54
    s_waitcnt lgkmcnt(14)
    v_mfma_f32_32x32x16_bf16 v[172:187], v[100:103], a[200:203], v[172:187]
    ds_read_b64_tr_b16 v[96:97], v25 offset:5120
    ds_read_b64_tr_b16 v[98:99], v25 offset:5376
    v_rcp_f32 v55, v55
    v_exp_f32 v52, v120
    v_exp_f32 v53, v121
    v_fma_f32 v54, -v118, v54, v118
    v_fma_f32 v55, -v119, v55, v119
    v_fma_f32 v52, v52, v4, v4
    v_mfma_f32_32x32x16_bf16 v[172:187], v[104:107], a[204:207], v[172:187]
    ds_read_b128 a[68:71], v47 offset:33024
    ds_read_b64_tr_b16 v[100:101], v25 offset:6144
    ds_read_b64_tr_b16 v[102:103], v25 offset:6400
    v_fma_f32 v53, v53, v4, v4
    v_cvt_pk_bf16_f32 v65, v54, v55
    v_fma_f32 v52, v52, v52, 0.5
    v_fma_f32 v53, v53, v53, 0.5
    v_rcp_f32 v52, v52
    v_rcp_f32 v53, v53
    s_waitcnt lgkmcnt(14)
    v_mfma_f32_32x32x16_bf16 v[172:187], v[76:79], a[208:211], v[172:187]
    ds_read_b64_tr_b16 v[104:105], v25 offset:7168
    ds_read_b64_tr_b16 v[106:107], v25 offset:7424
    v_exp_f32 v54, v122
    v_exp_f32 v55, v123
    v_fma_f32 v52, -v120, v52, v120
    v_fma_f32 v53, -v121, v53, v121
    v_fma_f32 v54, v54, v4, v4
    v_fma_f32 v55, v55, v4, v4
    v_mfma_f32_32x32x16_bf16 v[172:187], v[80:83], a[212:215], v[172:187]
    ds_read_b128 a[72:75], v47 offset:33792
    ds_read_b64_tr_b16 v[76:77], v25 offset:8192
    ds_read_b64_tr_b16 v[78:79], v25 offset:8448
    v_cvt_pk_bf16_f32 v66, v52, v53
    v_fma_f32 v54, v54, v54, 0.5
    v_fma_f32 v55, v55, v55, 0.5
    v_rcp_f32 v54, v54
    v_rcp_f32 v55, v55
    s_waitcnt lgkmcnt(13)
    v_mfma_f32_32x32x16_bf16 v[172:187], v[84:87], a[216:219], v[172:187]
    ds_read_b64_tr_b16 v[80:81], v25 offset:9216
    ds_read_b64_tr_b16 v[82:83], v25 offset:9472
    v_exp_f32 v52, v124
    v_exp_f32 v53, v125
    v_fma_f32 v54, -v122, v54, v122
    v_fma_f32 v55, -v123, v55, v123
    v_fma_f32 v52, v52, v4, v4
    v_fma_f32 v53, v53, v4, v4
    v_cvt_pk_bf16_f32 v67, v54, v55
    v_fma_f32 v52, v52, v52, 0.5
    v_mfma_f32_32x32x16_bf16 v[172:187], v[88:91], a[220:223], v[172:187]
    ds_read_b128 a[76:79], v47 offset:34048
    ds_read_b64_tr_b16 v[84:85], v25 offset:10240
    ds_read_b64_tr_b16 v[86:87], v25 offset:10496
    v_fma_f32 v53, v53, v53, 0.5
    ds_write_b128 v42, v[64:67] offset:53248
    v_rcp_f32 v52, v52
    s_waitcnt lgkmcnt(14)
    v_mfma_f32_32x32x16_bf16 v[172:187], v[92:95], a[224:227], v[172:187]
    ds_read_b64_tr_b16 v[88:89], v25 offset:11264
    ds_read_b64_tr_b16 v[90:91], v25 offset:11520
    v_rcp_f32 v53, v53
    buffer_store_dwordx4 v[64:67], v45, s[16:19], s50 offen offset:1024 sc1
    v_mfma_f32_32x32x16_bf16 v[172:187], v[96:99], a[228:231], v[172:187]
    ds_read_b128 a[80:83], v47 offset:40960
    ds_read_b64_tr_b16 v[92:93], v25 offset:12288
    ds_read_b64_tr_b16 v[94:95], v25 offset:12544
    v_exp_f32 v54, v126
    v_exp_f32 v55, v127
    v_fma_f32 v52, -v124, v52, v124
    v_fma_f32 v53, -v125, v53, v125
    v_fma_f32 v54, v54, v4, v4
    v_fma_f32 v55, v55, v4, v4
    s_waitcnt lgkmcnt(14)
    v_mfma_f32_32x32x16_bf16 v[172:187], v[100:103], a[232:235], v[172:187]
    ds_read_b64_tr_b16 v[96:97], v25 offset:13312
    ds_read_b64_tr_b16 v[98:99], v25 offset:13568
    v_cvt_pk_bf16_f32 v68, v52, v53
    v_fma_f32 v54, v54, v54, 0.5
    v_fma_f32 v55, v55, v55, 0.5
    v_rcp_f32 v54, v54
    v_rcp_f32 v55, v55
    v_exp_f32 v52, v128
    v_mfma_f32_32x32x16_bf16 v[172:187], v[104:107], a[236:239], v[172:187]
    ds_read_b128 a[84:87], v47 offset:41216
    ds_read_b64_tr_b16 v[100:101], v25 offset:14336
    ds_read_b64_tr_b16 v[102:103], v25 offset:14592
    v_exp_f32 v53, v129
    v_fma_f32 v54, -v126, v54, v126
    v_fma_f32 v55, -v127, v55, v127
    v_fma_f32 v52, v52, v4, v4
    v_fma_f32 v53, v53, v4, v4
    v_cvt_pk_bf16_f32 v69, v54, v55
    s_waitcnt lgkmcnt(14)
    v_mfma_f32_32x32x16_bf16 v[172:187], v[76:79], a[240:243], v[172:187]
    ds_read_b64_tr_b16 v[104:105], v25 offset:15360
    ds_read_b64_tr_b16 v[106:107], v25 offset:15616
    s_waitcnt vmcnt(2)
    v_cmp_le_u32 vcc, 1, v7
    s_nop 0
    s_cmp_eq_u64 vcc, -1
    s_cbranch_scc0 L2_spin0
L2_ok0:
    v_fma_f32 v52, v52, v52, 0.5
    v_fma_f32 v53, v53, v53, 0.5
    v_rcp_f32 v52, v52
    v_rcp_f32 v53, v53
    v_mov_b32 v58, 2
    buffer_store_dword v58, v59, s[16:19], s46 offen sc1
    v_mfma_f32_32x32x16_bf16 v[172:187], v[80:83], a[244:247], v[172:187]
    ds_read_b128 a[88:91], v47 offset:41984
    ds_read_b64_tr_b16 v[76:77], v25 offset:16384
    ds_read_b64_tr_b16 v[78:79], v25 offset:16640
    v_exp_f32 v54, v130
    v_exp_f32 v55, v131
    v_fma_f32 v52, -v128, v52, v128
    v_fma_f32 v53, -v129, v53, v129
    v_fma_f32 v54, v54, v4, v4
    v_fma_f32 v55, v55, v4, v4
    s_waitcnt lgkmcnt(13)
    v_mfma_f32_32x32x16_bf16 v[172:187], v[84:87], a[248:251], v[172:187]
    ds_read_b64_tr_b16 v[80:81], v25 offset:17408
    ds_read_b64_tr_b16 v[82:83], v25 offset:17664
    s_add_u32 m0, s37, 24576
    s_add_u32 s40, s43, 0
    buffer_load_dwordx4 v1, s[16:19], s40 offen offset:0 sc1 lds
    v_cvt_pk_bf16_f32 v70, v52, v53
    v_fma_f32 v54, v54, v54, 0.5
    v_fma_f32 v55, v55, v55, 0.5
    v_rcp_f32 v54, v54
    v_mfma_f32_32x32x16_bf16 v[172:187], v[88:91], a[252:255], v[172:187]
    ds_read_b128 a[92:95], v47 offset:42240
    ds_read_b64_tr_b16 v[84:85], v25 offset:18432
    ds_read_b64_tr_b16 v[86:87], v25 offset:18688
    v_rcp_f32 v55, v55
    v_exp_f32 v52, v132
    v_exp_f32 v53, v133
    v_fma_f32 v54, -v130, v54, v130
    s_waitcnt lgkmcnt(13)
    v_mfma_f32_32x32x16_bf16 v[172:187], v[92:95], v[224:227], v[172:187]
    ds_read_b64_tr_b16 v[88:89], v25 offset:19456
    ds_read_b64_tr_b16 v[90:91], v25 offset:19712
    buffer_load_dwordx4 v1, s[16:19], s40 offen offset:1024 sc1 lds
    v_fma_f32 v55, -v131, v55, v131
    v_fma_f32 v52, v52, v4, v4
    v_fma_f32 v53, v53, v4, v4
    v_cvt_pk_bf16_f32 v71, v54, v55
    v_fma_f32 v52, v52, v52, 0.5
    v_fma_f32 v53, v53, v53, 0.5
    v_mfma_f32_32x32x16_bf16 v[172:187], v[96:99], v[228:231], v[172:187]
    buffer_load_dwordx4 v1, s[16:19], s40 offen offset:2048 sc1 lds
    ds_write_b128 v43, v[68:71] offset:49152
    v_rcp_f32 v52, v52
    v_rcp_f32 v53, v53
    s_waitcnt lgkmcnt(11)
    v_mfma_f32_32x32x16_bf16 v[172:187], v[100:103], v[232:235], v[172:187]
    buffer_store_dwordx4 v[68:71], v46, s[16:19], s50 offen offset:0 sc1
    v_exp_f32 v54, v134
    v_exp_f32 v55, v135
    v_fma_f32 v52, -v132, v52, v132
    v_mfma_f32_32x32x16_bf16 v[172:187], v[104:107], v[236:239], v[172:187]
    s_waitcnt lgkmcnt(1)
    s_barrier
    ds_read_b64_tr_b16 v[92:93], v27 offset:12288
    ds_read_b64_tr_b16 v[94:95], v27 offset:13312
    v_fma_f32 v53, -v133, v53, v133
    v_fma_f32 v54, v54, v4, v4
    v_fma_f32 v55, v55, v4, v4
    v_mfma_f32_32x32x16_bf16 v[172:187], v[76:79], v[240:243], v[172:187]
    ds_read_b64_tr_b16 v[96:97], v30 offset:12288
    ds_read_b64_tr_b16 v[98:99], v30 offset:13312
    s_add_u32 m0, s37, 110592
    s_add_u32 s40, s43, 36864
    buffer_load_dwordx4 v1, s[16:19], s40 offen offset:0 sc1 lds
    v_cvt_pk_bf16_f32 v72, v52, v53
    v_fma_f32 v54, v54, v54, 0.5
    v_fma_f32 v55, v55, v55, 0.5
    v_rcp_f32 v54, v54
    v_mfma_f32_32x32x16_bf16 v[172:187], v[80:83], v[244:247], v[172:187]
    ds_read_b64_tr_b16 v[100:101], v27 offset:16384
    ds_read_b64_tr_b16 v[102:103], v27 offset:17408
    v_rcp_f32 v55, v55
    v_exp_f32 v52, v136
    v_exp_f32 v53, v137
    v_fma_f32 v54, -v134, v54, v134
    v_fma_f32 v55, -v135, v55, v135
    v_mfma_f32_32x32x16_bf16 v[172:187], v[84:87], v[248:251], v[172:187]
    ds_read_b64_tr_b16 v[104:105], v30 offset:16384
    ds_read_b64_tr_b16 v[106:107], v30 offset:17408
    buffer_load_dwordx4 v1, s[16:19], s40 offen offset:1024 sc1 lds
    v_fma_f32 v52, v52, v4, v4
    v_fma_f32 v53, v53, v4, v4
    v_cvt_pk_bf16_f32 v73, v54, v55
    v_fma_f32 v52, v52, v52, 0.5
    v_fma_f32 v53, v53, v53, 0.5
    v_rcp_f32 v52, v52
    v_mfma_f32_32x32x16_bf16 v[172:187], v[88:91], v[252:255], v[172:187]
    ds_read_b64_tr_b16 v[76:77], v27 offset:20480
    ds_read_b64_tr_b16 v[78:79], v27 offset:21504
    v_rcp_f32 v53, v53
    v_exp_f32 v54, v138
    v_exp_f32 v55, v139
    v_fma_f32 v52, -v136, v52, v136
    v_fma_f32 v53, -v137, v53, v137
    s_waitcnt lgkmcnt(6)
    v_mfma_f32_16x16x32_bf16 v[140:143], v[92:95], a[0:3], 0
    ds_read_b64_tr_b16 v[80:81], v30 offset:20480
    v_fma_f32 v54, v54, v4, v4
    v_fma_f32 v55, v55, v4, v4
    v_cvt_pk_bf16_f32 v74, v52, v53
    v_fma_f32 v54, v54, v54, 0.5
    v_mfma_f32_16x16x32_bf16 v[144:147], v[92:95], a[4:7], 0
    ds_read_b64_tr_b16 v[82:83], v30 offset:21504
    v_fma_f32 v55, v55, v55, 0.5
    v_rcp_f32 v54, v54
    v_mfma_f32_16x16x32_bf16 v[148:151], v[92:95], a[8:11], 0
    buffer_load_dwordx4 v1, s[16:19], s40 offen offset:2048 sc1 lds
    v_rcp_f32 v55, v55
    v_mfma_f32_16x16x32_bf16 v[152:155], v[92:95], a[12:15], 0
    v_fma_f32 v54, -v138, v54, v138
    v_fma_f32 v55, -v139, v55, v139
    v_cvt_pk_bf16_f32 v75, v54, v55
    v_mfma_f32_16x16x32_bf16 v[156:159], v[96:99], a[0:3], 0
    ds_read_b64_tr_b16 v[84:85], v27 offset:36864
    ds_write_b128 v43, v[72:75] offset:53248
    v_mfma_f32_16x16x32_bf16 v[160:163], v[96:99], a[4:7], 0
    ds_read_b64_tr_b16 v[86:87], v27 offset:37888
    buffer_store_dwordx4 v[72:75], v46, s[16:19], s50 offen offset:1024 sc1
    v_mfma_f32_16x16x32_bf16 v[164:167], v[96:99], a[8:11], 0
    s_add_u32 m0, s37, 122880
    s_add_u32 s48, s48, s36
    s_add_u32 s40, s55, s48
    buffer_load_dwordx4 v18, s[12:15], s40 offen offset:0 lds
    v_mfma_f32_16x16x32_bf16 v[168:171], v[96:99], a[12:15], 0
    buffer_load_dwordx4 v19, s[12:15], s40 offen offset:1024 lds
    s_waitcnt lgkmcnt(7)
    v_mfma_f32_16x16x32_bf16 v[140:143], v[100:103], a[16:19], v[140:143]
    ds_read_b64_tr_b16 v[88:89], v30 offset:36864
    v_exp_f32 v52, v172
    v_exp_f32 v53, v173
    v_fma_f32 v52, v52, v4, v4
    v_fma_f32 v53, v53, v4, v4
    v_fma_f32 v52, v52, v52, 0.5
    v_fma_f32 v53, v53, v53, 0.5
    v_mfma_f32_16x16x32_bf16 v[144:147], v[100:103], a[20:23], v[144:147]
    ds_read_b64_tr_b16 v[90:91], v30 offset:37888
    v_rcp_f32 v52, v52
    v_rcp_f32 v53, v53
    v_exp_f32 v54, v174
    v_exp_f32 v55, v175
    v_mfma_f32_16x16x32_bf16 v[148:151], v[100:103], a[24:27], v[148:151]
    buffer_load_dwordx4 v20, s[12:15], s40 offen offset:2048 lds
    v_fma_f32 v52, -v172, v52, v172
    v_fma_f32 v53, -v173, v53, v173
    v_fma_f32 v54, v54, v4, v4
    v_fma_f32 v55, v55, v4, v4
    v_cvt_pk_bf16_f32 v60, v52, v53
    v_mfma_f32_16x16x32_bf16 v[152:155], v[100:103], a[28:31], v[152:155]
    v_fma_f32 v54, v54, v54, 0.5
    v_fma_f32 v55, v55, v55, 0.5
    v_rcp_f32 v54, v54
    v_rcp_f32 v55, v55
    v_exp_f32 v52, v176
    v_mfma_f32_16x16x32_bf16 v[156:159], v[104:107], a[16:19], v[156:159]
    ds_read_b64_tr_b16 v[92:93], v27 offset:40960
    v_exp_f32 v53, v177
    v_fma_f32 v54, -v174, v54, v174
    v_fma_f32 v55, -v175, v55, v175
    v_fma_f32 v52, v52, v4, v4
    v_fma_f32 v53, v53, v4, v4
    v_cvt_pk_bf16_f32 v61, v54, v55
    v_fma_f32 v52, v52, v52, 0.5
    v_mfma_f32_16x16x32_bf16 v[160:163], v[104:107], a[20:23], v[160:163]
    ds_read_b64_tr_b16 v[94:95], v27 offset:41984
    v_fma_f32 v53, v53, v53, 0.5
    v_rcp_f32 v52, v52
    v_rcp_f32 v53, v53
    v_exp_f32 v54, v178
    v_mfma_f32_16x16x32_bf16 v[164:167], v[104:107], a[24:27], v[164:167]
    s_add_u32 m0, s37, 0
    s_sub_u32 s48, s48, s36
    s_add_u32 s40, s56, s48
    buffer_load_dwordx4 v18, s[12:15], s40 offen offset:0 lds
    v_exp_f32 v55, v179
    v_fma_f32 v52, -v176, v52, v176
    v_fma_f32 v53, -v177, v53, v177
    v_fma_f32 v54, v54, v4, v4
    v_mfma_f32_16x16x32_bf16 v[168:171], v[104:107], a[28:31], v[168:171]
    buffer_load_dwordx4 v19, s[12:15], s40 offen offset:1024 lds
    v_fma_f32 v55, v55, v4, v4
    v_cvt_pk_bf16_f32 v62, v52, v53
    v_fma_f32 v54, v54, v54, 0.5
    v_fma_f32 v55, v55, v55, 0.5
    v_rcp_f32 v54, v54
    s_waitcnt lgkmcnt(7)
    v_mfma_f32_16x16x32_bf16 v[140:143], v[76:79], a[32:35], v[140:143]
    ds_read_b64_tr_b16 v[96:97], v30 offset:40960
    v_rcp_f32 v55, v55
    v_exp_f32 v52, v180
    v_exp_f32 v53, v181
    v_fma_f32 v54, -v178, v54, v178
    v_fma_f32 v55, -v179, v55, v179
    v_mfma_f32_16x16x32_bf16 v[144:147], v[76:79], a[36:39], v[144:147]
    ds_read_b64_tr_b16 v[98:99], v30 offset:41984
    v_fma_f32 v52, v52, v4, v4
    v_fma_f32 v53, v53, v4, v4
    v_cvt_pk_bf16_f32 v63, v54, v55
    v_fma_f32 v52, v52, v52, 0.5
    v_fma_f32 v53, v53, v53, 0.5
    ds_write_b128 v44, v[60:63] offset:0
    v_mfma_f32_16x16x32_bf16 v[148:151], v[76:79], a[40:43], v[148:151]
    buffer_load_dwordx4 v20, s[12:15], s40 offen offset:2048 lds
    v_rcp_f32 v52, v52
    v_rcp_f32 v53, v53
    v_mfma_f32_16x16x32_bf16 v[152:155], v[76:79], a[44:47], v[152:155]
    buffer_store_dwordx4 v[60:63], v45, s[16:19], s42 offen offset:0 sc1
    v_exp_f32 v54, v182
    v_mfma_f32_16x16x32_bf16 v[156:159], v[80:83], a[32:35], v[156:159]
    ds_read_b64_tr_b16 v[100:101], v27 offset:45056
    v_exp_f32 v55, v183
    v_fma_f32 v52, -v180, v52, v180
    v_fma_f32 v53, -v181, v53, v181
    v_fma_f32 v54, v54, v4, v4
    v_fma_f32 v55, v55, v4, v4
    v_cvt_pk_bf16_f32 v64, v52, v53
    v_fma_f32 v54, v54, v54, 0.5
    v_mfma_f32_16x16x32_bf16 v[160:163], v[80:83], a[36:39], v[160:163]
    ds_read_b64_tr_b16 v[102:103], v27 offset:46080
    v_fma_f32 v55, v55, v55, 0.5
    v_rcp_f32 v54, v54
    v_rcp_f32 v55, v55
    v_exp_f32 v52, v184
    v_exp_f32 v53, v185
    v_mfma_f32_16x16x32_bf16 v[164:167], v[80:83], a[40:43], v[164:167]
    buffer_load_dword v7, v6, s[16:19], s47 offen sc1
    v_fma_f32 v54, -v182, v54, v182
    v_fma_f32 v55, -v183, v55, v183
    v_fma_f32 v52, v52, v4, v4
    v_fma_f32 v53, v53, v4, v4
    v_cvt_pk_bf16_f32 v65, v54, v55
    v_mfma_f32_16x16x32_bf16 v[168:171], v[80:83], a[44:47], v[168:171]
    s_add_u32 m0, s37, 61440
    s_add_u32 s48, s48, s36
    s_add_u32 s40, s56, s48
    buffer_load_dwordx4 v18, s[12:15], s40 offen offset:0 lds
    v_fma_f32 v52, v52, v52, 0.5
    v_fma_f32 v53, v53, v53, 0.5
    v_rcp_f32 v52, v52
    s_waitcnt lgkmcnt(7)
    v_mfma_f32_16x16x32_bf16 v[188:191], v[84:87], a[0:3], 0
    ds_read_b64_tr_b16 v[104:105], v30 offset:45056
    v_rcp_f32 v53, v53
    v_exp_f32 v54, v186
    v_exp_f32 v55, v187
    v_fma_f32 v52, -v184, v52, v184
    v_fma_f32 v53, -v185, v53, v185
    v_mfma_f32_16x16x32_bf16 v[192:195], v[84:87], a[4:7], 0
    ds_read_b64_tr_b16 v[106:107], v30 offset:46080
    v_fma_f32 v54, v54, v4, v4
    v_fma_f32 v55, v55, v4, v4
    v_cvt_pk_bf16_f32 v66, v52, v53
    v_fma_f32 v54, v54, v54, 0.5
    v_fma_f32 v55, v55, v55, 0.5
    v_rcp_f32 v54, v54
    v_mfma_f32_16x16x32_bf16 v[196:199], v[84:87], a[8:11], 0
    buffer_load_dwordx4 v19, s[12:15], s40 offen offset:1024 lds
    v_rcp_f32 v55, v55
    v_fma_f32 v54, -v186, v54, v186
    v_fma_f32 v55, -v187, v55, v187
    v_cvt_pk_bf16_f32 v67, v54, v55
    v_mfma_f32_16x16x32_bf16 v[200:203], v[84:87], a[12:15], 0
    ds_write_b128 v44, v[64:67] offset:4096
    buffer_store_dwordx4 v[64:67], v45, s[16:19], s42 offen offset:1024 sc1
    v_mfma_f32_16x16x32_bf16 v[204:207], v[88:91], a[0:3], 0
    v_mfma_f32_16x16x32_bf16 v[208:211], v[88:91], a[4:7], 0
    buffer_load_dwordx4 v20, s[12:15], s40 offen offset:2048 lds
    v_mfma_f32_16x16x32_bf16 v[212:215], v[88:91], a[8:11], 0
    v_mfma_f32_16x16x32_bf16 v[216:219], v[88:91], a[12:15], 0
    s_waitcnt vmcnt(13) lgkmcnt(1)
    v_mfma_f32_16x16x32_bf16 v[188:191], v[92:95], a[16:19], v[188:191]
    s_barrier
    v_mfma_f32_16x16x32_bf16 v[192:195], v[92:95], a[20:23], v[192:195]
    s_cmp_eq_u32 s32, 0
    s_mov_b32 s39, 110592
    s_cselect_b32 s39, 24576, s39
    v_add_u32 v49, s39, v50
    v_mfma_f32_16x16x32_bf16 v[196:199], v[92:95], a[24:27], v[196:199]
    ds_read_b128 a[96:99], v49 offset:0
    v_mfma_f32_16x16x32_bf16 v[200:203], v[92:95], a[28:31], v[200:203]
    ds_read_b64_tr_b16 v[76:77], v28 offset:20480
    s_add_u32 m0, s37, 73728
    s_sub_u32 s48, s48, s36
    s_add_u32 s40, s54, s48
    buffer_load_dwordx4 v15, s[12:15], s40 offen offset:0 lds
    v_mfma_f32_16x16x32_bf16 v[204:207], v[96:99], a[16:19], v[204:207]
    ds_read_b64_tr_b16 v[78:79], v28 offset:21504
    buffer_load_dwordx4 v16, s[12:15], s40 offen offset:1024 lds
    v_mfma_f32_16x16x32_bf16 v[208:211], v[96:99], a[20:23], v[208:211]
    ds_read_b128 a[100:103], v49 offset:256
    v_mfma_f32_16x16x32_bf16 v[212:215], v[96:99], a[24:27], v[212:215]
    ds_read_b64_tr_b16 v[80:81], v31 offset:20480
    v_mfma_f32_16x16x32_bf16 v[216:219], v[96:99], a[28:31], v[216:219]
    ds_read_b64_tr_b16 v[82:83], v31 offset:21504
    buffer_load_dwordx4 v17, s[12:15], s40 offen offset:2048 lds
    v_mfma_f32_16x16x32_bf16 v[188:191], v[100:103], a[32:35], v[188:191]
    ds_read_b128 a[104:107], v49 offset:6144
    v_mfma_f32_16x16x32_bf16 v[192:195], v[100:103], a[36:39], v[192:195]
    ds_read_b64_tr_b16 v[84:85], v28 offset:24576
    v_mfma_f32_16x16x32_bf16 v[196:199], v[100:103], a[40:43], v[196:199]
    ds_read_b64_tr_b16 v[86:87], v28 offset:25600
    v_mfma_f32_16x16x32_bf16 v[200:203], v[100:103], a[44:47], v[200:203]
    ds_read_b128 a[108:111], v49 offset:6400
    v_mfma_f32_16x16x32_bf16 v[204:207], v[104:107], a[32:35], v[204:207]
    ds_read_b64_tr_b16 v[88:89], v31 offset:24576
    v_mfma_f32_16x16x32_bf16 v[208:211], v[104:107], a[36:39], v[208:211]
    ds_read_b64_tr_b16 v[90:91], v31 offset:25600
    v_mfma_f32_16x16x32_bf16 v[212:215], v[104:107], a[40:43], v[212:215]
    ds_read_b128 a[112:115], v49 offset:2048
    v_mfma_f32_16x16x32_bf16 v[216:219], v[104:107], a[44:47], v[216:219]
    ds_read_b64_tr_b16 v[92:93], v28 offset:28672
    s_waitcnt lgkmcnt(8)
    v_mfma_f32_16x16x32_bf16 v[140:143], v[76:79], a[48:51], v[140:143]
    ds_read_b64_tr_b16 v[94:95], v28 offset:29696
    v_mfma_f32_16x16x32_bf16 v[144:147], v[76:79], a[52:55], v[144:147]
    ds_read_b128 a[116:119], v49 offset:2304
    v_mfma_f32_16x16x32_bf16 v[148:151], v[76:79], a[56:59], v[148:151]
    ds_read_b64_tr_b16 v[96:97], v31 offset:28672
    v_mfma_f32_16x16x32_bf16 v[152:155], v[76:79], a[60:63], v[152:155]
    ds_read_b64_tr_b16 v[98:99], v31 offset:29696
    v_mfma_f32_16x16x32_bf16 v[156:159], v[80:83], a[48:51], v[156:159]
    ds_read_b128 a[120:123], v49 offset:8192
    v_mfma_f32_16x16x32_bf16 v[160:163], v[80:83], a[52:55], v[160:163]
    ds_read_b64_tr_b16 v[100:101], v28 offset:32768
    v_mfma_f32_16x16x32_bf16 v[164:167], v[80:83], a[56:59], v[164:167]
    ds_read_b64_tr_b16 v[102:103], v28 offset:33792
    v_mfma_f32_16x16x32_bf16 v[168:171], v[80:83], a[60:63], v[168:171]
    s_waitcnt lgkmcnt(9)
    v_mfma_f32_16x16x32_bf16 v[140:143], v[84:87], a[64:67], v[140:143]
    ds_read_b128 a[124:127], v49 offset:8448
    v_mfma_f32_16x16x32_bf16 v[144:147], v[84:87], a[68:71], v[144:147]
    ds_read_b64_tr_b16 v[104:105], v31 offset:32768
    v_mfma_f32_16x16x32_bf16 v[148:151], v[84:87], a[72:75], v[148:151]
    ds_read_b64_tr_b16 v[106:107], v31 offset:33792
    v_mfma_f32_16x16x32_bf16 v[152:155], v[84:87], a[76:79], v[152:155]
    s_waitcnt vmcnt(7)
    v_cmp_le_u32 vcc, 2, v7
    s_nop 0
    s_cmp_eq_u64 vcc, -1
    s_cbranch_scc0 L2_spin1
L2_ok1:
    v_mfma_f32_16x16x32_bf16 v[156:159], v[88:91], a[64:67], v[156:159]
    ds_read_b128 a[128:131], v49 offset:4096
    v_mfma_f32_16x16x32_bf16 v[160:163], v[88:91], a[68:71], v[160:163]
    ds_read_b64_tr_b16 v[76:77], v28 offset:36864
    v_mfma_f32_16x16x32_bf16 v[164:167], v[88:91], a[72:75], v[164:167]
    ds_read_b64_tr_b16 v[78:79], v28 offset:37888
    v_mfma_f32_16x16x32_bf16 v[168:171], v[88:91], a[76:79], v[168:171]
    s_add_u32 m0, s37, 12288
    s_add_u32 s40, s43, 6144
    buffer_load_dwordx4 v1, s[16:19], s40 offen offset:0 sc1 lds
    s_waitcnt lgkmcnt(9)
    v_mfma_f32_16x16x32_bf16 v[140:143], v[92:95], a[80:83], v[140:143]
    ds_read_b128 a[132:135], v49 offset:4352
    v_mfma_f32_16x16x32_bf16 v[144:147], v[92:95], a[84:87], v[144:147]
    ds_read_b64_tr_b16 v[80:81], v31 offset:36864
    buffer_load_dwordx4 v1, s[16:19], s40 offen offset:1024 sc1 lds
    v_mfma_f32_16x16x32_bf16 v[148:151], v[92:95], a[88:91], v[148:151]
    ds_read_b64_tr_b16 v[82:83], v31 offset:37888
    v_mfma_f32_16x16x32_bf16 v[152:155], v[92:95], a[92:95], v[152:155]
    buffer_load_dwordx4 v1, s[16:19], s40 offen offset:2048 sc1 lds
    v_mfma_f32_16x16x32_bf16 v[156:159], v[96:99], a[80:83], v[156:159]
    ds_read_b128 a[136:139], v49 offset:10240
    v_mfma_f32_16x16x32_bf16 v[160:163], v[96:99], a[84:87], v[160:163]
    ds_read_b64_tr_b16 v[84:85], v28 offset:40960
    v_mfma_f32_16x16x32_bf16 v[164:167], v[96:99], a[88:91], v[164:167]
    ds_read_b64_tr_b16 v[86:87], v28 offset:41984
    v_mfma_f32_16x16x32_bf16 v[168:171], v[96:99], a[92:95], v[168:171]
    s_add_u32 m0, s37, 36864
    s_add_u32 s40, s43, 43008
    buffer_load_dwordx4 v1, s[16:19], s40 offen offset:0 sc1 lds
    s_waitcnt lgkmcnt(9)
    v_mfma_f32_16x16x32_bf16 v[188:191], v[100:103], a[48:51], v[188:191]
    ds_read_b128 a[140:143], v49 offset:10496
    v_mfma_f32_16x16x32_bf16 v[192:195], v[100:103], a[52:55], v[192:195]
    ds_read_b64_tr_b16 v[88:89], v31 offset:40960
    v_mfma_f32_16x16x32_bf16 v[196:199], v[100:103], a[56:59], v[196:199]
    ds_read_b64_tr_b16 v[90:91], v31 offset:41984
    v_mfma_f32_16x16x32_bf16 v[200:203], v[100:103], a[60:63], v[200:203]
    buffer_load_dwordx4 v1, s[16:19], s40 offen offset:1024 sc1 lds
    v_mfma_f32_16x16x32_bf16 v[204:207], v[104:107], a[48:51], v[204:207]
    buffer_load_dwordx4 v1, s[16:19], s40 offen offset:2048 sc1 lds
    v_mfma_f32_16x16x32_bf16 v[208:211], v[104:107], a[52:55], v[208:211]
    v_mfma_f32_16x16x32_bf16 v[212:215], v[104:107], a[56:59], v[212:215]
    v_mfma_f32_16x16x32_bf16 v[216:219], v[104:107], a[60:63], v[216:219]
    s_waitcnt vmcnt(10)
    v_mov_b32 v58, 3
    buffer_store_dword v58, v59, s[16:19], s46 offen sc1
    s_waitcnt lgkmcnt(0)
    v_mfma_f32_16x16x32_bf16 v[188:191], v[76:79], a[64:67], v[188:191]
    s_barrier
    v_mfma_f32_16x16x32_bf16 v[192:195], v[76:79], a[68:71], v[192:195]
    ds_read_b64_tr_b16 v[92:93], v27 offset:49152
    s_add_u32 m0, s37, 86016
    s_add_u32 s48, s48, s36
    s_add_u32 s40, s54, s48
    buffer_load_dwordx4 v15, s[12:15], s40 offen offset:0 lds
    v_mfma_f32_16x16x32_bf16 v[196:199], v[76:79], a[72:75], v[196:199]
    ds_read_b64_tr_b16 v[94:95], v27 offset:50176
    v_mfma_f32_16x16x32_bf16 v[200:203], v[76:79], a[76:79], v[200:203]
    ds_read_b64_tr_b16 v[96:97], v30 offset:49152
    v_mfma_f32_16x16x32_bf16 v[204:207], v[80:83], a[64:67], v[204:207]
    ds_read_b64_tr_b16 v[98:99], v30 offset:50176
    s_and_b32 s23, s2, 63
    v_mfma_f32_16x16x32_bf16 v[208:211], v[80:83], a[68:71], v[208:211]
    ds_read_b64_tr_b16 v[100:101], v27 offset:53248
    s_lshr_b32 s5, s23, 2
    v_mfma_f32_16x16x32_bf16 v[212:215], v[80:83], a[72:75], v[212:215]
    ds_read_b64_tr_b16 v[102:103], v27 offset:54272
    v_and_b32 v223, 15, v0
    v_mfma_f32_16x16x32_bf16 v[216:219], v[80:83], a[76:79], v[216:219]
    buffer_load_dwordx4 v16, s[12:15], s40 offen offset:1024 lds
    v_mfma_f32_16x16x32_bf16 v[188:191], v[84:87], a[80:83], v[188:191]
    s_branch L2_skip5
.p2align 12
L2_pad5:
    s_branch L2_ret5
    s_nop 0
L2_skip5:
    ds_read_b64_tr_b16 v[104:105], v30 offset:53248
    v_mfma_f32_16x16x32_bf16 v[192:195], v[84:87], a[84:87], v[192:195]
    ds_read_b64_tr_b16 v[106:107], v30 offset:54272
    s_lshr_b32 s7, s5, 3
    v_mfma_f32_16x16x32_bf16 v[196:199], v[84:87], a[88:91], v[196:199]
    buffer_load_dwordx4 v17, s[12:15], s40 offen offset:2048 lds
    v_mfma_f32_16x16x32_bf16 v[200:203], v[84:87], a[92:95], v[200:203]
    s_and_b32 s5, s5, 7
    v_mfma_f32_16x16x32_bf16 v[204:207], v[88:91], a[80:83], v[204:207]
    ds_read_b64_tr_b16 v[76:77], v27 offset:57344
    s_lshl_b32 s5, s5, 5
    v_mfma_f32_16x16x32_bf16 v[208:211], v[88:91], a[84:87], v[208:211]
    ds_read_b64_tr_b16 v[78:79], v27 offset:58368
    s_add_u32 s5, s5, s7
    v_mfma_f32_16x16x32_bf16 v[212:215], v[88:91], a[88:91], v[212:215]
    v_lshlrev_b32 v223, 1, v223
    s_lshl_b32 s5, s5, 8
    v_mfma_f32_16x16x32_bf16 v[216:219], v[88:91], a[92:95], v[216:219]
    s_add_u32 m0, s37, 98304
    s_sub_u32 s48, s48, s36
    s_add_u32 s40, s57, s48
    buffer_load_dwordx4 v18, s[12:15], s40 offen offset:0 lds
    s_waitcnt lgkmcnt(6)
    v_mfma_f32_16x16x32_bf16 v[140:143], v[92:95], a[96:99], v[140:143]
    ds_read_b64_tr_b16 v[80:81], v30 offset:57344
    v_mfma_f32_16x16x32_bf16 v[144:147], v[92:95], a[100:103], v[144:147]
    ds_read_b64_tr_b16 v[82:83], v30 offset:58368
    v_mfma_f32_16x16x32_bf16 v[148:151], v[92:95], a[104:107], v[148:151]
    s_add_u32 s5, s5, 48963584
    v_mfma_f32_16x16x32_bf16 v[152:155], v[92:95], a[108:111], v[152:155]
    buffer_load_dwordx4 v19, s[12:15], s40 offen offset:1024 lds
    v_mfma_f32_16x16x32_bf16 v[156:159], v[96:99], a[96:99], v[156:159]
    ds_read_b64_tr_b16 v[84:85], v28 offset:57344
    v_mfma_f32_16x16x32_bf16 v[160:163], v[96:99], a[100:103], v[160:163]
    ds_read_b64_tr_b16 v[86:87], v28 offset:58368
    v_lshlrev_b32 v223, 8, v223
    v_mfma_f32_16x16x32_bf16 v[164:167], v[96:99], a[104:107], v[164:167]
    v_add_u32 v223, s5, v223
    s_lshr_b32 s7, s28, 1
    v_mfma_f32_16x16x32_bf16 v[168:171], v[96:99], a[108:111], v[168:171]
    s_and_b32 s3, s28, 1
    s_lshr_b32 s5, s2, 6
    s_waitcnt lgkmcnt(6)
    v_mfma_f32_16x16x32_bf16 v[140:143], v[100:103], a[112:115], v[140:143]
    ds_read_b64_tr_b16 v[88:89], v31 offset:57344
    s_lshl_b32 s5, s5, 1
    v_mfma_f32_16x16x32_bf16 v[144:147], v[100:103], a[116:119], v[144:147]
    ds_read_b64_tr_b16 v[90:91], v31 offset:58368
    v_mfma_f32_16x16x32_bf16 v[148:151], v[100:103], a[120:123], v[148:151]
    buffer_load_dwordx4 v20, s[12:15], s40 offen offset:2048 lds
    v_mfma_f32_16x16x32_bf16 v[152:155], v[100:103], a[124:127], v[152:155]
    s_mul_i32 s20, s7, 30
    s_add_u32 s20, s20, s5
    v_mfma_f32_16x16x32_bf16 v[156:159], v[104:107], a[112:115], v[156:159]
    ds_read_b64_tr_b16 v[92:93], v28 offset:61440
    s_add_u32 s20, s20, s3
    v_mfma_f32_16x16x32_bf16 v[160:163], v[104:107], a[116:119], v[160:163]
    ds_read_b64_tr_b16 v[94:95], v28 offset:62464
    v_mfma_f32_16x16x32_bf16 v[164:167], v[104:107], a[120:123], v[164:167]
    buffer_load_dword v7, v6, s[16:19], s47 offen sc1
    v_mfma_f32_16x16x32_bf16 v[168:171], v[104:107], a[124:127], v[168:171]
    s_mul_i32 s22, s7, 6
    s_sub_u32 s22, 18, s22
    s_waitcnt lgkmcnt(6)
    v_mfma_f32_16x16x32_bf16 v[140:143], v[76:79], a[128:131], v[140:143]
    ds_read_b64_tr_b16 v[96:97], v31 offset:61440
    s_add_u32 s22, s22, s5
    v_mfma_f32_16x16x32_bf16 v[144:147], v[76:79], a[132:135], v[144:147]
    ds_read_b64_tr_b16 v[98:99], v31 offset:62464
    s_add_u32 s22, s22, s3
    v_mfma_f32_16x16x32_bf16 v[148:151], v[76:79], a[136:139], v[148:151]
    s_add_u32 m0, s37, 110592
    s_add_u32 s48, s48, s36
    s_add_u32 s40, s57, s48
    buffer_load_dwordx4 v18, s[12:15], s40 offen offset:0 lds
    v_mfma_f32_16x16x32_bf16 v[152:155], v[76:79], a[140:143], v[152:155]
    v_mfma_f32_16x16x32_bf16 v[156:159], v[80:83], a[128:131], v[156:159]
    ds_read_b64_tr_b16 v[100:101], v29 offset:0
    v_mfma_f32_16x16x32_bf16 v[160:163], v[80:83], a[132:135], v[160:163]
    ds_read_b64_tr_b16 v[102:103], v29 offset:1024
    s_mul_i32 s21, s3, 18
    v_mfma_f32_16x16x32_bf16 v[164:167], v[80:83], a[136:139], v[164:167]
    buffer_load_dwordx4 v19, s[12:15], s40 offen offset:1024 lds
    v_mfma_f32_16x16x32_bf16 v[168:171], v[80:83], a[140:143], v[168:171]
    s_add_u32 s21, s21, s5
    s_waitcnt lgkmcnt(6)
    v_mfma_f32_16x16x32_bf16 v[188:191], v[84:87], a[96:99], v[188:191]
    ds_read_b64_tr_b16 v[104:105], v32 offset:0
    s_add_u32 s21, s21, s7
    v_mfma_f32_16x16x32_bf16 v[192:195], v[84:87], a[100:103], v[192:195]
    ds_read_b64_tr_b16 v[106:107], v32 offset:1024
    s_add_u32 s21, s21, 6
    v_mfma_f32_16x16x32_bf16 v[196:199], v[84:87], a[104:107], v[196:199]
    s_add_u32 s5, s2, 64
    v_mfma_f32_16x16x32_bf16 v[200:203], v[84:87], a[108:111], v[200:203]
    buffer_load_dwordx4 v20, s[12:15], s40 offen offset:2048 lds
    v_mfma_f32_16x16x32_bf16 v[204:207], v[88:91], a[96:99], v[204:207]
    s_lshr_b32 s5, s5, 8
    s_lshl_b32 s5, s5, 30
    v_mfma_f32_16x16x32_bf16 v[208:211], v[88:91], a[100:103], v[208:211]
    s_mul_i32 s23, s23, 36864
    s_add_u32 s5, s5, s23
    v_mfma_f32_16x16x32_bf16 v[212:215], v[88:91], a[104:107], v[212:215]
    s_add_u32 s5, s5, 7340032
    s_sub_u32 s58, s5, 2555904
    v_mfma_f32_16x16x32_bf16 v[216:219], v[88:91], a[108:111], v[216:219]
    s_lshl_b32 s23, s20, 10
    s_waitcnt vmcnt(11) lgkmcnt(0)
    v_mfma_f32_16x16x32_bf16 v[188:191], v[92:95], a[112:115], v[188:191]
    s_barrier
    v_mfma_f32_16x16x32_bf16 v[192:195], v[92:95], a[116:119], v[192:195]
    s_cmp_eq_u32 s32, 0
    s_mov_b32 s39, 36864
    s_cselect_b32 s39, 12288, s39
    v_add_u32 v49, s39, v50
    v_mfma_f32_16x16x32_bf16 v[196:199], v[92:95], a[120:123], v[196:199]
    ds_read_b128 a[144:147], v49 offset:0
    s_add_u32 m0, s37, 49152
    s_add_u32 s48, s48, s36
    s_add_u32 s40, s52, s48
    buffer_load_dwordx4 v15, s[12:15], s40 offen offset:0 lds
    v_mfma_f32_16x16x32_bf16 v[200:203], v[92:95], a[124:127], v[200:203]
    ds_read_b128 a[148:151], v49 offset:256
    v_mfma_f32_16x16x32_bf16 v[204:207], v[96:99], a[112:115], v[204:207]
    ds_read_b128 a[152:155], v49 offset:6144
    v_mfma_f32_16x16x32_bf16 v[208:211], v[96:99], a[116:119], v[208:211]
    ds_read_b128 a[156:159], v49 offset:6400
    v_mfma_f32_16x16x32_bf16 v[212:215], v[96:99], a[120:123], v[212:215]
    ds_read_b64_tr_b16 v[76:77], v27 offset:0
    buffer_load_dwordx4 v16, s[12:15], s40 offen offset:1024 lds
    v_mfma_f32_16x16x32_bf16 v[216:219], v[96:99], a[124:127], v[216:219]
    ds_read_b64_tr_b16 v[78:79], v27 offset:1024
    buffer_load_dwordx4 v17, s[12:15], s40 offen offset:2048 lds
    v_mfma_f32_16x16x32_bf16 v[188:191], v[100:103], a[128:131], v[188:191]
    ds_read_b64_tr_b16 v[80:81], v30 offset:0
    v_mfma_f32_16x16x32_bf16 v[192:195], v[100:103], a[132:135], v[192:195]
    ds_read_b64_tr_b16 v[82:83], v30 offset:1024
    v_mfma_f32_16x16x32_bf16 v[196:199], v[100:103], a[136:139], v[196:199]
    ds_read_b128 a[160:163], v49 offset:2048
    v_mfma_f32_16x16x32_bf16 v[200:203], v[100:103], a[140:143], v[200:203]
    ds_read_b128 a[164:167], v49 offset:2304
    v_mfma_f32_16x16x32_bf16 v[204:207], v[104:107], a[128:131], v[204:207]
    ds_read_b128 a[168:171], v49 offset:8192
    v_mfma_f32_16x16x32_bf16 v[208:211], v[104:107], a[132:135], v[208:211]
    ds_read_b128 a[172:175], v49 offset:8448
    v_mfma_f32_16x16x32_bf16 v[212:215], v[104:107], a[136:139], v[212:215]
    ds_read_b64_tr_b16 v[84:85], v27 offset:4096
    v_mfma_f32_16x16x32_bf16 v[216:219], v[104:107], a[140:143], v[216:219]
    ds_read_b64_tr_b16 v[86:87], v27 offset:5120
    s_waitcnt lgkmcnt(6)
    v_mfma_f32_16x16x32_bf16 v[140:143], v[76:79], a[144:147], v[140:143]
    ds_read_b64_tr_b16 v[88:89], v30 offset:4096
    v_mfma_f32_16x16x32_bf16 v[144:147], v[76:79], a[148:151], v[144:147]
    ds_read_b64_tr_b16 v[90:91], v30 offset:5120
    v_mfma_f32_16x16x32_bf16 v[148:151], v[76:79], a[152:155], v[148:151]
    ds_read_b128 a[176:179], v49 offset:4096
    v_mfma_f32_16x16x32_bf16 v[152:155], v[76:79], a[156:159], v[152:155]
    ds_read_b128 a[180:183], v49 offset:4352
    v_mfma_f32_16x16x32_bf16 v[156:159], v[80:83], a[144:147], v[156:159]
    ds_read_b128 a[184:187], v49 offset:10240
    v_mfma_f32_16x16x32_bf16 v[160:163], v[80:83], a[148:151], v[160:163]
    ds_read_b128 a[188:191], v49 offset:10496
    v_mfma_f32_16x16x32_bf16 v[164:167], v[80:83], a[152:155], v[164:167]
    ds_read_b64_tr_b16 v[92:93], v27 offset:8192
    v_mfma_f32_16x16x32_bf16 v[168:171], v[80:83], a[156:159], v[168:171]
    ds_read_b64_tr_b16 v[94:95], v27 offset:9216
    s_waitcnt lgkmcnt(6)
    v_mfma_f32_16x16x32_bf16 v[140:143], v[84:87], a[160:163], v[140:143]
    ds_read_b64_tr_b16 v[96:97], v30 offset:8192
    v_mfma_f32_16x16x32_bf16 v[144:147], v[84:87], a[164:167], v[144:147]
    ds_read_b64_tr_b16 v[98:99], v30 offset:9216
    v_mfma_f32_16x16x32_bf16 v[148:151], v[84:87], a[168:171], v[148:151]
    ds_read_b64_tr_b16 v[100:101], v27 offset:61440
    s_waitcnt vmcnt(6)
    v_cmp_le_u32 vcc, 3, v7
    s_nop 0
    s_cmp_eq_u64 vcc, -1
    s_cbranch_scc0 L2_spin2
L2_ok2:
    v_mfma_f32_16x16x32_bf16 v[152:155], v[84:87], a[172:175], v[152:155]
    ds_read_b64_tr_b16 v[102:103], v27 offset:62464
    v_mfma_f32_16x16x32_bf16 v[156:159], v[88:91], a[160:163], v[156:159]
    ds_read_b64_tr_b16 v[104:105], v30 offset:61440
    v_mfma_f32_16x16x32_bf16 v[160:163], v[88:91], a[164:167], v[160:163]
    ds_read_b64_tr_b16 v[106:107], v30 offset:62464
    s_add_u32 m0, s37, 122880
    s_add_u32 s40, s43, 12288
    buffer_load_dwordx4 v1, s[16:19], s40 offen offset:0 sc1 lds
    v_mfma_f32_16x16x32_bf16 v[164:167], v[88:91], a[168:171], v[164:167]
    ds_read_b64_tr_b16 v[76:77], v28 offset:0
    v_mfma_f32_16x16x32_bf16 v[168:171], v[88:91], a[172:175], v[168:171]
    ds_read_b64_tr_b16 v[78:79], v28 offset:1024
    s_waitcnt lgkmcnt(6)
    v_mfma_f32_16x16x32_bf16 v[140:143], v[92:95], a[176:179], v[140:143]
    ds_read_b64_tr_b16 v[80:81], v31 offset:0
    v_mfma_f32_16x16x32_bf16 v[144:147], v[92:95], a[180:183], v[144:147]
    ds_read_b64_tr_b16 v[82:83], v31 offset:1024
    v_mfma_f32_16x16x32_bf16 v[148:151], v[92:95], a[184:187], v[148:151]
    buffer_load_dwordx4 v1, s[16:19], s40 offen offset:1024 sc1 lds
    v_mfma_f32_16x16x32_bf16 v[152:155], v[92:95], a[188:191], v[152:155]
    buffer_load_dwordx4 v1, s[16:19], s40 offen offset:2048 sc1 lds
    v_mfma_f32_16x16x32_bf16 v[156:159], v[96:99], a[176:179], v[156:159]
    ds_read_b64_tr_b16 v[84:85], v28 offset:4096
    v_mfma_f32_16x16x32_bf16 v[160:163], v[96:99], a[180:183], v[160:163]
    ds_read_b64_tr_b16 v[86:87], v28 offset:5120
    v_mfma_f32_16x16x32_bf16 v[164:167], v[96:99], a[184:187], v[164:167]
    s_add_u32 m0, s37, 24576
    s_add_u32 s40, s43, 49152
    buffer_load_dwordx4 v1, s[16:19], s40 offen offset:0 sc1 lds
    v_mfma_f32_16x16x32_bf16 v[168:171], v[96:99], a[188:191], v[168:171]
    s_waitcnt lgkmcnt(6)
    v_mfma_f32_16x16x32_bf16 v[188:191], v[100:103], a[144:147], v[188:191]
    ds_read_b64_tr_b16 v[88:89], v31 offset:4096
    s_add_u32 s23, s23, s5
    v_mfma_f32_16x16x32_bf16 v[192:195], v[100:103], a[148:151], v[192:195]
    ds_read_b64_tr_b16 v[90:91], v31 offset:5120
    s_and_b32 s6, s20, 1
    v_mfma_f32_16x16x32_bf16 v[196:199], v[100:103], a[152:155], v[196:199]
    buffer_load_dwordx4 v1, s[16:19], s40 offen offset:1024 sc1 lds
    v_mfma_f32_16x16x32_bf16 v[200:203], v[100:103], a[156:159], v[200:203]
    s_mul_i32 s6, s6, 768
    v_mfma_f32_16x16x32_bf16 v[204:207], v[104:107], a[144:147], v[204:207]
    buffer_load_dwordx4 v1, s[16:19], s40 offen offset:2048 sc1 lds
    v_mfma_f32_16x16x32_bf16 v[208:211], v[104:107], a[148:151], v[208:211]
    s_sub_u32 s23, s23, s6
    v_mfma_f32_16x16x32_bf16 v[212:215], v[104:107], a[152:155], v[212:215]
    s_lshl_b32 s7, s21, 10
    s_add_u32 s7, s7, s5
    v_mfma_f32_16x16x32_bf16 v[216:219], v[104:107], a[156:159], v[216:219]
    s_and_b32 s6, s21, 1
    s_mul_i32 s6, s6, 768
    s_waitcnt lgkmcnt(0)
    v_mfma_f32_16x16x32_bf16 v[188:191], v[76:79], a[160:163], v[188:191]
    s_barrier
    v_mfma_f32_16x16x32_bf16 v[192:195], v[76:79], a[164:167], v[192:195]
    ds_read_b128 a[192:195], v47 offset:49152
    v_mfma_f32_16x16x32_bf16 v[196:199], v[76:79], a[168:171], v[196:199]
    ds_read_b128 a[196:199], v47 offset:49408
    v_mfma_f32_16x16x32_bf16 v[200:203], v[76:79], a[172:175], v[200:203]
    ds_read_b128 a[200:203], v47 offset:50176
    v_mfma_f32_16x16x32_bf16 v[204:207], v[80:83], a[160:163], v[204:207]
    ds_read_b128 a[204:207], v47 offset:50432
    v_mfma_f32_16x16x32_bf16 v[208:211], v[80:83], a[164:167], v[208:211]
    ds_read_b64_tr_b16 v[92:93], v28 offset:8192
    s_add_u32 m0, s37, 0
    s_add_u32 s40, s53, s48
    buffer_load_dwordx4 v15, s[12:15], s40 offen offset:0 lds
    v_mfma_f32_16x16x32_bf16 v[212:215], v[80:83], a[168:171], v[212:215]
    ds_read_b64_tr_b16 v[94:95], v28 offset:9216
    buffer_load_dwordx4 v16, s[12:15], s40 offen offset:1024 lds
    v_mfma_f32_16x16x32_bf16 v[216:219], v[80:83], a[172:175], v[216:219]
    ds_read_b64_tr_b16 v[96:97], v31 offset:8192
    v_mfma_f32_16x16x32_bf16 v[188:191], v[84:87], a[176:179], v[188:191]
    ds_read_b64_tr_b16 v[98:99], v31 offset:9216
    v_mfma_f32_16x16x32_bf16 v[192:195], v[84:87], a[180:183], v[192:195]
    ds_read_b128 a[208:211], v47 offset:57344
    v_mfma_f32_16x16x32_bf16 v[196:199], v[84:87], a[184:187], v[196:199]
    ds_read_b128 a[212:215], v47 offset:57600
    v_mfma_f32_16x16x32_bf16 v[200:203], v[84:87], a[188:191], v[200:203]
    ds_read_b128 a[216:219], v47 offset:58368
    v_mfma_f32_16x16x32_bf16 v[204:207], v[88:91], a[176:179], v[204:207]
    ds_read_b128 a[220:223], v47 offset:58624
    v_mfma_f32_16x16x32_bf16 v[208:211], v[88:91], a[180:183], v[208:211]
    ds_read_b64_tr_b16 v[100:101], v28 offset:12288
    buffer_load_dwordx4 v17, s[12:15], s40 offen offset:2048 lds
    v_mfma_f32_16x16x32_bf16 v[212:215], v[88:91], a[184:187], v[212:215]
    ds_read_b64_tr_b16 v[102:103], v28 offset:13312
    v_mfma_f32_16x16x32_bf16 v[216:219], v[88:91], a[188:191], v[216:219]
    ds_read_b64_tr_b16 v[104:105], v31 offset:12288
    s_waitcnt lgkmcnt(7)
    v_mfma_f32_16x16x32_bf16 v[140:143], v[92:95], a[192:195], v[140:143]
    ds_read_b64_tr_b16 v[106:107], v31 offset:13312
    s_add_u32 m0, s37, 12288
    s_add_u32 s40, s54, s48
    buffer_load_dwordx4 v15, s[12:15], s40 offen offset:0 lds
    v_mfma_f32_16x16x32_bf16 v[144:147], v[92:95], a[196:199], v[144:147]
    ds_read_b128 a[224:227], v48 offset:0
    v_mfma_f32_16x16x32_bf16 v[148:151], v[92:95], a[200:203], v[148:151]
    ds_read_b128 a[228:231], v48 offset:256
    v_mfma_f32_16x16x32_bf16 v[152:155], v[92:95], a[204:207], v[152:155]
    ds_read_b128 a[232:235], v48 offset:1024
    v_mfma_f32_16x16x32_bf16 v[156:159], v[96:99], a[192:195], v[156:159]
    ds_read_b128 a[236:239], v48 offset:1280
    v_mfma_f32_16x16x32_bf16 v[160:163], v[96:99], a[196:199], v[160:163]
    ds_read_b64_tr_b16 v[76:77], v28 offset:16384
    buffer_load_dwordx4 v16, s[12:15], s40 offen offset:1024 lds
    v_mfma_f32_16x16x32_bf16 v[164:167], v[96:99], a[200:203], v[164:167]
    ds_read_b64_tr_b16 v[78:79], v28 offset:17408
    v_mfma_f32_16x16x32_bf16 v[168:171], v[96:99], a[204:207], v[168:171]
    ds_read_b64_tr_b16 v[80:81], v31 offset:16384
    s_waitcnt lgkmcnt(7)
    v_mfma_f32_16x16x32_bf16 v[140:143], v[100:103], a[208:211], v[140:143]
    ds_read_b64_tr_b16 v[82:83], v31 offset:17408
    v_mfma_f32_16x16x32_bf16 v[144:147], v[100:103], a[212:215], v[144:147]
    ds_read_b64_tr_b16 v[84:85], v28 offset:20480
    v_mfma_f32_16x16x32_bf16 v[148:151], v[100:103], a[216:219], v[148:151]
    ds_read_b64_tr_b16 v[86:87], v28 offset:21504
    v_mfma_f32_16x16x32_bf16 v[152:155], v[100:103], a[220:223], v[152:155]
    ds_read_b64_tr_b16 v[88:89], v31 offset:20480
    v_mfma_f32_16x16x32_bf16 v[156:159], v[104:107], a[208:211], v[156:159]
    ds_read_b64_tr_b16 v[90:91], v31 offset:21504
    v_mfma_f32_16x16x32_bf16 v[160:163], v[104:107], a[212:215], v[160:163]
    ds_read_b64_tr_b16 v[92:93], v28 offset:24576
    v_mfma_f32_16x16x32_bf16 v[164:167], v[104:107], a[216:219], v[164:167]
    ds_read_b64_tr_b16 v[94:95], v28 offset:25600
    v_mfma_f32_16x16x32_bf16 v[168:171], v[104:107], a[220:223], v[168:171]
    buffer_load_dwordx4 v17, s[12:15], s40 offen offset:2048 lds
    s_waitcnt lgkmcnt(6)
    v_mfma_f32_16x16x32_bf16 v[140:143], v[76:79], a[224:227], v[140:143]
    ds_read_b64_tr_b16 v[96:97], v31 offset:24576
    v_mfma_f32_16x16x32_bf16 v[144:147], v[76:79], a[228:231], v[144:147]
    ds_read_b64_tr_b16 v[98:99], v31 offset:25600
    s_sub_u32 s7, s7, s6
    v_mfma_f32_16x16x32_bf16 v[148:151], v[76:79], a[232:235], v[148:151]
    s_add_u32 m0, s37, 36864
    s_add_u32 s40, s55, s48
    buffer_load_dwordx4 v18, s[12:15], s40 offen offset:0 lds
    v_mfma_f32_16x16x32_bf16 v[152:155], v[76:79], a[236:239], v[152:155]
    v_mfma_f32_16x16x32_bf16 v[156:159], v[80:83], a[224:227], v[156:159]
    ds_read_b64_tr_b16 v[100:101], v28 offset:28672
    v_mfma_f32_16x16x32_bf16 v[160:163], v[80:83], a[228:231], v[160:163]
    ds_read_b64_tr_b16 v[102:103], v28 offset:29696
    s_lshl_b32 s3, s22, 10
    v_mfma_f32_16x16x32_bf16 v[164:167], v[80:83], a[232:235], v[164:167]
    buffer_load_dwordx4 v19, s[12:15], s40 offen offset:1024 lds
    v_mfma_f32_16x16x32_bf16 v[168:171], v[80:83], a[236:239], v[168:171]
    s_add_u32 s3, s3, s5
    s_waitcnt lgkmcnt(6)
    v_mfma_f32_16x16x32_bf16 v[188:191], v[84:87], a[192:195], v[188:191]
    ds_read_b64_tr_b16 v[104:105], v31 offset:28672
    s_and_b32 s6, s22, 1
    v_mfma_f32_16x16x32_bf16 v[192:195], v[84:87], a[196:199], v[192:195]
    ds_read_b64_tr_b16 v[106:107], v31 offset:29696
    s_mul_i32 s6, s6, 768
    v_mfma_f32_16x16x32_bf16 v[196:199], v[84:87], a[200:203], v[196:199]
    buffer_load_dwordx4 v20, s[12:15], s40 offen offset:2048 lds
    v_mfma_f32_16x16x32_bf16 v[200:203], v[84:87], a[204:207], v[200:203]
    s_sub_u32 s3, s3, s6
    v_mfma_f32_16x16x32_bf16 v[204:207], v[88:91], a[192:195], v[204:207]
    v_and_b32 v21, 16, v0
    v_and_b32 v22, 0x2f0, v1
    v_mfma_f32_16x16x32_bf16 v[208:211], v[88:91], a[196:199], v[208:211]
    v_lshl_add_u32 v21, v21, 6, v22
    v_mfma_f32_16x16x32_bf16 v[212:215], v[88:91], a[200:203], v[212:215]
    v_mfma_f32_16x16x32_bf16 v[216:219], v[88:91], a[204:207], v[216:219]
    s_waitcnt vmcnt(9) lgkmcnt(0)
    v_mfma_f32_16x16x32_bf16 v[188:191], v[92:95], a[208:211], v[188:191]
    s_barrier
    v_mfma_f32_16x16x32_bf16 v[192:195], v[92:95], a[212:215], v[192:195]
    s_cmp_eq_u32 s32, 0
    s_mov_b32 s39, 24576
    s_cselect_b32 s39, 122880, s39
    v_add_u32 v49, s39, v50
    v_mfma_f32_16x16x32_bf16 v[196:199], v[92:95], a[216:219], v[196:199]
    ds_read_b128 a[240:243], v49 offset:0
    s_add_u32 m0, s37, 86016
    s_add_u32 s40, s56, s48
    buffer_load_dwordx4 v18, s[12:15], s40 offen offset:0 lds
    v_mfma_f32_16x16x32_bf16 v[200:203], v[92:95], a[220:223], v[200:203]
    ds_read_b128 a[244:247], v49 offset:256
    v_mfma_f32_16x16x32_bf16 v[204:207], v[96:99], a[208:211], v[204:207]
    ds_read_b128 a[248:251], v49 offset:6144
    v_mfma_f32_16x16x32_bf16 v[208:211], v[96:99], a[212:215], v[208:211]
    ds_read_b128 a[252:255], v49 offset:6400
    v_mfma_f32_16x16x32_bf16 v[212:215], v[96:99], a[216:219], v[212:215]
    ds_read_b64_tr_b16 v[76:77], v28 offset:32768
    buffer_load_dwordx4 v19, s[12:15], s40 offen offset:1024 lds
    v_mfma_f32_16x16x32_bf16 v[216:219], v[96:99], a[220:223], v[216:219]
    ds_read_b64_tr_b16 v[78:79], v28 offset:33792
    v_mfma_f32_16x16x32_bf16 v[188:191], v[100:103], a[224:227], v[188:191]
    ds_read_b64_tr_b16 v[80:81], v31 offset:32768
    v_mfma_f32_16x16x32_bf16 v[192:195], v[100:103], a[228:231], v[192:195]
    ds_read_b64_tr_b16 v[82:83], v31 offset:33792
    v_mfma_f32_16x16x32_bf16 v[196:199], v[100:103], a[232:235], v[196:199]
    ds_read_b128 v[224:227], v49 offset:2048
    v_mfma_f32_16x16x32_bf16 v[200:203], v[100:103], a[236:239], v[200:203]
    ds_read_b128 v[228:231], v49 offset:2304
    v_mfma_f32_16x16x32_bf16 v[204:207], v[104:107], a[224:227], v[204:207]
    ds_read_b128 v[232:235], v49 offset:8192
    v_mfma_f32_16x16x32_bf16 v[208:211], v[104:107], a[228:231], v[208:211]
    ds_read_b128 v[236:239], v49 offset:8448
    v_mfma_f32_16x16x32_bf16 v[212:215], v[104:107], a[232:235], v[212:215]
    ds_read_b64_tr_b16 v[84:85], v28 offset:36864
    buffer_load_dwordx4 v20, s[12:15], s40 offen offset:2048 lds
    v_mfma_f32_16x16x32_bf16 v[216:219], v[104:107], a[236:239], v[216:219]
    ds_read_b64_tr_b16 v[86:87], v28 offset:37888
    s_waitcnt lgkmcnt(6)
    v_mfma_f32_16x16x32_bf16 v[140:143], v[76:79], a[240:243], v[140:143]
    ds_read_b64_tr_b16 v[88:89], v31 offset:36864
    s_add_u32 m0, s37, 135168
    s_add_u32 s40, s57, s48
    buffer_load_dwordx4 v18, s[12:15], s40 offen offset:0 lds
    v_mfma_f32_16x16x32_bf16 v[144:147], v[76:79], a[244:247], v[144:147]
    ds_read_b64_tr_b16 v[90:91], v31 offset:37888
    v_mfma_f32_16x16x32_bf16 v[148:151], v[76:79], a[248:251], v[148:151]
    ds_read_b128 v[240:243], v49 offset:4096
    v_mfma_f32_16x16x32_bf16 v[152:155], v[76:79], a[252:255], v[152:155]
    ds_read_b128 v[244:247], v49 offset:4352
    v_mfma_f32_16x16x32_bf16 v[156:159], v[80:83], a[240:243], v[156:159]
    ds_read_b128 v[248:251], v49 offset:10240
    v_mfma_f32_16x16x32_bf16 v[160:163], v[80:83], a[244:247], v[160:163]
    ds_read_b128 v[252:255], v49 offset:10496
    v_mfma_f32_16x16x32_bf16 v[164:167], v[80:83], a[248:251], v[164:167]
    ds_read_b64_tr_b16 v[92:93], v28 offset:40960
    buffer_load_dwordx4 v19, s[12:15], s40 offen offset:1024 lds
    v_mfma_f32_16x16x32_bf16 v[168:171], v[80:83], a[252:255], v[168:171]
    ds_read_b64_tr_b16 v[94:95], v28 offset:41984
    s_waitcnt lgkmcnt(6)
    v_mfma_f32_16x16x32_bf16 v[140:143], v[84:87], v[224:227], v[140:143]
    ds_read_b64_tr_b16 v[96:97], v31 offset:40960
    v_mfma_f32_16x16x32_bf16 v[144:147], v[84:87], v[228:231], v[144:147]
    ds_read_b64_tr_b16 v[98:99], v31 offset:41984
    v_mfma_f32_16x16x32_bf16 v[148:151], v[84:87], v[232:235], v[148:151]
    ds_read_b64_tr_b16 v[100:101], v28 offset:45056
    v_mfma_f32_16x16x32_bf16 v[152:155], v[84:87], v[236:239], v[152:155]
    ds_read_b64_tr_b16 v[102:103], v28 offset:46080
    buffer_load_dwordx4 v20, s[12:15], s40 offen offset:2048 lds
    v_mfma_f32_16x16x32_bf16 v[156:159], v[88:91], v[224:227], v[156:159]
    ds_read_b64_tr_b16 v[104:105], v31 offset:45056
    v_mfma_f32_16x16x32_bf16 v[160:163], v[88:91], v[228:231], v[160:163]
    ds_read_b64_tr_b16 v[106:107], v31 offset:46080
    v_mfma_f32_16x16x32_bf16 v[164:167], v[88:91], v[232:235], v[164:167]
    ds_read_b64_tr_b16 v[76:77], v28 offset:49152
    v_mfma_f32_16x16x32_bf16 v[168:171], v[88:91], v[236:239], v[168:171]
    ds_read_b64_tr_b16 v[78:79], v28 offset:50176
    s_waitcnt lgkmcnt(6)
    v_mfma_f32_16x16x32_bf16 v[140:143], v[92:95], v[240:243], v[140:143]
    ds_read_b64_tr_b16 v[80:81], v31 offset:49152
    v_mfma_f32_16x16x32_bf16 v[144:147], v[92:95], v[244:247], v[144:147]
    ds_read_b64_tr_b16 v[82:83], v31 offset:50176
    v_mfma_f32_16x16x32_bf16 v[148:151], v[92:95], v[248:251], v[148:151]
    s_add_u32 m0, s37, 147456
    s_add_u32 s48, s48, s36
    s_add_u32 s40, s52, s48
    buffer_load_dwordx4 v15, s[12:15], s40 offen offset:0 lds
    v_mfma_f32_16x16x32_bf16 v[152:155], v[92:95], v[252:255], v[152:155]
    v_mfma_f32_16x16x32_bf16 v[156:159], v[96:99], v[240:243], v[156:159]
    ds_read_b64_tr_b16 v[84:85], v28 offset:53248
    v_mfma_f32_16x16x32_bf16 v[160:163], v[96:99], v[244:247], v[160:163]
    ds_read_b64_tr_b16 v[86:87], v28 offset:54272
    v_mfma_f32_16x16x32_bf16 v[164:167], v[96:99], v[248:251], v[164:167]
    buffer_load_dwordx4 v16, s[12:15], s40 offen offset:1024 lds
    v_mfma_f32_16x16x32_bf16 v[168:171], v[96:99], v[252:255], v[168:171]
    s_waitcnt lgkmcnt(6)
    v_mfma_f32_16x16x32_bf16 v[188:191], v[100:103], a[240:243], v[188:191]
    ds_read_b64_tr_b16 v[88:89], v31 offset:53248
    v_mfma_f32_16x16x32_bf16 v[192:195], v[100:103], a[244:247], v[192:195]
    ds_read_b64_tr_b16 v[90:91], v31 offset:54272
    v_mfma_f32_16x16x32_bf16 v[196:199], v[100:103], a[248:251], v[196:199]
    buffer_load_dwordx4 v17, s[12:15], s40 offen offset:2048 lds
    v_mfma_f32_16x16x32_bf16 v[200:203], v[100:103], a[252:255], v[200:203]
    s_add_u32 s51, s44, 36864
    v_mfma_f32_16x16x32_bf16 v[204:207], v[104:107], a[240:243], v[204:207]
    v_cvt_pk_bf16_f32 v60, v140, v141
    v_cvt_pk_bf16_f32 v62, v144, v145
    v_mfma_f32_16x16x32_bf16 v[208:211], v[104:107], a[244:247], v[208:211]
    v_cvt_pk_bf16_f32 v61, v142, v143
    v_cvt_pk_bf16_f32 v63, v146, v147
    v_mfma_f32_16x16x32_bf16 v[212:215], v[104:107], a[248:251], v[212:215]
    v_permlane16_swap_b32 v60, v62
    v_permlane16_swap_b32 v61, v63
    v_mfma_f32_16x16x32_bf16 v[216:219], v[104:107], a[252:255], v[216:219]
    s_waitcnt vmcnt(12) lgkmcnt(0)
    v_mfma_f32_16x16x32_bf16 v[188:191], v[76:79], v[224:227], v[188:191]
    s_barrier
    v_mfma_f32_16x16x32_bf16 v[192:195], v[76:79], v[228:231], v[192:195]
    ds_read_b64_tr_b16 v[92:93], v27 offset:49152
    s_add_u32 m0, s37, 98304
    s_add_u32 s40, s53, s48
    buffer_load_dwordx4 v15, s[12:15], s40 offen offset:0 lds
    v_mfma_f32_16x16x32_bf16 v[196:199], v[76:79], v[232:235], v[196:199]
    ds_read_b64_tr_b16 v[94:95], v27 offset:50176
    v_mfma_f32_16x16x32_bf16 v[200:203], v[76:79], v[236:239], v[200:203]
    ds_read_b64_tr_b16 v[96:97], v30 offset:49152
    v_mfma_f32_16x16x32_bf16 v[204:207], v[80:83], v[224:227], v[204:207]
    ds_read_b64_tr_b16 v[98:99], v30 offset:50176
    v_mfma_f32_16x16x32_bf16 v[208:211], v[80:83], v[228:231], v[208:211]
    ds_read_b64_tr_b16 v[100:101], v27 offset:53248
    v_mfma_f32_16x16x32_bf16 v[212:215], v[80:83], v[232:235], v[212:215]
    ds_read_b64_tr_b16 v[102:103], v27 offset:54272
    v_mfma_f32_16x16x32_bf16 v[216:219], v[80:83], v[236:239], v[216:219]
    buffer_load_dwordx4 v16, s[12:15], s40 offen offset:1024 lds
    v_mfma_f32_16x16x32_bf16 v[188:191], v[84:87], v[240:243], v[188:191]
    ds_read_b64_tr_b16 v[104:105], v30 offset:53248
    v_mfma_f32_16x16x32_bf16 v[192:195], v[84:87], v[244:247], v[192:195]
    ds_read_b64_tr_b16 v[106:107], v30 offset:54272
    v_mfma_f32_16x16x32_bf16 v[196:199], v[84:87], v[248:251], v[196:199]
    buffer_load_dwordx4 v17, s[12:15], s40 offen offset:2048 lds
    v_mfma_f32_16x16x32_bf16 v[200:203], v[84:87], v[252:255], v[200:203]
    v_mfma_f32_16x16x32_bf16 v[204:207], v[88:91], v[240:243], v[204:207]
    ds_read_b64_tr_b16 v[76:77], v27 offset:57344
    v_mfma_f32_16x16x32_bf16 v[208:211], v[88:91], v[244:247], v[208:211]
    ds_read_b64_tr_b16 v[78:79], v27 offset:58368
    v_mfma_f32_16x16x32_bf16 v[212:215], v[88:91], v[248:251], v[212:215]
    buffer_store_dwordx4 v[60:63], v1, s[16:19], s44 offen offset:0 sc1
    v_mfma_f32_16x16x32_bf16 v[216:219], v[88:91], v[252:255], v[216:219]
    s_add_u32 m0, s37, 110592
    s_add_u32 s40, s54, s48
    buffer_load_dwordx4 v15, s[12:15], s40 offen offset:0 lds
    s_waitcnt lgkmcnt(6)
    v_mfma_f32_16x16x32_bf16 v[108:111], v[92:95], a[0:3], 0
    s_branch L2_skip6
.p2align 12
L2_pad6:
    s_branch L2_ret6
    s_nop 0
L2_skip6:
    ds_read_b64_tr_b16 v[80:81], v30 offset:57344
    v_mfma_f32_16x16x32_bf16 v[112:115], v[92:95], a[4:7], 0
    ds_read_b64_tr_b16 v[82:83], v30 offset:58368
    v_mfma_f32_16x16x32_bf16 v[116:119], v[92:95], a[8:11], 0
    v_mfma_f32_16x16x32_bf16 v[120:123], v[92:95], a[12:15], 0
    buffer_load_dwordx4 v16, s[12:15], s40 offen offset:1024 lds
    v_mfma_f32_16x16x32_bf16 v[124:127], v[96:99], a[0:3], 0
    ds_read_b64_tr_b16 v[84:85], v27 offset:0
    v_mfma_f32_16x16x32_bf16 v[128:131], v[96:99], a[4:7], 0
    ds_read_b64_tr_b16 v[86:87], v27 offset:1024
    v_mfma_f32_16x16x32_bf16 v[132:135], v[96:99], a[8:11], 0
    v_mfma_f32_16x16x32_bf16 v[136:139], v[96:99], a[12:15], 0
    v_cvt_pk_bf16_f32 v64, v148, v149
    v_cvt_pk_bf16_f32 v66, v152, v153
    s_waitcnt lgkmcnt(6)
    v_mfma_f32_16x16x32_bf16 v[108:111], v[100:103], a[16:19], v[108:111]
    ds_read_b64_tr_b16 v[88:89], v30 offset:0
    v_cvt_pk_bf16_f32 v65, v150, v151
    v_mfma_f32_16x16x32_bf16 v[112:115], v[100:103], a[20:23], v[112:115]
    ds_read_b64_tr_b16 v[90:91], v30 offset:1024
    v_cvt_pk_bf16_f32 v67, v154, v155
    v_mfma_f32_16x16x32_bf16 v[116:119], v[100:103], a[24:27], v[116:119]
    buffer_load_dwordx4 v17, s[12:15], s40 offen offset:2048 lds
    v_mfma_f32_16x16x32_bf16 v[120:123], v[100:103], a[28:31], v[120:123]
    v_permlane16_swap_b32 v64, v66
    v_mfma_f32_16x16x32_bf16 v[124:127], v[104:107], a[16:19], v[124:127]
    ds_read_b64_tr_b16 v[92:93], v27 offset:4096
    v_permlane16_swap_b32 v65, v67
    v_mfma_f32_16x16x32_bf16 v[128:131], v[104:107], a[20:23], v[128:131]
    ds_read_b64_tr_b16 v[94:95], v27 offset:5120
    v_mfma_f32_16x16x32_bf16 v[132:135], v[104:107], a[24:27], v[132:135]
    s_add_u32 m0, s37, 122880
    s_add_u32 s40, s55, s48
    buffer_load_dwordx4 v18, s[12:15], s40 offen offset:0 lds
    v_mfma_f32_16x16x32_bf16 v[136:139], v[104:107], a[28:31], v[136:139]
    s_waitcnt lgkmcnt(6)
    v_mfma_f32_16x16x32_bf16 v[108:111], v[76:79], a[32:35], v[108:111]
    ds_read_b64_tr_b16 v[96:97], v30 offset:4096
    v_mfma_f32_16x16x32_bf16 v[112:115], v[76:79], a[36:39], v[112:115]
    ds_read_b64_tr_b16 v[98:99], v30 offset:5120
    v_mfma_f32_16x16x32_bf16 v[116:119], v[76:79], a[40:43], v[116:119]
    buffer_load_dwordx4 v19, s[12:15], s40 offen offset:1024 lds
    v_mfma_f32_16x16x32_bf16 v[120:123], v[76:79], a[44:47], v[120:123]
    v_mfma_f32_16x16x32_bf16 v[124:127], v[80:83], a[32:35], v[124:127]
    ds_read_b64_tr_b16 v[100:101], v27 offset:8192
    buffer_store_dwordx4 v[64:67], v1, s[16:19], s51 offen offset:0 sc1
    v_mfma_f32_16x16x32_bf16 v[128:131], v[80:83], a[36:39], v[128:131]
    ds_read_b64_tr_b16 v[102:103], v27 offset:9216
    v_mfma_f32_16x16x32_bf16 v[132:135], v[80:83], a[40:43], v[132:135]
    buffer_load_dwordx4 v20, s[12:15], s40 offen offset:2048 lds
    v_mfma_f32_16x16x32_bf16 v[136:139], v[80:83], a[44:47], v[136:139]
    s_waitcnt lgkmcnt(6)
    v_mfma_f32_16x16x32_bf16 v[108:111], v[84:87], a[48:51], v[108:111]
    ds_read_b64_tr_b16 v[104:105], v30 offset:8192
    v_mfma_f32_16x16x32_bf16 v[112:115], v[84:87], a[52:55], v[112:115]
    ds_read_b64_tr_b16 v[106:107], v30 offset:9216
    v_cvt_pk_bf16_f32 v68, v156, v157
    v_mfma_f32_16x16x32_bf16 v[116:119], v[84:87], a[56:59], v[116:119]
    v_cvt_pk_bf16_f32 v70, v160, v161
    v_cvt_pk_bf16_f32 v69, v158, v159
    v_mfma_f32_16x16x32_bf16 v[120:123], v[84:87], a[60:63], v[120:123]
    s_add_u32 m0, s37, 24576
    s_add_u32 s40, s56, s48
    buffer_load_dwordx4 v18, s[12:15], s40 offen offset:0 lds
    v_mfma_f32_16x16x32_bf16 v[124:127], v[88:91], a[48:51], v[124:127]
    ds_read_b64_tr_b16 v[76:77], v27 offset:12288
    v_mfma_f32_16x16x32_bf16 v[128:131], v[88:91], a[52:55], v[128:131]
    ds_read_b64_tr_b16 v[78:79], v27 offset:13312
    v_mfma_f32_16x16x32_bf16 v[132:135], v[88:91], a[56:59], v[132:135]
    v_mfma_f32_16x16x32_bf16 v[136:139], v[88:91], a[60:63], v[136:139]
    v_cvt_pk_bf16_f32 v71, v162, v163
    v_permlane16_swap_b32 v68, v70
    s_waitcnt lgkmcnt(6)
    v_mfma_f32_16x16x32_bf16 v[108:111], v[92:95], a[64:67], v[108:111]
    ds_read_b64_tr_b16 v[80:81], v30 offset:12288
    v_permlane16_swap_b32 v69, v71
    v_mfma_f32_16x16x32_bf16 v[112:115], v[92:95], a[68:71], v[112:115]
    ds_read_b64_tr_b16 v[82:83], v30 offset:13312
    v_mfma_f32_16x16x32_bf16 v[116:119], v[92:95], a[72:75], v[116:119]
    buffer_load_dwordx4 v19, s[12:15], s40 offen offset:1024 lds
    v_mfma_f32_16x16x32_bf16 v[120:123], v[92:95], a[76:79], v[120:123]
    v_mfma_f32_16x16x32_bf16 v[124:127], v[96:99], a[64:67], v[124:127]
    ds_read_b64_tr_b16 v[84:85], v27 offset:16384
    v_mfma_f32_16x16x32_bf16 v[128:131], v[96:99], a[68:71], v[128:131]
    ds_read_b64_tr_b16 v[86:87], v27 offset:17408
    buffer_store_dwordx4 v[68:71], v1, s[16:19], s44 offen offset:1024 sc1
    v_mfma_f32_16x16x32_bf16 v[132:135], v[96:99], a[72:75], v[132:135]
    buffer_load_dwordx4 v20, s[12:15], s40 offen offset:2048 lds
    v_mfma_f32_16x16x32_bf16 v[136:139], v[96:99], a[76:79], v[136:139]
    s_waitcnt lgkmcnt(6)
    v_mfma_f32_16x16x32_bf16 v[108:111], v[100:103], a[80:83], v[108:111]
    ds_read_b64_tr_b16 v[88:89], v30 offset:16384
    v_mfma_f32_16x16x32_bf16 v[112:115], v[100:103], a[84:87], v[112:115]
    ds_read_b64_tr_b16 v[90:91], v30 offset:17408
    v_mfma_f32_16x16x32_bf16 v[116:119], v[100:103], a[88:91], v[116:119]
    s_add_u32 m0, s37, 61440
    s_add_u32 s40, s57, s48
    buffer_load_dwordx4 v18, s[12:15], s40 offen offset:0 lds
    v_mfma_f32_16x16x32_bf16 v[120:123], v[100:103], a[92:95], v[120:123]
    v_mfma_f32_16x16x32_bf16 v[124:127], v[104:107], a[80:83], v[124:127]
    ds_read_b64_tr_b16 v[92:93], v27 offset:20480
    v_mfma_f32_16x16x32_bf16 v[128:131], v[104:107], a[84:87], v[128:131]
    ds_read_b64_tr_b16 v[94:95], v27 offset:21504
    v_cvt_pk_bf16_f32 v72, v164, v165
    v_mfma_f32_16x16x32_bf16 v[132:135], v[104:107], a[88:91], v[132:135]
    buffer_load_dwordx4 v19, s[12:15], s40 offen offset:1024 lds
    v_mfma_f32_16x16x32_bf16 v[136:139], v[104:107], a[92:95], v[136:139]
    v_cvt_pk_bf16_f32 v74, v168, v169
    s_waitcnt lgkmcnt(6)
    v_mfma_f32_16x16x32_bf16 v[108:111], v[76:79], a[192:195], v[108:111]
    ds_read_b64_tr_b16 v[96:97], v30 offset:20480
    v_cvt_pk_bf16_f32 v73, v166, v167
    v_mfma_f32_16x16x32_bf16 v[112:115], v[76:79], a[196:199], v[112:115]
    ds_read_b64_tr_b16 v[98:99], v30 offset:21504
    v_cvt_pk_bf16_f32 v75, v170, v171
    v_mfma_f32_16x16x32_bf16 v[116:119], v[76:79], a[200:203], v[116:119]
    v_permlane16_swap_b32 v72, v74
    v_permlane16_swap_b32 v73, v75
    v_mfma_f32_16x16x32_bf16 v[120:123], v[76:79], a[204:207], v[120:123]
    buffer_load_dwordx4 v20, s[12:15], s40 offen offset:2048 lds
    v_mfma_f32_16x16x32_bf16 v[124:127], v[80:83], a[192:195], v[124:127]
    v_mfma_f32_16x16x32_bf16 v[128:131], v[80:83], a[196:199], v[128:131]
    v_mfma_f32_16x16x32_bf16 v[132:135], v[80:83], a[200:203], v[132:135]
    buffer_store_dwordx4 v[72:75], v1, s[16:19], s51 offen offset:1024 sc1
    v_mfma_f32_16x16x32_bf16 v[136:139], v[80:83], a[204:207], v[136:139]
    s_waitcnt vmcnt(22) lgkmcnt(0)
    v_mfma_f32_16x16x32_bf16 v[108:111], v[84:87], a[208:211], v[108:111]
    s_barrier
    v_mfma_f32_16x16x32_bf16 v[112:115], v[84:87], a[212:215], v[112:115]
    ds_read_b64_tr_b16 v[100:101], v27 offset:36864
    v_mfma_f32_16x16x32_bf16 v[116:119], v[84:87], a[216:219], v[116:119]
    ds_read_b64_tr_b16 v[102:103], v27 offset:37888
    v_mfma_f32_16x16x32_bf16 v[120:123], v[84:87], a[220:223], v[120:123]
    ds_read_b64_tr_b16 v[104:105], v30 offset:36864
    v_mfma_f32_16x16x32_bf16 v[124:127], v[88:91], a[208:211], v[124:127]
    ds_read_b64_tr_b16 v[106:107], v30 offset:37888
    v_mfma_f32_16x16x32_bf16 v[128:131], v[88:91], a[212:215], v[128:131]
    ds_read_b64_tr_b16 v[76:77], v27 offset:40960
    v_mfma_f32_16x16x32_bf16 v[132:135], v[88:91], a[216:219], v[132:135]
    ds_read_b64_tr_b16 v[78:79], v27 offset:41984
    s_add_u32 s44, s44, s49
    v_mfma_f32_16x16x32_bf16 v[136:139], v[88:91], a[220:223], v[136:139]
    s_add_u32 m0, s37, 49152
    s_add_u32 s48, s48, s36
    s_add_u32 s40, s52, s48
    buffer_load_dwordx4 v15, s[12:15], s40 offen offset:0 lds
    v_mfma_f32_16x16x32_bf16 v[108:111], v[92:95], a[224:227], v[108:111]
    ds_read_b64_tr_b16 v[80:81], v30 offset:40960
    v_mfma_f32_16x16x32_bf16 v[112:115], v[92:95], a[228:231], v[112:115]
    ds_read_b64_tr_b16 v[82:83], v30 offset:41984
    v_mfma_f32_16x16x32_bf16 v[116:119], v[92:95], a[232:235], v[116:119]
    v_mfma_f32_16x16x32_bf16 v[120:123], v[92:95], a[236:239], v[120:123]
    s_add_u32 s51, s44, 36864
    v_mfma_f32_16x16x32_bf16 v[124:127], v[96:99], a[224:227], v[124:127]
    ds_read_b64_tr_b16 v[84:85], v27 offset:45056
    v_mfma_f32_16x16x32_bf16 v[128:131], v[96:99], a[228:231], v[128:131]
    ds_read_b64_tr_b16 v[86:87], v27 offset:46080
    v_cvt_pk_bf16_f32 v60, v188, v189
    v_mfma_f32_16x16x32_bf16 v[132:135], v[96:99], a[232:235], v[132:135]
    buffer_load_dwordx4 v16, s[12:15], s40 offen offset:1024 lds
    v_mfma_f32_16x16x32_bf16 v[136:139], v[96:99], a[236:239], v[136:139]
    s_waitcnt lgkmcnt(6)
    v_mfma_f32_16x16x32_bf16 v[108:111], v[100:103], a[96:99], v[108:111]
    ds_read_b64_tr_b16 v[88:89], v30 offset:45056
    v_cvt_pk_bf16_f32 v62, v192, v193
    v_mfma_f32_16x16x32_bf16 v[112:115], v[100:103], a[100:103], v[112:115]
    ds_read_b64_tr_b16 v[90:91], v30 offset:46080
    v_mfma_f32_16x16x32_bf16 v[116:119], v[100:103], a[104:107], v[116:119]
    v_cvt_pk_bf16_f32 v61, v190, v191
    v_cvt_pk_bf16_f32 v63, v194, v195
    v_mfma_f32_16x16x32_bf16 v[120:123], v[100:103], a[108:111], v[120:123]
    v_permlane16_swap_b32 v60, v62
    v_mfma_f32_16x16x32_bf16 v[124:127], v[104:107], a[96:99], v[124:127]
    ds_read_b64_tr_b16 v[92:93], v28 offset:20480
    v_permlane16_swap_b32 v61, v63
    v_mfma_f32_16x16x32_bf16 v[128:131], v[104:107], a[100:103], v[128:131]
    ds_read_b64_tr_b16 v[94:95], v28 offset:21504
    v_mfma_f32_16x16x32_bf16 v[132:135], v[104:107], a[104:107], v[132:135]
    v_mfma_f32_16x16x32_bf16 v[136:139], v[104:107], a[108:111], v[136:139]
    buffer_store_dwordx4 v[60:63], v1, s[16:19], s44 offen offset:0 sc1
    s_waitcnt lgkmcnt(6)
    v_mfma_f32_16x16x32_bf16 v[108:111], v[76:79], a[112:115], v[108:111]
    ds_read_b64_tr_b16 v[96:97], v31 offset:20480
    v_mfma_f32_16x16x32_bf16 v[112:115], v[76:79], a[116:119], v[112:115]
    ds_read_b64_tr_b16 v[98:99], v31 offset:21504
    v_mfma_f32_16x16x32_bf16 v[116:119], v[76:79], a[120:123], v[116:119]
    buffer_load_dwordx4 v17, s[12:15], s40 offen offset:2048 lds
    v_mfma_f32_16x16x32_bf16 v[120:123], v[76:79], a[124:127], v[120:123]
    v_mfma_f32_16x16x32_bf16 v[124:127], v[80:83], a[112:115], v[124:127]
    ds_read_b64_tr_b16 v[100:101], v28 offset:24576
    v_mfma_f32_16x16x32_bf16 v[128:131], v[80:83], a[116:119], v[128:131]
    ds_read_b64_tr_b16 v[102:103], v28 offset:25600
    v_mfma_f32_16x16x32_bf16 v[132:135], v[80:83], a[120:123], v[132:135]
    v_cvt_pk_bf16_f32 v64, v196, v197
    v_mfma_f32_16x16x32_bf16 v[136:139], v[80:83], a[124:127], v[136:139]
    v_cvt_pk_bf16_f32 v66, v200, v201
    v_cvt_pk_bf16_f32 v65, v198, v199
    s_waitcnt lgkmcnt(6)
    v_mfma_f32_16x16x32_bf16 v[108:111], v[84:87], a[128:131], v[108:111]
    ds_read_b64_tr_b16 v[104:105], v31 offset:24576
    v_mfma_f32_16x16x32_bf16 v[112:115], v[84:87], a[132:135], v[112:115]
    ds_read_b64_tr_b16 v[106:107], v31 offset:25600
    v_cvt_pk_bf16_f32 v67, v202, v203
    v_mfma_f32_16x16x32_bf16 v[116:119], v[84:87], a[136:139], v[116:119]
    v_permlane16_swap_b32 v64, v66
    v_permlane16_swap_b32 v65, v67
    v_mfma_f32_16x16x32_bf16 v[120:123], v[84:87], a[140:143], v[120:123]
    v_mfma_f32_16x16x32_bf16 v[124:127], v[88:91], a[128:131], v[124:127]
    ds_read_b64_tr_b16 v[76:77], v28 offset:28672
    v_mfma_f32_16x16x32_bf16 v[128:131], v[88:91], a[132:135], v[128:131]
    ds_read_b64_tr_b16 v[78:79], v28 offset:29696
    v_mfma_f32_16x16x32_bf16 v[132:135], v[88:91], a[136:139], v[132:135]
    s_add_u32 m0, s37, 73728
    s_add_u32 s40, s53, s48
    buffer_load_dwordx4 v15, s[12:15], s40 offen offset:0 lds
    v_mfma_f32_16x16x32_bf16 v[136:139], v[88:91], a[140:143], v[136:139]
    s_waitcnt lgkmcnt(6)
    v_mfma_f32_16x16x32_bf16 v[108:111], v[92:95], a[144:147], v[108:111]
    ds_read_b64_tr_b16 v[80:81], v31 offset:28672
    v_mfma_f32_16x16x32_bf16 v[112:115], v[92:95], a[148:151], v[112:115]
    ds_read_b64_tr_b16 v[82:83], v31 offset:29696
    v_mfma_f32_16x16x32_bf16 v[116:119], v[92:95], a[152:155], v[116:119]
    buffer_store_dwordx4 v[64:67], v1, s[16:19], s51 offen offset:0 sc1
    v_mfma_f32_16x16x32_bf16 v[120:123], v[92:95], a[156:159], v[120:123]
    v_mfma_f32_16x16x32_bf16 v[124:127], v[96:99], a[144:147], v[124:127]
    ds_read_b64_tr_b16 v[84:85], v29 offset:4096
    v_mfma_f32_16x16x32_bf16 v[128:131], v[96:99], a[148:151], v[128:131]
    ds_read_b64_tr_b16 v[86:87], v29 offset:5120
    v_mfma_f32_16x16x32_bf16 v[132:135], v[96:99], a[152:155], v[132:135]
    v_cvt_pk_bf16_f32 v68, v204, v205
    v_mfma_f32_16x16x32_bf16 v[136:139], v[96:99], a[156:159], v[136:139]
    v_cvt_pk_bf16_f32 v70, v208, v209
    v_cvt_pk_bf16_f32 v69, v206, v207
    s_waitcnt lgkmcnt(6)
    v_mfma_f32_16x16x32_bf16 v[108:111], v[100:103], a[160:163], v[108:111]
    ds_read_b64_tr_b16 v[88:89], v32 offset:4096
    v_mfma_f32_16x16x32_bf16 v[112:115], v[100:103], a[164:167], v[112:115]
    ds_read_b64_tr_b16 v[90:91], v32 offset:5120
    v_cvt_pk_bf16_f32 v71, v210, v211
    v_mfma_f32_16x16x32_bf16 v[116:119], v[100:103], a[168:171], v[116:119]
    buffer_load_dwordx4 v16, s[12:15], s40 offen offset:1024 lds
    v_mfma_f32_16x16x32_bf16 v[120:123], v[100:103], a[172:175], v[120:123]
    v_mfma_f32_16x16x32_bf16 v[124:127], v[104:107], a[160:163], v[124:127]
    ds_read_b64_tr_b16 v[92:93], v29 offset:8192
    v_permlane16_swap_b32 v68, v70
    v_mfma_f32_16x16x32_bf16 v[128:131], v[104:107], a[164:167], v[128:131]
    ds_read_b64_tr_b16 v[94:95], v29 offset:9216
    v_mfma_f32_16x16x32_bf16 v[132:135], v[104:107], a[168:171], v[132:135]
    v_permlane16_swap_b32 v69, v71
    v_mfma_f32_16x16x32_bf16 v[136:139], v[104:107], a[172:175], v[136:139]
    s_waitcnt lgkmcnt(6)
    v_mfma_f32_16x16x32_bf16 v[108:111], v[76:79], a[176:179], v[108:111]
    ds_read_b64_tr_b16 v[96:97], v32 offset:8192
    v_mfma_f32_16x16x32_bf16 v[112:115], v[76:79], a[180:183], v[112:115]
    ds_read_b64_tr_b16 v[98:99], v32 offset:9216
    buffer_store_dwordx4 v[68:71], v1, s[16:19], s44 offen offset:1024 sc1
    v_mfma_f32_16x16x32_bf16 v[116:119], v[76:79], a[184:187], v[116:119]
    v_mfma_f32_16x16x32_bf16 v[120:123], v[76:79], a[188:191], v[120:123]
    v_mfma_f32_16x16x32_bf16 v[124:127], v[80:83], a[176:179], v[124:127]
    ds_read_b64_tr_b16 v[100:101], v29 offset:12288
    v_cvt_pk_bf16_f32 v72, v212, v213
    v_mfma_f32_16x16x32_bf16 v[128:131], v[80:83], a[180:183], v[128:131]
    ds_read_b64_tr_b16 v[102:103], v29 offset:13312
    v_cvt_pk_bf16_f32 v74, v216, v217
    v_mfma_f32_16x16x32_bf16 v[132:135], v[80:83], a[184:187], v[132:135]
    buffer_load_dwordx4 v17, s[12:15], s40 offen offset:2048 lds
    v_mfma_f32_16x16x32_bf16 v[136:139], v[80:83], a[188:191], v[136:139]
    s_waitcnt lgkmcnt(6)
    v_mfma_f32_16x16x32_bf16 v[108:111], v[84:87], a[240:243], v[108:111]
    ds_read_b64_tr_b16 v[104:105], v32 offset:12288
    v_cvt_pk_bf16_f32 v73, v214, v215
    v_mfma_f32_16x16x32_bf16 v[112:115], v[84:87], a[244:247], v[112:115]
    ds_read_b64_tr_b16 v[106:107], v32 offset:13312
    v_mfma_f32_16x16x32_bf16 v[116:119], v[84:87], a[248:251], v[116:119]
    v_cvt_pk_bf16_f32 v75, v218, v219
    v_permlane16_swap_b32 v72, v74
    v_mfma_f32_16x16x32_bf16 v[120:123], v[84:87], a[252:255], v[120:123]
    v_permlane16_swap_b32 v73, v75
    v_mfma_f32_16x16x32_bf16 v[124:127], v[88:91], a[240:243], v[124:127]
    v_mfma_f32_16x16x32_bf16 v[128:131], v[88:91], a[244:247], v[128:131]
    buffer_store_dwordx4 v[72:75], v1, s[16:19], s51 offen offset:1024 sc1
    v_mfma_f32_16x16x32_bf16 v[132:135], v[88:91], a[248:251], v[132:135]
    v_mfma_f32_16x16x32_bf16 v[136:139], v[88:91], a[252:255], v[136:139]
    s_waitcnt vmcnt(22) lgkmcnt(0)
    v_mfma_f32_16x16x32_bf16 v[108:111], v[92:95], v[224:227], v[108:111]
    s_barrier
    v_mfma_f32_16x16x32_bf16 v[112:115], v[92:95], v[228:231], v[112:115]
    ds_read_b64_tr_b16 v[76:77], v29 offset:16384
    v_mfma_f32_16x16x32_bf16 v[116:119], v[92:95], v[232:235], v[116:119]
    ds_read_b64_tr_b16 v[78:79], v29 offset:17408
    v_mfma_f32_16x16x32_bf16 v[120:123], v[92:95], v[236:239], v[120:123]
    ds_read_b64_tr_b16 v[80:81], v32 offset:16384
    v_mfma_f32_16x16x32_bf16 v[124:127], v[96:99], v[224:227], v[124:127]
    ds_read_b64_tr_b16 v[82:83], v32 offset:17408
    v_mfma_f32_16x16x32_bf16 v[128:131], v[96:99], v[228:231], v[128:131]
    ds_read_b64_tr_b16 v[84:85], v29 offset:20480
    v_mfma_f32_16x16x32_bf16 v[132:135], v[96:99], v[232:235], v[132:135]
    ds_read_b64_tr_b16 v[86:87], v29 offset:21504
    v_mfma_f32_16x16x32_bf16 v[136:139], v[96:99], v[236:239], v[136:139]
    s_add_u32 m0, s37, 86016
    s_add_u32 s40, s54, s48
    buffer_load_dwordx4 v15, s[12:15], s40 offen offset:0 lds
    v_mfma_f32_16x16x32_bf16 v[108:111], v[100:103], v[240:243], v[108:111]
    ds_read_b64_tr_b16 v[88:89], v32 offset:20480
    v_mfma_f32_16x16x32_bf16 v[112:115], v[100:103], v[244:247], v[112:115]
    ds_read_b64_tr_b16 v[90:91], v32 offset:21504
    v_mfma_f32_16x16x32_bf16 v[116:119], v[100:103], v[248:251], v[116:119]
    buffer_load_dwordx4 v16, s[12:15], s40 offen offset:1024 lds
    v_mfma_f32_16x16x32_bf16 v[120:123], v[100:103], v[252:255], v[120:123]
    v_mfma_f32_16x16x32_bf16 v[124:127], v[104:107], v[240:243], v[124:127]
    ds_read_b64_tr_b16 v[92:93], v29 offset:24576
    v_mfma_f32_16x16x32_bf16 v[128:131], v[104:107], v[244:247], v[128:131]
    ds_read_b64_tr_b16 v[94:95], v29 offset:25600
    v_mfma_f32_16x16x32_bf16 v[132:135], v[104:107], v[248:251], v[132:135]
    v_mfma_f32_16x16x32_bf16 v[136:139], v[104:107], v[252:255], v[136:139]
    buffer_load_dwordx4 v17, s[12:15], s40 offen offset:2048 lds
    s_waitcnt lgkmcnt(6)
    v_mfma_f32_16x16x32_bf16 v[140:143], v[76:79], a[0:3], 0
    ds_read_b64_tr_b16 v[96:97], v32 offset:24576
    v_mfma_f32_16x16x32_bf16 v[144:147], v[76:79], a[4:7], 0
    ds_read_b64_tr_b16 v[98:99], v32 offset:25600
    v_mfma_f32_16x16x32_bf16 v[148:151], v[76:79], a[8:11], 0
    s_add_u32 s44, s44, s49
    s_add_u32 s51, s44, 36864
    v_mfma_f32_16x16x32_bf16 v[152:155], v[76:79], a[12:15], 0
    v_cvt_pk_bf16_f32 v60, v108, v109
    s_and_b32 s29, s2, 63
    s_lshr_b32 s30, s2, 6
    v_mfma_f32_16x16x32_bf16 v[156:159], v[80:83], a[0:3], 0
    ds_read_b64_tr_b16 v[100:101], v28 offset:32768
    v_cvt_pk_bf16_f32 v62, v112, v113
    v_mfma_f32_16x16x32_bf16 v[160:163], v[80:83], a[4:7], 0
    ds_read_b64_tr_b16 v[102:103], v28 offset:33792
    s_and_b32 s31, s28, 1
    v_mfma_f32_16x16x32_bf16 v[164:167], v[80:83], a[8:11], 0
    s_add_u32 m0, s37, 135168
    s_add_u32 s40, s55, s48
    buffer_load_dwordx4 v18, s[12:15], s40 offen offset:0 lds
    v_mfma_f32_16x16x32_bf16 v[168:171], v[80:83], a[12:15], 0
    s_waitcnt lgkmcnt(6)
    v_mfma_f32_16x16x32_bf16 v[140:143], v[84:87], a[16:19], v[140:143]
    ds_read_b64_tr_b16 v[104:105], v31 offset:32768
    s_lshr_b32 s32, s28, 1
    v_and_b32 v5, 31, v0
    v_mfma_f32_16x16x32_bf16 v[144:147], v[84:87], a[20:23], v[144:147]
    ds_read_b64_tr_b16 v[106:107], v31 offset:33792
    v_bfe_u32 v6, v0, 5, 1
    v_mfma_f32_16x16x32_bf16 v[148:151], v[84:87], a[24:27], v[148:151]
    v_cvt_pk_bf16_f32 v61, v110, v111
    s_mul_i32 s43, s29, 1152
    v_mfma_f32_16x16x32_bf16 v[152:155], v[84:87], a[28:31], v[152:155]
    v_cvt_pk_bf16_f32 v63, v114, v115
    v_permlane16_swap_b32 v60, v62
    s_and_b32 s42, s20, 1
    v_mfma_f32_16x16x32_bf16 v[156:159], v[88:91], a[16:19], v[156:159]
    ds_read_b64_tr_b16 v[76:77], v28 offset:36864
    s_mul_i32 s96, s42, 1179616
    v_mfma_f32_16x16x32_bf16 v[160:163], v[88:91], a[20:23], v[160:163]
    ds_read_b64_tr_b16 v[78:79], v28 offset:37888
    v_permlane16_swap_b32 v61, v63
    v_mfma_f32_16x16x32_bf16 v[164:167], v[88:91], a[24:27], v[164:167]
    buffer_load_dwordx4 v19, s[12:15], s40 offen offset:1024 lds
    v_mfma_f32_16x16x32_bf16 v[168:171], v[88:91], a[28:31], v[168:171]
    s_lshl_b32 s42, s20, 5
    s_add_u32 s96, s96, s42
    s_waitcnt lgkmcnt(6)
    v_mfma_f32_16x16x32_bf16 v[140:143], v[92:95], a[32:35], v[140:143]
    ds_read_b64_tr_b16 v[80:81], v31 offset:36864
    s_add_u32 s96, s96, s43
    s_and_b32 s42, s21, 1
    v_mfma_f32_16x16x32_bf16 v[144:147], v[92:95], a[36:39], v[144:147]
    ds_read_b64_tr_b16 v[82:83], v31 offset:37888
    s_mul_i32 s97, s42, 1179616
    v_mfma_f32_16x16x32_bf16 v[148:151], v[92:95], a[40:43], v[148:151]
    buffer_store_dwordx4 v[60:63], v1, s[16:19], s44 offen offset:0 sc1
    v_mfma_f32_16x16x32_bf16 v[152:155], v[92:95], a[44:47], v[152:155]
    v_mfma_f32_16x16x32_bf16 v[156:159], v[96:99], a[32:35], v[156:159]
    ds_read_b64_tr_b16 v[84:85], v28 offset:40960
    v_mfma_f32_16x16x32_bf16 v[160:163], v[96:99], a[36:39], v[160:163]
    ds_read_b64_tr_b16 v[86:87], v28 offset:41984
    s_lshl_b32 s42, s21, 5
    v_mfma_f32_16x16x32_bf16 v[164:167], v[96:99], a[40:43], v[164:167]
    buffer_load_dwordx4 v20, s[12:15], s40 offen offset:2048 lds
    v_mfma_f32_16x16x32_bf16 v[168:171], v[96:99], a[44:47], v[168:171]
    s_add_u32 s97, s97, s42
    s_add_u32 s97, s97, s43
    s_waitcnt lgkmcnt(6)
    v_mfma_f32_16x16x32_bf16 v[140:143], v[100:103], a[48:51], v[140:143]
    ds_read_b64_tr_b16 v[88:89], v31 offset:40960
    v_cvt_pk_bf16_f32 v64, v116, v117
    v_mfma_f32_16x16x32_bf16 v[144:147], v[100:103], a[52:55], v[144:147]
    ds_read_b64_tr_b16 v[90:91], v31 offset:41984
    s_and_b32 s42, s22, 1
    s_mul_i32 s98, s42, 1179616
    v_mfma_f32_16x16x32_bf16 v[148:151], v[100:103], a[56:59], v[148:151]
    v_cvt_pk_bf16_f32 v66, v120, v121
    v_cvt_pk_bf16_f32 v65, v118, v119
    v_mfma_f32_16x16x32_bf16 v[152:155], v[100:103], a[60:63], v[152:155]
    s_add_u32 m0, s37, 36864
    s_add_u32 s40, s56, s48
    buffer_load_dwordx4 v18, s[12:15], s40 offen offset:0 lds
    v_mfma_f32_16x16x32_bf16 v[156:159], v[104:107], a[48:51], v[156:159]
    ds_read_b64_tr_b16 v[92:93], v28 offset:45056
    v_mfma_f32_16x16x32_bf16 v[160:163], v[104:107], a[52:55], v[160:163]
    ds_read_b64_tr_b16 v[94:95], v28 offset:46080
    s_lshl_b32 s42, s22, 5
    v_mfma_f32_16x16x32_bf16 v[164:167], v[104:107], a[56:59], v[164:167]
    s_add_u32 s98, s98, s42
    s_add_u32 s98, s98, s43
    v_mfma_f32_16x16x32_bf16 v[168:171], v[104:107], a[60:63], v[168:171]
    v_cvt_pk_bf16_f32 v67, v122, v123
    v_and_b32 v9, 15, v0
    s_waitcnt lgkmcnt(6)
    v_mfma_f32_16x16x32_bf16 v[140:143], v[76:79], a[64:67], v[140:143]
    ds_read_b64_tr_b16 v[96:97], v31 offset:45056
    v_permlane16_swap_b32 v64, v66
    v_mfma_f32_16x16x32_bf16 v[144:147], v[76:79], a[68:71], v[144:147]
    ds_read_b64_tr_b16 v[98:99], v31 offset:46080
    v_mul_u32_u24 v9, 73728, v9
    v_lshl_add_u32 v9, v6, 4, v9
    v_mfma_f32_16x16x32_bf16 v[148:151], v[76:79], a[72:75], v[148:151]
    buffer_load_dwordx4 v19, s[12:15], s40 offen offset:1024 lds
    v_mfma_f32_16x16x32_bf16 v[152:155], v[76:79], a[76:79], v[152:155]
    v_permlane16_swap_b32 v65, v67
    v_and_b32 v4, 16, v0
    v_mfma_f32_16x16x32_bf16 v[156:159], v[80:83], a[64:67], v[156:159]
    ds_read_b64_tr_b16 v[100:101], v28 offset:49152
    v_lshl_add_u32 v9, v4, 1, v9
    v_mfma_f32_16x16x32_bf16 v[160:163], v[80:83], a[68:71], v[160:163]
    ds_read_b64_tr_b16 v[102:103], v28 offset:50176
    v_lshlrev_b32 v10, 6, v5
    v_mfma_f32_16x16x32_bf16 v[164:167], v[80:83], a[72:75], v[164:167]
    v_add_u32 v10, s29, v10
    v_cvt_f32_u32 v10, v10
    v_mul_f32 v10, 0x3a000000, v10
    v_mfma_f32_16x16x32_bf16 v[168:171], v[80:83], a[76:79], v[168:171]
    buffer_store_dwordx4 v[64:67], v1, s[16:19], s51 offen offset:0 sc1
    s_waitcnt lgkmcnt(6)
    v_mfma_f32_16x16x32_bf16 v[140:143], v[84:87], a[80:83], v[140:143]
    ds_read_b64_tr_b16 v[104:105], v31 offset:49152
    v_mfma_f32_16x16x32_bf16 v[144:147], v[84:87], a[84:87], v[144:147]
    ds_read_b64_tr_b16 v[106:107], v31 offset:50176
    v_mfma_f32_16x16x32_bf16 v[148:151], v[84:87], a[88:91], v[148:151]
    buffer_load_dwordx4 v20, s[12:15], s40 offen offset:2048 lds
    v_mfma_f32_16x16x32_bf16 v[152:155], v[84:87], a[92:95], v[152:155]
    v_cvt_f32_u32 v11, v6
    v_mfma_f32_16x16x32_bf16 v[156:159], v[88:91], a[80:83], v[156:159]
    ds_read_b64_tr_b16 v[76:77], v28 offset:53248
    v_mul_f32 v11, 0x41000000, v11
    v_mfma_f32_16x16x32_bf16 v[160:163], v[88:91], a[84:87], v[160:163]
    ds_read_b64_tr_b16 v[78:79], v28 offset:54272
    v_cvt_pk_bf16_f32 v68, v124, v125
    v_mfma_f32_16x16x32_bf16 v[164:167], v[88:91], a[88:91], v[164:167]
    v_cvt_pk_bf16_f32 v70, v128, v129
    v_mul_f32 v11, v11, v10
    v_mov_b32 v39, v11
    v_mfma_f32_16x16x32_bf16 v[168:171], v[88:91], a[92:95], v[168:171]
    v_cvt_pk_bf16_f32 v69, v126, v127
    v_cvt_pk_bf16_f32 v71, v130, v131
    s_waitcnt lgkmcnt(6)
    v_mfma_f32_16x16x32_bf16 v[140:143], v[92:95], a[192:195], v[140:143]
    ds_read_b64_tr_b16 v[80:81], v31 offset:53248
    v_fmamk_f32 v40, v10, 0x3f800000, v11
    v_mfma_f32_16x16x32_bf16 v[144:147], v[92:95], a[196:199], v[144:147]
    ds_read_b64_tr_b16 v[82:83], v31 offset:54272
    v_permlane16_swap_b32 v68, v70
    v_fmamk_f32 v41, v10, 0x40000000, v11
    v_mfma_f32_16x16x32_bf16 v[148:151], v[92:95], a[200:203], v[148:151]
    v_bfe_u32 v36, v0, 3, 5
    v_bfe_u32 v37, v0, 4, 1
    v_lshlrev_b32 v37, 2, v37
    v_and_b32 v38, 7, v0
    v_xor_b32 v37, v37, v38
    v_mul_u32_u24 v36, 1152, v36
    v_lshl_add_u32 v36, v37, 4, v36
    s_lshl_b32 s59, s28, 10
    s_and_b32 s60, s2, 63
    s_lshl_b32 s60, s60, 7
    s_add_u32 s60, s60, 4726784
    v_and_b32 v37, 0x70, v1
    v_lshlrev_b32 v58, 4, v0
    s_mov_b32 s24, 48959488
    v_mov_b32 v220, 0
    buffer_load_dword v7, v58, s[16:19], s24 offen sc1
    v_mfma_f32_16x16x32_bf16 v[152:155], v[92:95], a[204:207], v[152:155]
    v_fmamk_f32 v42, v10, 0x40400000, v11
    v_mfma_f32_16x16x32_bf16 v[156:159], v[96:99], a[192:195], v[156:159]
    v_permlane16_swap_b32 v69, v71
    v_cos_f32 v43, v39
    v_mfma_f32_16x16x32_bf16 v[160:163], v[96:99], a[196:199], v[160:163]
    v_sin_f32 v47, v39
    v_mfma_f32_16x16x32_bf16 v[164:167], v[96:99], a[200:203], v[164:167]
    buffer_store_dwordx4 v[68:71], v1, s[16:19], s44 offen offset:1024 sc1
    v_mfma_f32_16x16x32_bf16 v[168:171], v[96:99], a[204:207], v[168:171]
    s_waitcnt vmcnt(13) lgkmcnt(0)
    v_mfma_f32_16x16x32_bf16 v[140:143], v[100:103], a[208:211], v[140:143]
    s_barrier
    v_mov_b32 v222, 1
    s_mov_b64 exec, 1
    buffer_store_dword v222, off, s[16:19], s101 offset:0 sc1
    s_mov_b64 exec, -1
    v_mfma_f32_16x16x32_bf16 v[144:147], v[100:103], a[212:215], v[144:147]
    s_branch L2_skip7
.p2align 12
L2_pad7:
    s_branch L2_ret7
    s_nop 0
L2_skip7:
    ds_read_b64_tr_b16 v[84:85], v28 offset:57344
    v_mfma_f32_16x16x32_bf16 v[148:151], v[100:103], a[216:219], v[148:151]
    ds_read_b64_tr_b16 v[86:87], v28 offset:58368
    v_mfma_f32_16x16x32_bf16 v[152:155], v[100:103], a[220:223], v[152:155]
    ds_read_b64_tr_b16 v[88:89], v31 offset:57344
    v_mfma_f32_16x16x32_bf16 v[156:159], v[104:107], a[208:211], v[156:159]
    ds_read_b64_tr_b16 v[90:91], v31 offset:58368
    v_mfma_f32_16x16x32_bf16 v[160:163], v[104:107], a[212:215], v[160:163]
    ds_read_b64_tr_b16 v[92:93], v28 offset:61440
    v_cos_f32 v44, v40
    v_mfma_f32_16x16x32_bf16 v[164:167], v[104:107], a[216:219], v[164:167]
    ds_read_b64_tr_b16 v[94:95], v28 offset:62464
    v_sin_f32 v48, v40
    v_mfma_f32_16x16x32_bf16 v[168:171], v[104:107], a[220:223], v[168:171]
    s_add_u32 m0, s37, 98304
    s_add_u32 s40, s57, s48
    buffer_load_dwordx4 v18, s[12:15], s40 offen offset:0 lds
    v_mfma_f32_16x16x32_bf16 v[140:143], v[76:79], a[224:227], v[140:143]
    ds_read_b64_tr_b16 v[96:97], v31 offset:61440
    v_mfma_f32_16x16x32_bf16 v[144:147], v[76:79], a[228:231], v[144:147]
    ds_read_b64_tr_b16 v[98:99], v31 offset:62464
    v_mfma_f32_16x16x32_bf16 v[148:151], v[76:79], a[232:235], v[148:151]
    v_cos_f32 v45, v41
    v_mfma_f32_16x16x32_bf16 v[152:155], v[76:79], a[236:239], v[152:155]
    v_sin_f32 v49, v41
    v_mfma_f32_16x16x32_bf16 v[156:159], v[80:83], a[224:227], v[156:159]
    ds_read_b64_tr_b16 v[100:101], v29 offset:0
    v_cos_f32 v46, v42
    v_mfma_f32_16x16x32_bf16 v[160:163], v[80:83], a[228:231], v[160:163]
    ds_read_b64_tr_b16 v[102:103], v29 offset:1024
    v_cvt_pk_bf16_f32 v72, v132, v133
    v_mfma_f32_16x16x32_bf16 v[164:167], v[80:83], a[232:235], v[164:167]
    v_cvt_pk_bf16_f32 v74, v136, v137
    v_mfma_f32_16x16x32_bf16 v[168:171], v[80:83], a[236:239], v[168:171]
    buffer_load_dwordx4 v19, s[12:15], s40 offen offset:1024 lds
    s_waitcnt lgkmcnt(6)
    v_mfma_f32_16x16x32_bf16 v[140:143], v[84:87], a[96:99], v[140:143]
    ds_read_b64_tr_b16 v[104:105], v32 offset:0
    v_sin_f32 v50, v42
    v_mfma_f32_16x16x32_bf16 v[144:147], v[84:87], a[100:103], v[144:147]
    ds_read_b64_tr_b16 v[106:107], v32 offset:1024
    v_cvt_pk_bf16_f32 v196, v43, v44
    v_mfma_f32_16x16x32_bf16 v[148:151], v[84:87], a[104:107], v[148:151]
    v_cvt_pk_bf16_f32 v73, v134, v135
    v_cvt_pk_bf16_f32 v75, v138, v139
    v_cvt_pk_bf16_f32 v204, v47, v48
    v_mfma_f32_16x16x32_bf16 v[152:155], v[84:87], a[108:111], v[152:155]
    v_permlane16_swap_b32 v72, v74
    v_cvt_pk_bf16_f32 v212, -v47, -v48
    v_mfma_f32_16x16x32_bf16 v[156:159], v[88:91], a[96:99], v[156:159]
    ds_read_b64_tr_b16 v[76:77], v27 offset:24576
    v_permlane16_swap_b32 v73, v75
    v_mfma_f32_16x16x32_bf16 v[160:163], v[88:91], a[100:103], v[160:163]
    ds_read_b64_tr_b16 v[78:79], v27 offset:25600
    v_cvt_pk_bf16_f32 v197, v45, v46
    v_cvt_pk_bf16_f32 v205, v49, v50
    v_mfma_f32_16x16x32_bf16 v[164:167], v[88:91], a[104:107], v[164:167]
    v_cvt_pk_bf16_f32 v213, -v49, -v50
    v_fmamk_f32 v39, v10, 0x40800000, v11
    v_mfma_f32_16x16x32_bf16 v[168:171], v[88:91], a[108:111], v[168:171]
    buffer_store_dwordx4 v[72:75], v1, s[16:19], s51 offen offset:1024 sc1
    s_waitcnt lgkmcnt(6)
    v_mfma_f32_16x16x32_bf16 v[140:143], v[92:95], a[112:115], v[140:143]
    ds_read_b64_tr_b16 v[80:81], v30 offset:24576
    v_mfma_f32_16x16x32_bf16 v[144:147], v[92:95], a[116:119], v[144:147]
    ds_read_b64_tr_b16 v[82:83], v30 offset:25600
    v_mfma_f32_16x16x32_bf16 v[148:151], v[92:95], a[120:123], v[148:151]
    v_fmamk_f32 v40, v10, 0x40a00000, v11
    v_mfma_f32_16x16x32_bf16 v[152:155], v[92:95], a[124:127], v[152:155]
    v_fmamk_f32 v41, v10, 0x40c00000, v11
    v_fmamk_f32 v42, v10, 0x40e00000, v11
    v_mfma_f32_16x16x32_bf16 v[156:159], v[96:99], a[112:115], v[156:159]
    ds_read_b64_tr_b16 v[84:85], v27 offset:28672
    v_cos_f32 v43, v39
    v_mfma_f32_16x16x32_bf16 v[160:163], v[96:99], a[116:119], v[160:163]
    ds_read_b64_tr_b16 v[86:87], v27 offset:29696
    v_sin_f32 v47, v39
    v_mfma_f32_16x16x32_bf16 v[164:167], v[96:99], a[120:123], v[164:167]
    buffer_load_dwordx4 v20, s[12:15], s40 offen offset:2048 lds
    v_mfma_f32_16x16x32_bf16 v[168:171], v[96:99], a[124:127], v[168:171]
    v_cos_f32 v44, v40
    s_waitcnt lgkmcnt(6)
    v_mfma_f32_16x16x32_bf16 v[140:143], v[100:103], a[128:131], v[140:143]
    ds_read_b64_tr_b16 v[88:89], v30 offset:28672
    v_mfma_f32_16x16x32_bf16 v[144:147], v[100:103], a[132:135], v[144:147]
    ds_read_b64_tr_b16 v[90:91], v30 offset:29696
    v_sin_f32 v48, v40
    v_mfma_f32_16x16x32_bf16 v[148:151], v[100:103], a[136:139], v[148:151]
    v_cos_f32 v45, v41
    v_mfma_f32_16x16x32_bf16 v[152:155], v[100:103], a[140:143], v[152:155]
    v_sin_f32 v49, v41
    v_mfma_f32_16x16x32_bf16 v[156:159], v[104:107], a[128:131], v[156:159]
    ds_read_b64_tr_b16 v[92:93], v27 offset:32768
    v_cos_f32 v46, v42
    v_mfma_f32_16x16x32_bf16 v[160:163], v[104:107], a[132:135], v[160:163]
    ds_read_b64_tr_b16 v[94:95], v27 offset:33792
    v_mfma_f32_16x16x32_bf16 v[164:167], v[104:107], a[136:139], v[164:167]
    v_sin_f32 v50, v42
    v_cvt_pk_bf16_f32 v198, v43, v44
    v_mfma_f32_16x16x32_bf16 v[168:171], v[104:107], a[140:143], v[168:171]
    v_cvt_pk_bf16_f32 v206, v47, v48
    v_cvt_pk_bf16_f32 v214, -v47, -v48
    v_cvt_pk_bf16_f32 v199, v45, v46
    s_waitcnt lgkmcnt(6)
    v_mfma_f32_16x16x32_bf16 v[140:143], v[76:79], a[144:147], v[140:143]
    ds_read_b64_tr_b16 v[96:97], v30 offset:32768
    v_cvt_pk_bf16_f32 v207, v49, v50
    v_mfma_f32_16x16x32_bf16 v[144:147], v[76:79], a[148:151], v[144:147]
    ds_read_b64_tr_b16 v[98:99], v30 offset:33792
    v_cvt_pk_bf16_f32 v215, -v49, -v50
    v_mfma_f32_16x16x32_bf16 v[148:151], v[76:79], a[152:155], v[148:151]
    v_fmamk_f32 v39, v10, 0x41800000, v11
    v_fmamk_f32 v40, v10, 0x41880000, v11
    v_fmamk_f32 v41, v10, 0x41900000, v11
    v_mfma_f32_16x16x32_bf16 v[152:155], v[76:79], a[156:159], v[152:155]
    v_fmamk_f32 v42, v10, 0x41980000, v11
    v_mfma_f32_16x16x32_bf16 v[156:159], v[80:83], a[144:147], v[156:159]
    ds_read_b64_tr_b16 v[100:101], v27 offset:61440
    v_cos_f32 v43, v39
    v_mfma_f32_16x16x32_bf16 v[160:163], v[80:83], a[148:151], v[160:163]
    ds_read_b64_tr_b16 v[102:103], v27 offset:62464
    v_sin_f32 v47, v39
    v_mfma_f32_16x16x32_bf16 v[164:167], v[80:83], a[152:155], v[164:167]
    v_cos_f32 v44, v40
    v_mfma_f32_16x16x32_bf16 v[168:171], v[80:83], a[156:159], v[168:171]
    v_sin_f32 v48, v40
    s_waitcnt lgkmcnt(6)
    v_mfma_f32_16x16x32_bf16 v[140:143], v[84:87], a[160:163], v[140:143]
    ds_read_b64_tr_b16 v[104:105], v30 offset:61440
    v_cos_f32 v45, v41
    v_mfma_f32_16x16x32_bf16 v[144:147], v[84:87], a[164:167], v[144:147]
    ds_read_b64_tr_b16 v[106:107], v30 offset:62464
    v_mfma_f32_16x16x32_bf16 v[148:151], v[84:87], a[168:171], v[148:151]
    v_sin_f32 v49, v41
    v_mfma_f32_16x16x32_bf16 v[152:155], v[84:87], a[172:175], v[152:155]
    v_cos_f32 v46, v42
    v_sin_f32 v50, v42
    v_mfma_f32_16x16x32_bf16 v[156:159], v[88:91], a[160:163], v[156:159]
    ds_read_b64_tr_b16 v[76:77], v28 offset:0
    v_cvt_pk_bf16_f32 v200, v43, v44
    v_mfma_f32_16x16x32_bf16 v[160:163], v[88:91], a[164:167], v[160:163]
    ds_read_b64_tr_b16 v[78:79], v28 offset:1024
    v_cvt_pk_bf16_f32 v208, v47, v48
    v_mfma_f32_16x16x32_bf16 v[164:167], v[88:91], a[168:171], v[164:167]
    v_cvt_pk_bf16_f32 v216, -v47, -v48
    v_cvt_pk_bf16_f32 v201, v45, v46
    v_mfma_f32_16x16x32_bf16 v[168:171], v[88:91], a[172:175], v[168:171]
    v_cvt_pk_bf16_f32 v209, v49, v50
    v_cvt_pk_bf16_f32 v217, -v49, -v50
    s_waitcnt lgkmcnt(6)
    v_mfma_f32_16x16x32_bf16 v[140:143], v[92:95], a[176:179], v[140:143]
    ds_read_b64_tr_b16 v[80:81], v31 offset:0
    v_fmamk_f32 v39, v10, 0x41a00000, v11
    v_fmamk_f32 v40, v10, 0x41a80000, v11
    v_mfma_f32_16x16x32_bf16 v[144:147], v[92:95], a[180:183], v[144:147]
    ds_read_b64_tr_b16 v[82:83], v31 offset:1024
    v_fmamk_f32 v41, v10, 0x41b00000, v11
    v_mfma_f32_16x16x32_bf16 v[148:151], v[92:95], a[184:187], v[148:151]
    s_waitcnt vmcnt(6)
    v_cmp_ne_u32 vcc, v220, v7
    s_nop 0
    s_cmp_eq_u64 vcc, -1
    s_cbranch_scc0 L2_uspin
L2_uok:
    v_mfma_f32_16x16x32_bf16 v[152:155], v[92:95], a[188:191], v[152:155]
    v_fmamk_f32 v42, v10, 0x41b80000, v11
    v_cos_f32 v43, v39
    v_mfma_f32_16x16x32_bf16 v[156:159], v[96:99], a[176:179], v[156:159]
    ds_read_b64_tr_b16 v[84:85], v28 offset:4096
    v_mfma_f32_16x16x32_bf16 v[160:163], v[96:99], a[180:183], v[160:163]
    ds_read_b64_tr_b16 v[86:87], v28 offset:5120
    v_sin_f32 v47, v39
    v_mfma_f32_16x16x32_bf16 v[164:167], v[96:99], a[184:187], v[164:167]
    v_cos_f32 v44, v40
    v_mfma_f32_16x16x32_bf16 v[168:171], v[96:99], a[188:191], v[168:171]
    v_sin_f32 v48, v40
    s_waitcnt lgkmcnt(6)
    v_mfma_f32_16x16x32_bf16 v[140:143], v[100:103], a[240:243], v[140:143]
    ds_read_b64_tr_b16 v[88:89], v31 offset:4096
    v_cos_f32 v45, v41
    v_mfma_f32_16x16x32_bf16 v[144:147], v[100:103], a[244:247], v[144:147]
    ds_read_b64_tr_b16 v[90:91], v31 offset:5120
    v_sin_f32 v49, v41
    v_mfma_f32_16x16x32_bf16 v[148:151], v[100:103], a[248:251], v[148:151]
    v_cos_f32 v46, v42
    v_mfma_f32_16x16x32_bf16 v[152:155], v[100:103], a[252:255], v[152:155]
    v_sin_f32 v50, v42
    v_mfma_f32_16x16x32_bf16 v[156:159], v[104:107], a[240:243], v[156:159]
    v_cvt_pk_bf16_f32 v202, v43, v44
    v_cvt_pk_bf16_f32 v210, v47, v48
    v_mfma_f32_16x16x32_bf16 v[160:163], v[104:107], a[244:247], v[160:163]
    v_cvt_pk_bf16_f32 v218, -v47, -v48
    v_cvt_pk_bf16_f32 v203, v45, v46
    v_mfma_f32_16x16x32_bf16 v[164:167], v[104:107], a[248:251], v[164:167]
    v_cvt_pk_bf16_f32 v211, v49, v50
    v_cvt_pk_bf16_f32 v219, -v49, -v50
    v_bfe_u32 v41, v0, 2, 2
    v_mfma_f32_16x16x32_bf16 v[168:171], v[104:107], a[252:255], v[168:171]
    v_lshl_add_u32 v41, v6, 3, v41
    v_bfe_u32 v42, v0, 3, 1
    s_waitcnt vmcnt(0) lgkmcnt(0)
    v_mfma_f32_16x16x32_bf16 v[140:143], v[76:79], v[224:227], v[140:143]
    s_barrier
    v_mov_b32 v222, 2
    s_mov_b64 exec, 1
    buffer_store_dword v222, off, s[16:19], s101 offset:0 sc1
    s_mov_b64 exec, -1
    v_mfma_f32_16x16x32_bf16 v[144:147], v[76:79], v[228:231], v[144:147]
    ds_read_b64_tr_b16 v[92:93], v33 offset:49152
    v_mfma_f32_16x16x32_bf16 v[148:151], v[76:79], v[232:235], v[148:151]
    ds_read_b64_tr_b16 v[94:95], v33 offset:50176
    v_mfma_f32_16x16x32_bf16 v[152:155], v[76:79], v[236:239], v[152:155]
    ds_read_b64_tr_b16 v[96:97], v33 offset:53248
    v_mfma_f32_16x16x32_bf16 v[156:159], v[80:83], v[224:227], v[156:159]
    ds_read_b64_tr_b16 v[98:99], v33 offset:54272
    v_lshlrev_b32 v42, 6, v42
    v_mfma_f32_16x16x32_bf16 v[160:163], v[80:83], v[228:231], v[160:163]
    ds_read_b64_tr_b16 v[100:101], v33 offset:57344
    v_lshl_add_u32 v41, v41, 7, v42
    v_bfe_u32 v42, v0, 4, 1
    v_mfma_f32_16x16x32_bf16 v[164:167], v[80:83], v[232:235], v[164:167]
    ds_read_b64_tr_b16 v[102:103], v33 offset:58368
    v_lshl_add_u32 v41, v42, 5, v41
    v_mfma_f32_16x16x32_bf16 v[168:171], v[80:83], v[236:239], v[168:171]
    s_add_u32 m0, s59, 0
    s_nop 0
    buffer_load_dwordx4 v36, s[16:19], s58 offen offset:0 sc1 lds
    v_mfma_f32_16x16x32_bf16 v[140:143], v[84:87], v[240:243], v[140:143]
    ds_read_b64_tr_b16 v[104:105], v34 offset:8192
    v_and_b32 v42, 3, v0
    v_mfma_f32_16x16x32_bf16 v[144:147], v[84:87], v[244:247], v[144:147]
    ds_read_b64_tr_b16 v[106:107], v34 offset:9216
    v_lshl_add_u32 v41, v42, 3, v41
    v_mfma_f32_16x16x32_bf16 v[148:151], v[84:87], v[248:251], v[148:151]
    s_add_u32 m0, s59, 3968
    s_nop 0
    buffer_load_dwordx4 v36, s[16:19], s58 offen offset:128 sc1 lds
    v_mfma_f32_16x16x32_bf16 v[152:155], v[84:87], v[252:255], v[152:155]
    s_lshl_b32 s99, s28, 12
    v_add_u32 v41, s99, v41
    v_mfma_f32_16x16x32_bf16 v[156:159], v[88:91], v[240:243], v[156:159]
    ds_read_b64_tr_b16 v[76:77], v34 offset:12288
    v_xor_b32 v42, 64, v41
    s_lshl_b32 s33, s28, 11
    v_mfma_f32_16x16x32_bf16 v[160:163], v[88:91], v[244:247], v[160:163]
    ds_read_b64_tr_b16 v[78:79], v34 offset:13312
    s_add_u32 s33, s33, 36864
    v_mfma_f32_16x16x32_bf16 v[164:167], v[88:91], v[248:251], v[164:167]
    v_add_u32 v2, s33, v1
    s_mul_i32 s33, s31, 18432
    v_mfma_f32_16x16x32_bf16 v[168:171], v[88:91], v[252:255], v[168:171]
    s_lshl_b32 s34, s32, 10
    s_add_u32 s33, s33, s34
    s_add_u32 s33, s33, 36864
    s_waitcnt lgkmcnt(6)
    v_mfma_f32_16x16x32_bf16 v[172:175], v[92:95], a[0:3], 0
    ds_read_b64_tr_b16 v[80:81], v34 offset:16384
    v_add_u32 v3, s33, v1
    v_mfma_f32_16x16x32_bf16 v[176:179], v[92:95], a[4:7], 0
    ds_read_b64_tr_b16 v[82:83], v34 offset:17408
    v_xor_b32 v39, 1024, v3
    v_mfma_f32_16x16x32_bf16 v[180:183], v[92:95], a[8:11], 0
    s_add_u32 m0, s59, 7936
    s_nop 0
    buffer_load_dwordx4 v36, s[16:19], s58 offen offset:256 sc1 lds
    v_mfma_f32_16x16x32_bf16 v[184:187], v[92:95], a[12:15], 0
    v_lshlrev_b32 v40, 4, v6
    v_add_u32 v40, 160896, v40
    v_mfma_f32_16x16x32_bf16 v[172:175], v[96:99], a[16:19], v[172:175]
    ds_read_b64_tr_b16 v[84:85], v34 offset:20480
    s_add_u32 s44, s44, s49
    v_and_b32 v12, 0x13, v5
    v_mfma_f32_16x16x32_bf16 v[176:179], v[96:99], a[20:23], v[176:179]
    ds_read_b64_tr_b16 v[86:87], v34 offset:21504
    v_bfe_u32 v13, v5, 2, 1
    v_mfma_f32_16x16x32_bf16 v[180:183], v[96:99], a[24:27], v[180:183]
    s_add_u32 s51, s44, 36864
    v_lshl_add_u32 v12, v13, 3, v12
    v_mfma_f32_16x16x32_bf16 v[184:187], v[96:99], a[28:31], v[184:187]
    v_cvt_pk_bf16_f32 v60, v140, v141
    v_cvt_pk_bf16_f32 v62, v144, v145
    v_bfe_u32 v13, v5, 3, 1
    s_waitcnt lgkmcnt(6)
    v_mfma_f32_16x16x32_bf16 v[172:175], v[100:103], a[32:35], v[172:175]
    ds_read_b64_tr_b16 v[88:89], v34 offset:24576
    v_lshl_add_u32 v12, v13, 2, v12
    v_mfma_f32_16x16x32_bf16 v[176:179], v[100:103], a[36:39], v[176:179]
    ds_read_b64_tr_b16 v[90:91], v34 offset:25600
    v_lshlrev_b32 v11, 3, v6
    v_mfma_f32_16x16x32_bf16 v[180:183], v[100:103], a[40:43], v[180:183]
    v_cvt_pk_bf16_f32 v61, v142, v143
    v_cvt_pk_bf16_f32 v63, v146, v147
    v_sub_u32 v10, v12, v11
    v_mfma_f32_16x16x32_bf16 v[184:187], v[100:103], a[44:47], v[184:187]
    s_add_u32 m0, s59, 11904
    s_nop 0
    buffer_load_dwordx4 v36, s[16:19], s58 offen offset:384 sc1 lds
    v_mfma_f32_16x16x32_bf16 v[172:175], v[104:107], a[48:51], v[172:175]
    ds_read_b64_tr_b16 v[92:93], v34 offset:28672
    v_mov_b32 v11, 0x3f80
    v_mfma_f32_16x16x32_bf16 v[176:179], v[104:107], a[52:55], v[176:179]
    ds_read_b64_tr_b16 v[94:95], v34 offset:29696
    v_mov_b32 v25, 0x3f800000
    v_mfma_f32_16x16x32_bf16 v[180:183], v[104:107], a[56:59], v[180:183]
    v_cmp_eq_u32 s[42:43], 0, v10
    v_cmp_eq_u32 s[46:47], 1, v10
    v_mfma_f32_16x16x32_bf16 v[184:187], v[104:107], a[60:63], v[184:187]
    v_permlane16_swap_b32 v60, v62
    v_permlane16_swap_b32 v61, v63
    v_cndmask_b32 v188, 0, v11, s[42:43]
    s_waitcnt lgkmcnt(6)
    v_mfma_f32_16x16x32_bf16 v[172:175], v[76:79], a[64:67], v[172:175]
    ds_read_b64_tr_b16 v[96:97], v35 offset:4096
    v_cndmask_b32 v188, v188, v25, s[46:47]
    v_mfma_f32_16x16x32_bf16 v[176:179], v[76:79], a[68:71], v[176:179]
    ds_read_b64_tr_b16 v[98:99], v35 offset:5120
    v_cmp_eq_u32 s[42:43], 2, v10
    v_mfma_f32_16x16x32_bf16 v[180:183], v[76:79], a[72:75], v[180:183]
    v_cmp_eq_u32 s[46:47], 3, v10
    v_cndmask_b32 v189, 0, v11, s[42:43]
    v_mfma_f32_16x16x32_bf16 v[184:187], v[76:79], a[76:79], v[184:187]
    s_add_u32 m0, s59, 15872
    s_nop 0
    buffer_load_dwordx4 v36, s[16:19], s58 offen offset:512 sc1 lds
    v_mfma_f32_16x16x32_bf16 v[172:175], v[80:83], a[80:83], v[172:175]
    ds_read_b64_tr_b16 v[100:101], v35 offset:8192
    v_cndmask_b32 v189, v189, v25, s[46:47]
    v_cmp_eq_u32 s[42:43], 4, v10
    v_mfma_f32_16x16x32_bf16 v[176:179], v[80:83], a[84:87], v[176:179]
    ds_read_b64_tr_b16 v[102:103], v35 offset:9216
    v_cmp_eq_u32 s[46:47], 5, v10
    v_mfma_f32_16x16x32_bf16 v[180:183], v[80:83], a[88:91], v[180:183]
    v_cndmask_b32 v190, 0, v11, s[42:43]
    v_cndmask_b32 v190, v190, v25, s[46:47]
    v_mfma_f32_16x16x32_bf16 v[184:187], v[80:83], a[92:95], v[184:187]
    buffer_store_dwordx4 v[60:63], v1, s[16:19], s44 offen offset:0 sc1
    s_waitcnt lgkmcnt(6)
    v_mfma_f32_16x16x32_bf16 v[172:175], v[84:87], a[192:195], v[172:175]
    ds_read_b64_tr_b16 v[104:105], v35 offset:12288
    v_mfma_f32_16x16x32_bf16 v[176:179], v[84:87], a[196:199], v[176:179]
    ds_read_b64_tr_b16 v[106:107], v35 offset:13312
    v_mfma_f32_16x16x32_bf16 v[180:183], v[84:87], a[200:203], v[180:183]
    v_cmp_eq_u32 s[42:43], 6, v10
    v_mfma_f32_16x16x32_bf16 v[184:187], v[84:87], a[204:207], v[184:187]
    v_cvt_pk_bf16_f32 v64, v148, v149
    v_cmp_eq_u32 s[46:47], 7, v10
    v_cndmask_b32 v191, 0, v11, s[42:43]
    v_mfma_f32_16x16x32_bf16 v[172:175], v[88:91], a[208:211], v[172:175]
    ds_read_b64_tr_b16 v[76:77], v33 offset:36864
    v_cvt_pk_bf16_f32 v66, v152, v153
    v_mfma_f32_16x16x32_bf16 v[176:179], v[88:91], a[212:215], v[176:179]
    ds_read_b64_tr_b16 v[78:79], v33 offset:37888
    v_cndmask_b32 v191, v191, v25, s[46:47]
    v_mfma_f32_16x16x32_bf16 v[180:183], v[88:91], a[216:219], v[180:183]
    s_add_u32 m0, s59, 19840
    s_nop 0
    buffer_load_dwordx4 v36, s[16:19], s58 offen offset:640 sc1 lds
    v_mfma_f32_16x16x32_bf16 v[184:187], v[88:91], a[220:223], v[184:187]
    v_cmp_eq_u32 s[42:43], 16, v10
    v_cmp_eq_u32 s[46:47], 17, v10
    s_waitcnt lgkmcnt(6)
    v_mfma_f32_16x16x32_bf16 v[172:175], v[92:95], a[224:227], v[172:175]
    ds_read_b64_tr_b16 v[80:81], v33 offset:40960
    v_cvt_pk_bf16_f32 v65, v150, v151
    v_cndmask_b32 v192, 0, v11, s[42:43]
    v_mfma_f32_16x16x32_bf16 v[176:179], v[92:95], a[228:231], v[176:179]
    ds_read_b64_tr_b16 v[82:83], v33 offset:41984
    v_cndmask_b32 v192, v192, v25, s[46:47]
    v_mfma_f32_16x16x32_bf16 v[180:183], v[92:95], a[232:235], v[180:183]
    v_cvt_pk_bf16_f32 v67, v154, v155
    v_cmp_eq_u32 s[42:43], 18, v10
    v_mfma_f32_16x16x32_bf16 v[184:187], v[92:95], a[236:239], v[184:187]
    v_permlane16_swap_b32 v64, v66
    v_permlane16_swap_b32 v65, v67
    v_cmp_eq_u32 s[46:47], 19, v10
    v_mfma_f32_16x16x32_bf16 v[172:175], v[96:99], a[96:99], v[172:175]
    ds_read_b64_tr_b16 v[84:85], v33 offset:45056
    v_cndmask_b32 v193, 0, v11, s[42:43]
    v_mfma_f32_16x16x32_bf16 v[176:179], v[96:99], a[100:103], v[176:179]
    ds_read_b64_tr_b16 v[86:87], v33 offset:46080
    v_cndmask_b32 v193, v193, v25, s[46:47]
    v_mfma_f32_16x16x32_bf16 v[180:183], v[96:99], a[104:107], v[180:183]
    s_add_u32 m0, s59, 23808
    s_nop 0
    buffer_load_dwordx4 v36, s[16:19], s58 offen offset:768 sc1 lds
    v_mfma_f32_16x16x32_bf16 v[184:187], v[96:99], a[108:111], v[184:187]
    v_cmp_eq_u32 s[42:43], 20, v10
    v_cmp_eq_u32 s[46:47], 21, v10
    s_waitcnt lgkmcnt(6)
    v_mfma_f32_16x16x32_bf16 v[172:175], v[100:103], a[112:115], v[172:175]
    ds_read_b64_tr_b16 v[88:89], v34 offset:32768
    v_cndmask_b32 v194, 0, v11, s[42:43]
    v_cndmask_b32 v194, v194, v25, s[46:47]
    v_mfma_f32_16x16x32_bf16 v[176:179], v[100:103], a[116:119], v[176:179]
    ds_read_b64_tr_b16 v[90:91], v34 offset:33792
    v_cmp_eq_u32 s[42:43], 22, v10
    v_mfma_f32_16x16x32_bf16 v[180:183], v[100:103], a[120:123], v[180:183]
    v_cmp_eq_u32 s[46:47], 23, v10
    v_cndmask_b32 v195, 0, v11, s[42:43]
    v_mfma_f32_16x16x32_bf16 v[184:187], v[100:103], a[124:127], v[184:187]
    buffer_store_dwordx4 v[64:67], v1, s[16:19], s51 offen offset:0 sc1
    v_mfma_f32_16x16x32_bf16 v[172:175], v[104:107], a[128:131], v[172:175]
    ds_read_b64_tr_b16 v[92:93], v34 offset:36864
    v_mfma_f32_16x16x32_bf16 v[176:179], v[104:107], a[132:135], v[176:179]
    ds_read_b64_tr_b16 v[94:95], v34 offset:37888
    v_mfma_f32_16x16x32_bf16 v[180:183], v[104:107], a[136:139], v[180:183]
    s_add_u32 m0, s59, 27776
    s_nop 0
    buffer_load_dwordx4 v36, s[16:19], s58 offen offset:896 sc1 lds
    v_mfma_f32_16x16x32_bf16 v[184:187], v[104:107], a[140:143], v[184:187]
    v_cndmask_b32 v195, v195, v25, s[46:47]
    s_waitcnt lgkmcnt(6)
    v_mfma_f32_16x16x32_bf16 v[172:175], v[76:79], a[144:147], v[172:175]
    ds_read_b64_tr_b16 v[96:97], v34 offset:40960
    v_lshlrev_b32 v13, 3, v6
    v_add_u32 v13, s31, v13
    v_mfma_f32_16x16x32_bf16 v[176:179], v[76:79], a[148:151], v[176:179]
    ds_read_b64_tr_b16 v[98:99], v34 offset:41984
    v_cvt_f32_u32 v13, v13
    v_mfma_f32_16x16x32_bf16 v[180:183], v[76:79], a[152:155], v[180:183]
    v_cvt_pk_bf16_f32 v68, v156, v157
    s_mul_i32 s50, s32, 0x3e800000
    v_mfma_f32_16x16x32_bf16 v[184:187], v[76:79], a[156:159], v[184:187]
    v_cvt_pk_bf16_f32 v70, v160, v161
    s_lshl_b32 s35, s32, 31
    s_xor_b32 s35, s35, 0xbae38e39
    v_mfma_f32_16x16x32_bf16 v[172:175], v[80:83], a[160:163], v[172:175]
    v_cvt_pk_bf16_f32 v69, v158, v159
    s_mul_i32 s34, s32, 6
    v_mfma_f32_16x16x32_bf16 v[176:179], v[80:83], a[164:167], v[176:179]
    v_cvt_pk_bf16_f32 v71, v162, v163
    v_permlane16_swap_b32 v68, v70
    v_mfma_f32_16x16x32_bf16 v[180:183], v[80:83], a[168:171], v[180:183]
    s_add_u32 m0, s59, 31744
    s_nop 0
    buffer_load_dwordx4 v36, s[16:19], s58 offen offset:1024 sc1 lds
    v_mfma_f32_16x16x32_bf16 v[184:187], v[80:83], a[172:175], v[184:187]
    s_add_u32 s34, s34, s30
    s_lshl_b32 s33, s34, 5
    s_waitcnt lgkmcnt(4)
    v_mfma_f32_16x16x32_bf16 v[172:175], v[84:87], a[176:179], v[172:175]
    v_permlane16_swap_b32 v69, v71
    v_add_u32 v10, s33, v12
    v_cvt_f32_u32 v10, v10
    v_mfma_f32_16x16x32_bf16 v[176:179], v[84:87], a[180:183], v[176:179]
    v_mul_f32 v10, s35, v10
    v_fma_f32 v11, v13, v10, s50
    v_mfma_f32_16x16x32_bf16 v[180:183], v[84:87], a[184:187], v[180:183]
    buffer_store_dwordx4 v[68:71], v1, s[16:19], s44 offen offset:1024 sc1
    v_mfma_f32_16x16x32_bf16 v[184:187], v[84:87], a[188:191], v[184:187]
    v_mfma_f32_16x16x32_bf16 v[172:175], v[88:91], a[240:243], v[172:175]
    v_mul_f32 v24, 0x42000000, v10
    v_mfma_f32_16x16x32_bf16 v[176:179], v[88:91], a[244:247], v[176:179]
    v_cvt_pk_bf16_f32 v72, v164, v165
    v_cos_f32 v24, v24
    v_mfma_f32_16x16x32_bf16 v[180:183], v[88:91], a[248:251], v[180:183]
    v_cvt_pk_bf16_f32 v74, v168, v169
    v_mfma_f32_16x16x32_bf16 v[184:187], v[88:91], a[252:255], v[184:187]
    s_mov_b32 m0, 160896
    s_nop 0
    buffer_load_dwordx4 v37, s[16:19], s60 offen sc1 lds
    s_waitcnt lgkmcnt(0)
    v_mfma_f32_16x16x32_bf16 v[172:175], v[92:95], v[224:227], v[172:175]
    v_cvt_pk_bf16_f32 v73, v166, v167
    v_add_f32 v24, v24, v24
    v_mfma_f32_16x16x32_bf16 v[176:179], v[92:95], v[228:231], v[176:179]
    v_cvt_pk_bf16_f32 v75, v170, v171
    v_mov_b32 v25, v24
    v_and_b32 v6, 0x2f0, v1
    v_mfma_f32_16x16x32_bf16 v[180:183], v[92:95], v[232:235], v[180:183]
    v_permlane16_swap_b32 v72, v74
    v_lshl_add_u32 v6, v4, 6, v6
    v_mfma_f32_16x16x32_bf16 v[184:187], v[92:95], v[236:239], v[184:187]
    v_permlane16_swap_b32 v73, v75
    v_mfma_f32_16x16x32_bf16 v[172:175], v[96:99], v[240:243], v[172:175]
    v_mfma_f32_16x16x32_bf16 v[176:179], v[96:99], v[244:247], v[176:179]
    buffer_store_dwordx4 v[72:75], v1, s[16:19], s51 offen offset:1024 sc1
    v_mfma_f32_16x16x32_bf16 v[180:183], v[96:99], v[248:251], v[180:183]
    v_mfma_f32_16x16x32_bf16 v[184:187], v[96:99], v[252:255], v[184:187]
    s_mov_b32 s5, 0
    v_mov_b32 v8, v223
    s_load_dwordx2 s[52:53], s[0:1], 0
    s_load_dwordx2 s[40:41], s[0:1], 56
    v_mov_b32 v44, v11
    v_fmamk_f32 v45, v10, 0x40000000, v11
    v_fmamk_f32 v46, v10, 0x40800000, v11
    v_fmamk_f32 v47, v10, 0x40c00000, v11
    v_fmamk_f32 v48, v10, 0x41800000, v11
    v_fmamk_f32 v49, v10, 0x41900000, v11
    v_fmamk_f32 v50, v10, 0x41a00000, v11
    v_fmamk_f32 v51, v10, 0x41b00000, v11
    s_mov_b32 s44, s45
    s_add_u32 s51, s44, 36864
    v_cvt_pk_bf16_f32 v60, v172, v173
    v_cvt_pk_bf16_f32 v62, v176, v177
    v_cvt_pk_bf16_f32 v61, v174, v175
    v_cvt_pk_bf16_f32 v63, v178, v179
    v_permlane16_swap_b32 v60, v62
    s_nop 0
    v_permlane16_swap_b32 v61, v63
    buffer_store_dwordx4 v[60:63], v1, s[16:19], s44 offen offset:0 sc1
    v_cvt_pk_bf16_f32 v64, v180, v181
    v_cvt_pk_bf16_f32 v66, v184, v185
    v_cvt_pk_bf16_f32 v65, v182, v183
    v_cvt_pk_bf16_f32 v67, v186, v187
    v_permlane16_swap_b32 v64, v66
    s_nop 0
    v_permlane16_swap_b32 v65, v67
    buffer_store_dwordx4 v[64:67], v1, s[16:19], s51 offen offset:0 sc1
    buffer_load_dword v26, v8, s[16:19], 0 offen offset:0 sc1
    v_cos_f32 v52, v44
    v_sin_f32 v60, v44
    v_cos_f32 v53, v45
    v_sin_f32 v61, v45
    v_cos_f32 v54, v46
    s_branch L2_skip8
.p2align 12
L2_pad8:
    s_branch L2_ret8
    s_nop 0
L2_skip8:
    v_sin_f32 v62, v46
    v_cos_f32 v55, v47
    v_sin_f32 v63, v47
    v_cos_f32 v56, v48
    v_sin_f32 v64, v48
    v_cos_f32 v57, v49
    v_sin_f32 v65, v49
    v_cos_f32 v58, v50
    v_sin_f32 v66, v50
    v_cos_f32 v59, v51
    v_sin_f32 v67, v51
    v_cvt_pk_bf16_f32 v84, v52, v53
    v_cvt_pk_bf16_f32 v85, v54, v55
    v_cvt_pk_bf16_f32 v86, v56, v57
    v_cvt_pk_bf16_f32 v87, v58, v59
    v_cvt_pk_bf16_f32 v88, v60, v61
    v_cvt_pk_bf16_f32 v89, v62, v63
    v_cvt_pk_bf16_f32 v90, v64, v65
    v_cvt_pk_bf16_f32 v91, v66, v67
    v_fmamk_f32 v44, v10, 0x42000000, v11
    v_fmamk_f32 v45, v10, 0x42080000, v11
    v_fmamk_f32 v46, v10, 0x42100000, v11
    v_fmamk_f32 v47, v10, 0x42180000, v11
    v_fmamk_f32 v48, v10, 0x42400000, v11
    v_fmamk_f32 v49, v10, 0x42480000, v11
    v_fmamk_f32 v50, v10, 0x42500000, v11
    v_fmamk_f32 v51, v10, 0x42580000, v11
    v_cos_f32 v68, v44
    v_sin_f32 v76, v44
    v_cos_f32 v69, v45
    v_sin_f32 v77, v45
    v_cos_f32 v70, v46
    v_sin_f32 v78, v46
    v_cos_f32 v71, v47
    v_sin_f32 v79, v47
    v_cos_f32 v72, v48
    v_sin_f32 v80, v48
    v_cos_f32 v73, v49
    v_sin_f32 v81, v49
    v_cos_f32 v74, v50
    v_sin_f32 v82, v50
    v_cos_f32 v75, v51
    v_sin_f32 v83, v51
    v_cvt_pk_bf16_f32 v92, v68, v69
    v_cvt_pk_bf16_f32 v93, v70, v71
    v_cvt_pk_bf16_f32 v94, v72, v73
    v_cvt_pk_bf16_f32 v95, v74, v75
    v_cvt_pk_bf16_f32 v96, v76, v77
    v_cvt_pk_bf16_f32 v97, v78, v79
    v_cvt_pk_bf16_f32 v98, v80, v81
    v_cvt_pk_bf16_f32 v99, v82, v83
    v_pk_fma_f32 v[52:53], v[68:69], v[24:25], v[52:53] neg_lo:[0,0,1] neg_hi:[0,0,1]
    v_pk_fma_f32 v[54:55], v[70:71], v[24:25], v[54:55] neg_lo:[0,0,1] neg_hi:[0,0,1]
    v_pk_fma_f32 v[56:57], v[72:73], v[24:25], v[56:57] neg_lo:[0,0,1] neg_hi:[0,0,1]
    v_pk_fma_f32 v[58:59], v[74:75], v[24:25], v[58:59] neg_lo:[0,0,1] neg_hi:[0,0,1]
    v_pk_fma_f32 v[60:61], v[76:77], v[24:25], v[60:61] neg_lo:[0,0,1] neg_hi:[0,0,1]
    v_pk_fma_f32 v[62:63], v[78:79], v[24:25], v[62:63] neg_lo:[0,0,1] neg_hi:[0,0,1]
    v_pk_fma_f32 v[64:65], v[80:81], v[24:25], v[64:65] neg_lo:[0,0,1] neg_hi:[0,0,1]
    v_pk_fma_f32 v[66:67], v[82:83], v[24:25], v[66:67] neg_lo:[0,0,1] neg_hi:[0,0,1]
    v_cvt_pk_bf16_f32 v100, v52, v53
    v_cvt_pk_bf16_f32 v101, v54, v55
    v_cvt_pk_bf16_f32 v102, v56, v57
    v_cvt_pk_bf16_f32 v103, v58, v59
    v_cvt_pk_bf16_f32 v104, v60, v61
    v_cvt_pk_bf16_f32 v105, v62, v63
    v_cvt_pk_bf16_f32 v106, v64, v65
    v_cvt_pk_bf16_f32 v107, v66, v67
    v_pk_fma_f32 v[68:69], v[52:53], v[24:25], v[68:69] neg_lo:[0,0,1] neg_hi:[0,0,1]
    v_pk_fma_f32 v[70:71], v[54:55], v[24:25], v[70:71] neg_lo:[0,0,1] neg_hi:[0,0,1]
    v_pk_fma_f32 v[72:73], v[56:57], v[24:25], v[72:73] neg_lo:[0,0,1] neg_hi:[0,0,1]
    v_pk_fma_f32 v[74:75], v[58:59], v[24:25], v[74:75] neg_lo:[0,0,1] neg_hi:[0,0,1]
    v_pk_fma_f32 v[76:77], v[60:61], v[24:25], v[76:77] neg_lo:[0,0,1] neg_hi:[0,0,1]
    v_pk_fma_f32 v[78:79], v[62:63], v[24:25], v[78:79] neg_lo:[0,0,1] neg_hi:[0,0,1]
    v_pk_fma_f32 v[80:81], v[64:65], v[24:25], v[80:81] neg_lo:[0,0,1] neg_hi:[0,0,1]
    v_pk_fma_f32 v[82:83], v[66:67], v[24:25], v[82:83] neg_lo:[0,0,1] neg_hi:[0,0,1]
    v_cvt_pk_bf16_f32 v108, v68, v69
    v_cvt_pk_bf16_f32 v109, v70, v71
    v_cvt_pk_bf16_f32 v110, v72, v73
    v_cvt_pk_bf16_f32 v111, v74, v75
    v_cvt_pk_bf16_f32 v112, v76, v77
    v_cvt_pk_bf16_f32 v113, v78, v79
    v_cvt_pk_bf16_f32 v114, v80, v81
    v_cvt_pk_bf16_f32 v115, v82, v83
    v_pk_fma_f32 v[52:53], v[68:69], v[24:25], v[52:53] neg_lo:[0,0,1] neg_hi:[0,0,1]
    v_pk_fma_f32 v[54:55], v[70:71], v[24:25], v[54:55] neg_lo:[0,0,1] neg_hi:[0,0,1]
    v_pk_fma_f32 v[56:57], v[72:73], v[24:25], v[56:57] neg_lo:[0,0,1] neg_hi:[0,0,1]
    v_pk_fma_f32 v[58:59], v[74:75], v[24:25], v[58:59] neg_lo:[0,0,1] neg_hi:[0,0,1]
    v_pk_fma_f32 v[60:61], v[76:77], v[24:25], v[60:61] neg_lo:[0,0,1] neg_hi:[0,0,1]
    v_pk_fma_f32 v[62:63], v[78:79], v[24:25], v[62:63] neg_lo:[0,0,1] neg_hi:[0,0,1]
    v_pk_fma_f32 v[64:65], v[80:81], v[24:25], v[64:65] neg_lo:[0,0,1] neg_hi:[0,0,1]
    v_pk_fma_f32 v[66:67], v[82:83], v[24:25], v[66:67] neg_lo:[0,0,1] neg_hi:[0,0,1]
    v_cvt_pk_bf16_f32 v116, v52, v53
    v_cvt_pk_bf16_f32 v117, v54, v55
    v_cvt_pk_bf16_f32 v118, v56, v57
    v_cvt_pk_bf16_f32 v119, v58, v59
    v_cvt_pk_bf16_f32 v120, v60, v61
    v_cvt_pk_bf16_f32 v121, v62, v63
    v_cvt_pk_bf16_f32 v122, v64, v65
    v_cvt_pk_bf16_f32 v123, v66, v67
    v_pk_fma_f32 v[68:69], v[52:53], v[24:25], v[68:69] neg_lo:[0,0,1] neg_hi:[0,0,1]
    v_pk_fma_f32 v[70:71], v[54:55], v[24:25], v[70:71] neg_lo:[0,0,1] neg_hi:[0,0,1]
    v_pk_fma_f32 v[72:73], v[56:57], v[24:25], v[72:73] neg_lo:[0,0,1] neg_hi:[0,0,1]
    v_pk_fma_f32 v[74:75], v[58:59], v[24:25], v[74:75] neg_lo:[0,0,1] neg_hi:[0,0,1]
    v_pk_fma_f32 v[76:77], v[60:61], v[24:25], v[76:77] neg_lo:[0,0,1] neg_hi:[0,0,1]
    v_pk_fma_f32 v[78:79], v[62:63], v[24:25], v[78:79] neg_lo:[0,0,1] neg_hi:[0,0,1]
    v_pk_fma_f32 v[80:81], v[64:65], v[24:25], v[80:81] neg_lo:[0,0,1] neg_hi:[0,0,1]
    v_pk_fma_f32 v[82:83], v[66:67], v[24:25], v[82:83] neg_lo:[0,0,1] neg_hi:[0,0,1]
    v_cvt_pk_bf16_f32 v124, v68, v69
    v_cvt_pk_bf16_f32 v125, v70, v71
    v_cvt_pk_bf16_f32 v126, v72, v73
    v_cvt_pk_bf16_f32 v127, v74, v75
    v_cvt_pk_bf16_f32 v128, v76, v77
    v_cvt_pk_bf16_f32 v129, v78, v79
    v_cvt_pk_bf16_f32 v130, v80, v81
    v_cvt_pk_bf16_f32 v131, v82, v83
    v_pk_fma_f32 v[52:53], v[68:69], v[24:25], v[52:53] neg_lo:[0,0,1] neg_hi:[0,0,1]
    v_pk_fma_f32 v[54:55], v[70:71], v[24:25], v[54:55] neg_lo:[0,0,1] neg_hi:[0,0,1]
    v_pk_fma_f32 v[56:57], v[72:73], v[24:25], v[56:57] neg_lo:[0,0,1] neg_hi:[0,0,1]
    v_pk_fma_f32 v[58:59], v[74:75], v[24:25], v[58:59] neg_lo:[0,0,1] neg_hi:[0,0,1]
    v_pk_fma_f32 v[60:61], v[76:77], v[24:25], v[60:61] neg_lo:[0,0,1] neg_hi:[0,0,1]
    v_pk_fma_f32 v[62:63], v[78:79], v[24:25], v[62:63] neg_lo:[0,0,1] neg_hi:[0,0,1]
    v_pk_fma_f32 v[64:65], v[80:81], v[24:25], v[64:65] neg_lo:[0,0,1] neg_hi:[0,0,1]
    v_pk_fma_f32 v[66:67], v[82:83], v[24:25], v[66:67] neg_lo:[0,0,1] neg_hi:[0,0,1]
    v_cvt_pk_bf16_f32 v132, v52, v53
    v_cvt_pk_bf16_f32 v133, v54, v55
    v_cvt_pk_bf16_f32 v134, v56, v57
    v_cvt_pk_bf16_f32 v135, v58, v59
    v_cvt_pk_bf16_f32 v136, v60, v61
    v_cvt_pk_bf16_f32 v137, v62, v63
    v_cvt_pk_bf16_f32 v138, v64, v65
    v_cvt_pk_bf16_f32 v139, v66, v67
    v_pk_fma_f32 v[68:69], v[52:53], v[24:25], v[68:69] neg_lo:[0,0,1] neg_hi:[0,0,1]
    v_pk_fma_f32 v[70:71], v[54:55], v[24:25], v[70:71] neg_lo:[0,0,1] neg_hi:[0,0,1]
    v_pk_fma_f32 v[72:73], v[56:57], v[24:25], v[72:73] neg_lo:[0,0,1] neg_hi:[0,0,1]
    v_pk_fma_f32 v[74:75], v[58:59], v[24:25], v[74:75] neg_lo:[0,0,1] neg_hi:[0,0,1]
    v_pk_fma_f32 v[76:77], v[60:61], v[24:25], v[76:77] neg_lo:[0,0,1] neg_hi:[0,0,1]
    v_pk_fma_f32 v[78:79], v[62:63], v[24:25], v[78:79] neg_lo:[0,0,1] neg_hi:[0,0,1]
    v_pk_fma_f32 v[80:81], v[64:65], v[24:25], v[80:81] neg_lo:[0,0,1] neg_hi:[0,0,1]
    v_pk_fma_f32 v[82:83], v[66:67], v[24:25], v[82:83] neg_lo:[0,0,1] neg_hi:[0,0,1]
    v_cvt_pk_bf16_f32 v140, v68, v69
    v_cvt_pk_bf16_f32 v141, v70, v71
    v_cvt_pk_bf16_f32 v142, v72, v73
    v_cvt_pk_bf16_f32 v143, v74, v75
    v_cvt_pk_bf16_f32 v144, v76, v77
    v_cvt_pk_bf16_f32 v145, v78, v79
    v_cvt_pk_bf16_f32 v146, v80, v81
    v_cvt_pk_bf16_f32 v147, v82, v83
    v_pk_fma_f32 v[52:53], v[68:69], v[24:25], v[52:53] neg_lo:[0,0,1] neg_hi:[0,0,1]
    v_pk_fma_f32 v[54:55], v[70:71], v[24:25], v[54:55] neg_lo:[0,0,1] neg_hi:[0,0,1]
    v_pk_fma_f32 v[56:57], v[72:73], v[24:25], v[56:57] neg_lo:[0,0,1] neg_hi:[0,0,1]
    v_pk_fma_f32 v[58:59], v[74:75], v[24:25], v[58:59] neg_lo:[0,0,1] neg_hi:[0,0,1]
    v_pk_fma_f32 v[60:61], v[76:77], v[24:25], v[60:61] neg_lo:[0,0,1] neg_hi:[0,0,1]
    v_pk_fma_f32 v[62:63], v[78:79], v[24:25], v[62:63] neg_lo:[0,0,1] neg_hi:[0,0,1]
    v_pk_fma_f32 v[64:65], v[80:81], v[24:25], v[64:65] neg_lo:[0,0,1] neg_hi:[0,0,1]
    v_pk_fma_f32 v[66:67], v[82:83], v[24:25], v[66:67] neg_lo:[0,0,1] neg_hi:[0,0,1]
    v_cvt_pk_bf16_f32 v148, v52, v53
    v_cvt_pk_bf16_f32 v149, v54, v55
    v_cvt_pk_bf16_f32 v150, v56, v57
    v_cvt_pk_bf16_f32 v151, v58, v59
    v_cvt_pk_bf16_f32 v152, v60, v61
    v_cvt_pk_bf16_f32 v153, v62, v63
    v_cvt_pk_bf16_f32 v154, v64, v65
    v_cvt_pk_bf16_f32 v155, v66, v67
    s_waitcnt vmcnt(0) lgkmcnt(0)
    s_barrier
    v_mov_b32 v222, 1
    s_mov_b64 exec, 1
    buffer_store_dword v222, off, s[16:19], s101 offset:128 sc1
    s_mov_b64 exec, -1
    s_cmp_ge_u32 s2, 192
    s_cbranch_scc1 L4_done
    ds_read_b64_tr_b16 v[172:173], v41 offset:16384
    ds_read_b64_tr_b16 v[180:181], v42 offset:16384
    ds_read_b64_tr_b16 v[174:175], v41 offset:16896
    ds_read_b64_tr_b16 v[182:183], v42 offset:16896
    ds_read_b64_tr_b16 v[176:177], v41 offset:18432
    ds_read_b64_tr_b16 v[184:185], v42 offset:18432
    ds_read_b64_tr_b16 v[178:179], v41 offset:18944
    ds_read_b64_tr_b16 v[186:187], v42 offset:18944
    ds_read_b64_tr_b16 v[156:157], v41 offset:0
    ds_read_b64_tr_b16 v[164:165], v42 offset:0
    ds_read_b64_tr_b16 v[158:159], v41 offset:512
    ds_read_b64_tr_b16 v[166:167], v42 offset:512
    ds_read_b64_tr_b16 v[160:161], v41 offset:2048
    ds_read_b64_tr_b16 v[168:169], v42 offset:2048
    ds_read_b64_tr_b16 v[162:163], v41 offset:2560
    ds_read_b64_tr_b16 v[170:171], v42 offset:2560
    ds_read_b128 a[112:115], v40 offset:0
    ds_read_b128 a[116:119], v40 offset:32
    ds_read_b128 a[120:123], v40 offset:64
    ds_read_b128 a[124:127], v40 offset:96
    v_cmp_le_u32 s[56:57], 1, v26
    s_nop 0
    s_cmp_eq_u64 s[56:57], -1
    s_cbranch_scc1 L4_kg0
    buffer_load_dword v26, v8, s[16:19], 0 offen offset:0 sc1
    s_mov_b32 s39, 0
L4_alg0:
    s_waitcnt vmcnt(0)
    v_cmp_le_u32 s[56:57], 1, v26
    s_add_u32 s39, s39, 1
    s_cmp_eq_u64 s[56:57], -1
    s_cbranch_scc1 L4_kg0
    s_sleep 4
    buffer_load_dword v26, v8, s[16:19], 0 offen offset:0 sc1
    s_cmp_lt_u32 s39, 0x10000
    s_cbranch_scc1 L4_alg0
L4_kg0:
    buffer_load_dword v28, v8, s[16:19], 0 offen offset:0 sc1
    v_cmp_le_u32 s[56:57], 1, v26
    s_nop 0
    s_cmp_eq_u64 s[56:57], -1
    s_cselect_b32 s62, s23, 0x40000000
    s_cselect_b32 s61, 1, 0
    s_or_b32 s5, s5, s61
    s_mov_b32 s8, s52
    s_mov_b32 s9, s53
    s_mov_b32 s10, 2359296
    s_mov_b32 s11, 0x20000
    s_mov_b32 s12, s40
    s_mov_b32 s13, s41
    s_mov_b32 s14, 2359296
    s_mov_b32 s15, 0x20000
    s_sub_u32 s44, 8, s28
    s_lshl_b32 s45, s44, 12
    v_add_u32 v41, s45, v41
    v_add_u32 v42, s45, v42
    s_lshl_b32 s44, s44, 11
    s_lshl_b32 s45, s32, 10
    s_add_u32 s44, s44, s45
    s_xor_b32 s45, s32, s31
    s_waitcnt lgkmcnt(0)
    v_mfma_f32_32x32x16_bf16 v[224:239], v[172:175], v[196:199], 0
    s_add_u32 s6, s62, 0
    buffer_load_dwordx4 a[0:3], v6, s[16:19], s6 offen sc1
    v_mfma_f32_32x32x16_bf16 v[224:239], v[180:183], v[212:215], v[224:239]
    s_add_u32 s6, s62, 2359296
    buffer_load_dwordx4 a[4:7], v6, s[16:19], s6 offen sc1
    v_mfma_f32_32x32x16_bf16 v[224:239], v[176:179], v[200:203], v[224:239]
    s_add_u32 s6, s62, 4718592
    buffer_load_dwordx4 a[8:11], v6, s[16:19], s6 offen sc1
    v_mfma_f32_32x32x16_bf16 v[224:239], v[184:187], v[216:219], v[224:239]
    s_add_u32 s6, s62, 7077888
    buffer_load_dwordx4 a[12:15], v6, s[16:19], s6 offen sc1
    v_mfma_f32_32x32x16_bf16 v[240:255], v[172:175], v[204:207], 0
    s_add_u32 s6, s62, 9437184
    buffer_load_dwordx4 a[16:19], v6, s[16:19], s6 offen sc1
    v_mfma_f32_32x32x16_bf16 v[240:255], v[180:183], v[196:199], v[240:255]
    s_add_u32 s6, s62, 11796480
    buffer_load_dwordx4 a[20:23], v6, s[16:19], s6 offen sc1
    v_mfma_f32_32x32x16_bf16 v[240:255], v[176:179], v[208:211], v[240:255]
    s_nop 2
    v_cvt_pk_bf16_f32 v30, v224, v225
    v_cvt_pk_bf16_f32 v31, v226, v227
    v_cvt_pk_bf16_f32 v32, v228, v229
    v_cvt_pk_bf16_f32 v33, v230, v231
    v_cvt_pk_bf16_f32 v34, v232, v233
    v_mfma_f32_32x32x16_bf16 v[240:255], v[184:187], v[200:203], v[240:255]
    v_cvt_pk_bf16_f32 v35, v234, v235
    v_cvt_pk_bf16_f32 v36, v236, v237
    v_cvt_pk_bf16_f32 v37, v238, v239
    ds_write_b128 v2, v[30:33] offset:8192
    ds_write_b128 v2, v[34:37] offset:26624
    ds_read_b64_tr_b16 v[172:173], v41 offset:0
    ds_read_b64_tr_b16 v[180:181], v42 offset:0
    ds_read_b64_tr_b16 v[174:175], v41 offset:512
    ds_read_b64_tr_b16 v[182:183], v42 offset:512
    ds_read_b64_tr_b16 v[176:177], v41 offset:2048
    ds_read_b64_tr_b16 v[184:185], v42 offset:2048
    ds_read_b64_tr_b16 v[178:179], v41 offset:2560
    ds_read_b64_tr_b16 v[186:187], v42 offset:2560
    v_mfma_f32_32x32x16_bf16 v[224:239], v[156:159], v[196:199], 0
    s_add_u32 s6, s62, 14155776
    buffer_load_dwordx4 a[24:27], v6, s[16:19], s6 offen sc1
    v_mfma_f32_32x32x16_bf16 v[224:239], v[164:167], v[212:215], v[224:239]
    s_add_u32 s6, s62, 16515072
    buffer_load_dwordx4 a[28:31], v6, s[16:19], s6 offen sc1
    v_mfma_f32_32x32x16_bf16 v[224:239], v[160:163], v[200:203], v[224:239]
    v_cvt_pk_bf16_f32 v16, v240, v241
    v_cvt_pk_bf16_f32 v17, v242, v243
    v_cvt_pk_bf16_f32 v18, v244, v245
    v_cvt_pk_bf16_f32 v19, v246, v247
    v_cvt_pk_bf16_f32 v20, v248, v249
    v_mfma_f32_32x32x16_bf16 v[224:239], v[168:171], v[216:219], v[224:239]
    v_cvt_pk_bf16_f32 v21, v250, v251
    v_cvt_pk_bf16_f32 v22, v252, v253
    v_cvt_pk_bf16_f32 v23, v254, v255
    ds_write_b128 v2, v[16:19] offset:9216
    ds_write_b128 v2, v[20:23] offset:27648
    s_cmp_lg_u32 s28, 0
    s_cbranch_scc1 L4_ns
    s_mov_b32 exec_lo, 1
    s_mov_b32 exec_hi, 1
    v_accvgpr_read_b32 v164, a112
    v_accvgpr_read_b32 v156, a120
    v_accvgpr_read_b32 v165, a113
    v_accvgpr_read_b32 v157, a121
    v_accvgpr_read_b32 v166, a114
    v_accvgpr_read_b32 v158, a122
    v_accvgpr_read_b32 v167, a115
    v_accvgpr_read_b32 v159, a123
    v_accvgpr_read_b32 v168, a116
    v_accvgpr_read_b32 v160, a124
    v_accvgpr_read_b32 v169, a117
    v_accvgpr_read_b32 v161, a125
    v_accvgpr_read_b32 v170, a118
    v_accvgpr_read_b32 v162, a126
    v_accvgpr_read_b32 v171, a119
    v_accvgpr_read_b32 v163, a127
    v_xor_b32 v156, 0x80008000, v156
    v_xor_b32 v157, 0x80008000, v157
    v_xor_b32 v158, 0x80008000, v158
    v_xor_b32 v159, 0x80008000, v159
    v_xor_b32 v160, 0x80008000, v160
    v_xor_b32 v161, 0x80008000, v161
    v_xor_b32 v162, 0x80008000, v162
    v_xor_b32 v163, 0x80008000, v163
    s_mov_b64 exec, -1
    s_nop 1
L4_ns:
    v_mfma_f32_32x32x16_bf16 v[240:255], v[156:159], v[204:207], 0
    v_mfma_f32_32x32x16_bf16 v[240:255], v[164:167], v[196:199], v[240:255]
    v_mfma_f32_32x32x16_bf16 v[240:255], v[160:163], v[208:211], v[240:255]
    s_nop 1
    v_cvt_pk_bf16_f32 v30, v224, v225
    v_cvt_pk_bf16_f32 v31, v226, v227
    v_cvt_pk_bf16_f32 v32, v228, v229
    v_cvt_pk_bf16_f32 v33, v230, v231
    v_cvt_pk_bf16_f32 v34, v232, v233
    v_mfma_f32_32x32x16_bf16 v[240:255], v[168:171], v[200:203], v[240:255]
    v_cvt_pk_bf16_f32 v35, v234, v235
    v_cvt_pk_bf16_f32 v36, v236, v237
    v_cvt_pk_bf16_f32 v37, v238, v239
    ds_write_b128 v2, v[30:33] offset:0
    ds_write_b128 v2, v[34:37] offset:18432
    s_waitcnt lgkmcnt(2)
    s_cmp_lg_u32 s28, 1
    s_cbranch_scc1 L4_v1
    v_mfma_f32_32x32x16_bf16 v[224:239], v[172:175], v[196:199], 0
    v_mfma_f32_32x32x16_bf16 v[224:239], v[180:183], v[212:215], v[224:239]
    v_mfma_f32_32x32x16_bf16 v[224:239], v[176:179], v[200:203], v[224:239]
    v_mfma_f32_32x32x16_bf16 v[224:239], v[184:187], v[216:219], v[224:239]
L4_v1:
    s_cmp_lg_u32 s28, 2
    s_cbranch_scc1 L4_v2
    s_nop 7
    v_mfma_f32_32x32x16_bf16 v[224:239], v[172:175], v[204:207], 0
    v_mfma_f32_32x32x16_bf16 v[224:239], v[180:183], v[196:199], v[224:239]
    v_mfma_f32_32x32x16_bf16 v[224:239], v[176:179], v[208:211], v[224:239]
    v_mfma_f32_32x32x16_bf16 v[224:239], v[184:187], v[200:203], v[224:239]
L4_v2:
    s_nop 1
    v_cvt_pk_bf16_f32 v16, v240, v241
    v_cvt_pk_bf16_f32 v17, v242, v243
    v_cvt_pk_bf16_f32 v18, v244, v245
    v_cvt_pk_bf16_f32 v19, v246, v247
    v_cvt_pk_bf16_f32 v20, v248, v249
    v_cvt_pk_bf16_f32 v21, v250, v251
    v_cvt_pk_bf16_f32 v22, v252, v253
    v_cvt_pk_bf16_f32 v23, v254, v255
    ds_write_b128 v2, v[16:19] offset:1024
    ds_write_b128 v2, v[20:23] offset:19456
    s_cmp_eq_u32 s45, 0
    s_cbranch_scc1 L4_v3
    v_add_u32 v2, s44, v2
    v_cvt_pk_bf16_f32 v30, v224, v225
    v_cvt_pk_bf16_f32 v31, v226, v227
    v_cvt_pk_bf16_f32 v32, v228, v229
    v_cvt_pk_bf16_f32 v33, v230, v231
    v_cvt_pk_bf16_f32 v34, v232, v233
    v_cvt_pk_bf16_f32 v35, v234, v235
    v_cvt_pk_bf16_f32 v36, v236, v237
    v_cvt_pk_bf16_f32 v37, v238, v239
    ds_write_b128 v2, v[30:33] offset:0
    ds_write_b128 v2, v[34:37] offset:18432
L4_v3:
    s_waitcnt vmcnt(8)
    v_cmp_le_u32 s[56:57], 2, v28
    s_nop 0
    s_cmp_eq_u64 s[56:57], -1
    s_cbranch_scc1 L4_kg1
    buffer_load_dword v28, v8, s[16:19], 0 offen offset:0 sc1
    s_mov_b32 s39, 0
L4_alg1:
    s_waitcnt vmcnt(0)
    v_cmp_le_u32 s[56:57], 2, v28
    s_add_u32 s39, s39, 1
    s_cmp_eq_u64 s[56:57], -1
    s_cbranch_scc1 L4_kg1
    s_sleep 4
    buffer_load_dword v28, v8, s[16:19], 0 offen offset:0 sc1
    s_cmp_lt_u32 s39, 0x10000
    s_cbranch_scc1 L4_alg1
L4_kg1:
    v_cmp_le_u32 s[56:57], 2, v28
    s_nop 0
    s_cmp_eq_u64 s[56:57], -1
    s_cselect_b32 s62, s7, 0x40000000
    s_cselect_b32 s61, 2, 0
    s_or_b32 s5, s5, s61
    s_add_u32 s34, s30, 3
    s_lshl_b32 s33, s34, 5
    v_add_u32 v10, s33, v12
    v_cvt_f32_u32 v10, v10
    v_mul_f32 v10, s35, v10
    v_fma_f32 v11, v13, v10, s50
    v_mul_f32 v24, 0x42000000, v10
    v_cos_f32 v24, v24
    s_nop 0
    v_add_f32 v24, v24, v24
    v_mov_b32 v25, v24
    v_mov_b32 v44, v11
    v_fmamk_f32 v45, v10, 0x40000000, v11
    s_add_u32 s6, s62, 0
    buffer_load_dwordx4 a[32:35], v6, s[16:19], s6 offen sc1
    v_fmamk_f32 v46, v10, 0x40800000, v11
    v_fmamk_f32 v47, v10, 0x40c00000, v11
    v_fmamk_f32 v48, v10, 0x41800000, v11
    v_fmamk_f32 v49, v10, 0x41900000, v11
    v_fmamk_f32 v50, v10, 0x41a00000, v11
    v_fmamk_f32 v51, v10, 0x41b00000, v11
    v_cos_f32 v52, v44
    v_cos_f32 v53, v45
    v_cos_f32 v54, v46
    v_cos_f32 v55, v47
    v_cos_f32 v56, v48
    v_cos_f32 v57, v49
    s_add_u32 s6, s62, 2359296
    buffer_load_dwordx4 a[36:39], v6, s[16:19], s6 offen sc1
    v_cos_f32 v58, v50
    v_cos_f32 v59, v51
    v_cvt_pk_bf16_f32 v156, v52, v53
    v_cvt_pk_bf16_f32 v157, v54, v55
    v_cvt_pk_bf16_f32 v158, v56, v57
    v_cvt_pk_bf16_f32 v159, v58, v59
    v_fmamk_f32 v44, v10, 0x42000000, v11
    v_fmamk_f32 v45, v10, 0x42080000, v11
    v_fmamk_f32 v46, v10, 0x42100000, v11
    v_fmamk_f32 v47, v10, 0x42180000, v11
    v_fmamk_f32 v48, v10, 0x42400000, v11
    v_fmamk_f32 v49, v10, 0x42480000, v11
    s_add_u32 s6, s62, 4718592
    buffer_load_dwordx4 a[40:43], v6, s[16:19], s6 offen sc1
    v_fmamk_f32 v50, v10, 0x42500000, v11
    v_fmamk_f32 v51, v10, 0x42580000, v11
    v_cos_f32 v68, v44
    v_cos_f32 v69, v45
    v_cos_f32 v70, v46
    v_cos_f32 v71, v47
    v_cos_f32 v72, v48
    v_cos_f32 v73, v49
    v_cos_f32 v74, v50
    v_cos_f32 v75, v51
    v_cvt_pk_bf16_f32 v160, v68, v69
    v_cvt_pk_bf16_f32 v161, v70, v71
    s_add_u32 s6, s62, 7077888
    buffer_load_dwordx4 a[44:47], v6, s[16:19], s6 offen sc1
    v_cvt_pk_bf16_f32 v162, v72, v73
    v_cvt_pk_bf16_f32 v163, v74, v75
    v_pk_fma_f32 v[52:53], v[68:69], v[24:25], v[52:53] neg_lo:[0,0,1] neg_hi:[0,0,1]
    v_pk_fma_f32 v[54:55], v[70:71], v[24:25], v[54:55] neg_lo:[0,0,1] neg_hi:[0,0,1]
    v_pk_fma_f32 v[56:57], v[72:73], v[24:25], v[56:57] neg_lo:[0,0,1] neg_hi:[0,0,1]
    v_pk_fma_f32 v[58:59], v[74:75], v[24:25], v[58:59] neg_lo:[0,0,1] neg_hi:[0,0,1]
    v_cvt_pk_bf16_f32 v164, v52, v53
    v_cvt_pk_bf16_f32 v165, v54, v55
    v_cvt_pk_bf16_f32 v166, v56, v57
    v_cvt_pk_bf16_f32 v167, v58, v59
    v_pk_fma_f32 v[68:69], v[52:53], v[24:25], v[68:69] neg_lo:[0,0,1] neg_hi:[0,0,1]
    v_pk_fma_f32 v[70:71], v[54:55], v[24:25], v[70:71] neg_lo:[0,0,1] neg_hi:[0,0,1]
    s_add_u32 s6, s62, 9437184
    buffer_load_dwordx4 a[48:51], v6, s[16:19], s6 offen sc1
    v_pk_fma_f32 v[72:73], v[56:57], v[24:25], v[72:73] neg_lo:[0,0,1] neg_hi:[0,0,1]
    v_pk_fma_f32 v[74:75], v[58:59], v[24:25], v[74:75] neg_lo:[0,0,1] neg_hi:[0,0,1]
    v_cvt_pk_bf16_f32 v168, v68, v69
    v_cvt_pk_bf16_f32 v169, v70, v71
    v_cvt_pk_bf16_f32 v170, v72, v73
    v_cvt_pk_bf16_f32 v171, v74, v75
    v_pk_fma_f32 v[52:53], v[68:69], v[24:25], v[52:53] neg_lo:[0,0,1] neg_hi:[0,0,1]
    v_pk_fma_f32 v[54:55], v[70:71], v[24:25], v[54:55] neg_lo:[0,0,1] neg_hi:[0,0,1]
    v_pk_fma_f32 v[56:57], v[72:73], v[24:25], v[56:57] neg_lo:[0,0,1] neg_hi:[0,0,1]
    v_pk_fma_f32 v[58:59], v[74:75], v[24:25], v[58:59] neg_lo:[0,0,1] neg_hi:[0,0,1]
    v_cvt_pk_bf16_f32 v172, v52, v53
    v_cvt_pk_bf16_f32 v173, v54, v55
    s_add_u32 s6, s62, 11796480
    buffer_load_dwordx4 a[52:55], v6, s[16:19], s6 offen sc1
    v_cvt_pk_bf16_f32 v174, v56, v57
    v_cvt_pk_bf16_f32 v175, v58, v59
    v_pk_fma_f32 v[68:69], v[52:53], v[24:25], v[68:69] neg_lo:[0,0,1] neg_hi:[0,0,1]
    v_pk_fma_f32 v[70:71], v[54:55], v[24:25], v[70:71] neg_lo:[0,0,1] neg_hi:[0,0,1]
    v_pk_fma_f32 v[72:73], v[56:57], v[24:25], v[72:73] neg_lo:[0,0,1] neg_hi:[0,0,1]
    v_pk_fma_f32 v[74:75], v[58:59], v[24:25], v[74:75] neg_lo:[0,0,1] neg_hi:[0,0,1]
    v_cvt_pk_bf16_f32 v176, v68, v69
    v_cvt_pk_bf16_f32 v177, v70, v71
    v_cvt_pk_bf16_f32 v178, v72, v73
    v_cvt_pk_bf16_f32 v179, v74, v75
    v_pk_fma_f32 v[52:53], v[68:69], v[24:25], v[52:53] neg_lo:[0,0,1] neg_hi:[0,0,1]
    v_pk_fma_f32 v[54:55], v[70:71], v[24:25], v[54:55] neg_lo:[0,0,1] neg_hi:[0,0,1]
    s_add_u32 s6, s62, 14155776
    buffer_load_dwordx4 a[56:59], v6, s[16:19], s6 offen sc1
    v_pk_fma_f32 v[56:57], v[72:73], v[24:25], v[56:57] neg_lo:[0,0,1] neg_hi:[0,0,1]
    v_pk_fma_f32 v[58:59], v[74:75], v[24:25], v[58:59] neg_lo:[0,0,1] neg_hi:[0,0,1]
    v_cvt_pk_bf16_f32 v180, v52, v53
    v_cvt_pk_bf16_f32 v181, v54, v55
    v_cvt_pk_bf16_f32 v182, v56, v57
    v_cvt_pk_bf16_f32 v183, v58, v59
    v_pk_fma_f32 v[68:69], v[52:53], v[24:25], v[68:69] neg_lo:[0,0,1] neg_hi:[0,0,1]
    v_pk_fma_f32 v[70:71], v[54:55], v[24:25], v[70:71] neg_lo:[0,0,1] neg_hi:[0,0,1]
    v_pk_fma_f32 v[72:73], v[56:57], v[24:25], v[72:73] neg_lo:[0,0,1] neg_hi:[0,0,1]
    v_pk_fma_f32 v[74:75], v[58:59], v[24:25], v[74:75] neg_lo:[0,0,1] neg_hi:[0,0,1]
    v_cvt_pk_bf16_f32 v184, v68, v69
    v_cvt_pk_bf16_f32 v185, v70, v71
    s_add_u32 s6, s62, 16515072
    buffer_load_dwordx4 a[60:63], v6, s[16:19], s6 offen sc1
    v_cvt_pk_bf16_f32 v186, v72, v73
    s_branch L2_skip9
.p2align 12
L2_pad9:
    s_branch L2_ret9
    s_nop 0
L2_skip9:
    v_cvt_pk_bf16_f32 v187, v74, v75
    v_pk_fma_f32 v[52:53], v[68:69], v[24:25], v[52:53] neg_lo:[0,0,1] neg_hi:[0,0,1]
    v_pk_fma_f32 v[54:55], v[70:71], v[24:25], v[54:55] neg_lo:[0,0,1] neg_hi:[0,0,1]
    v_pk_fma_f32 v[56:57], v[72:73], v[24:25], v[56:57] neg_lo:[0,0,1] neg_hi:[0,0,1]
    v_pk_fma_f32 v[58:59], v[74:75], v[24:25], v[58:59] neg_lo:[0,0,1] neg_hi:[0,0,1]
    v_cvt_pk_bf16_f32 v212, v52, v53
    v_cvt_pk_bf16_f32 v213, v54, v55
    v_cvt_pk_bf16_f32 v214, v56, v57
    v_cvt_pk_bf16_f32 v215, v58, v59
    v_cmp_eq_f32 vcc, 0, v13
    v_and_b32 v10, 1, v5
    v_lshlrev_b32 v10, 15, v10
    v_or_b32 v10, 0x3f00, v10
    v_mov_b32 v11, 0x3f00
    v_mov_b32 v24, s32
    v_cmp_eq_u32 s[46:47], 1, v24
    s_nop 1
    v_cndmask_b32 v24, v11, v10, s[46:47]
    v_cndmask_b32 v10, v10, v11, s[46:47]
    s_mov_b32 s44, 0xffff
    v_bfi_b32 v25, s44, v24, v84
    v_cndmask_b32 v84, v84, v25, vcc
    v_bfi_b32 v25, s44, v10, v88
    v_cndmask_b32 v88, v88, v25, vcc
    v_bfi_b32 v25, s44, v24, v156
    v_cndmask_b32 v156, v156, v25, vcc
    s_cmp_eq_u32 s5, 3
    s_cbranch_scc1 L4_ne
    buffer_load_dword v38, v8, s[16:19], 0 offen offset:0 sc1
L4_ne:
    s_waitcnt lgkmcnt(0)
    s_barrier
    ds_read_b128 v[16:19], v3 offset:0
    ds_read_b128 v[20:23], v39 offset:0
    ds_read_b128 v[28:31], v3 offset:2048
    ds_read_b128 v[32:35], v39 offset:2048
    ds_read_b128 v[44:47], v3 offset:4096
    ds_read_b128 v[48:51], v39 offset:4096
    ds_read_b128 v[52:55], v3 offset:6144
    ds_read_b128 v[56:59], v39 offset:6144
    ds_read_b128 v[60:63], v3 offset:8192
    ds_read_b128 v[64:67], v39 offset:8192
    ds_read_b128 v[68:71], v3 offset:10240
    s_waitcnt lgkmcnt(10)
    v_mfma_f32_32x32x16_bf16 v[224:239], v[84:87], v[16:19], 0
    ds_read_b128 v[72:75], v39 offset:10240
    v_mfma_f32_32x32x16_bf16 v[240:255], v[156:159], v[16:19], 0
    s_lshl_b32 s44, s28, 13
    s_add_u32 s44, s44, 75776
    v_add_u32 v14, s44, v1
    v_lshl_add_u32 v11, v4, 6, v6
    s_waitcnt lgkmcnt(10)
    v_mfma_f32_32x32x16_bf16 v[196:211], v[88:91], v[20:23], 0
    ds_read_b128 v[16:19], v3 offset:12288
    s_waitcnt lgkmcnt(10)
    v_mfma_f32_32x32x16_bf16 v[224:239], v[92:95], v[28:31], v[224:239]
    ds_read_b128 v[20:23], v39 offset:12288
    v_mfma_f32_32x32x16_bf16 v[240:255], v[160:163], v[28:31], v[240:255]
    s_lshl_b32 s44, s32, 14
    s_lshl_b32 s45, s31, 8
    s_add_u32 s44, s44, s45
    s_add_u32 s44, s44, 75776
    s_waitcnt lgkmcnt(10)
    v_mfma_f32_32x32x16_bf16 v[196:211], v[96:99], v[32:35], v[196:211]
    ds_read_b128 v[28:31], v3 offset:14336
    s_waitcnt lgkmcnt(10)
    v_mfma_f32_32x32x16_bf16 v[224:239], v[100:103], v[44:47], v[224:239]
    ds_read_b128 v[32:35], v39 offset:14336
    buffer_load_dword v7, v8, s[16:19], 0 offen offset:128 sc1
    v_mfma_f32_32x32x16_bf16 v[240:255], v[164:167], v[44:47], v[240:255]
    v_add_u32 v15, s44, v11
    s_lshl_b32 s44, s32, 8
    s_add_u32 s44, s44, 79872
    v_add_u32 v10, s44, v11
    s_waitcnt lgkmcnt(10)
    v_mfma_f32_32x32x16_bf16 v[196:211], v[104:107], v[48:51], v[196:211]
    ds_read_b128 v[44:47], v3 offset:16384
    buffer_load_dwordx4 a[96:99], v9, s[8:11], s96 offen
    s_waitcnt lgkmcnt(10)
    v_mfma_f32_32x32x16_bf16 v[224:239], v[108:111], v[52:55], v[224:239]
    ds_read_b128 v[48:51], v39 offset:16384
    buffer_load_dwordx4 a[100:103], v9, s[8:11], s97 offen
    v_mfma_f32_32x32x16_bf16 v[240:255], v[168:171], v[52:55], v[240:255]
    s_lshl_b32 s44, s31, 31
    s_xor_b32 s44, s44, 0x359dbac0
    v_mov_b32 v24, s44
    v_mov_b32 v25, s44
    s_waitcnt lgkmcnt(10)
    v_mfma_f32_32x32x16_bf16 v[196:211], v[112:115], v[56:59], v[196:211]
    buffer_load_dwordx4 a[104:107], v9, s[8:11], s98 offen
    s_waitcnt lgkmcnt(9)
    v_mfma_f32_32x32x16_bf16 v[224:239], v[116:119], v[60:63], v[224:239]
    v_mfma_f32_32x32x16_bf16 v[240:255], v[172:175], v[60:63], v[240:255]
    v_mov_b32 v4, 0x359dbac0
    v_mov_b32 v5, v4
    s_lshl_b32 s44, s32, 31
    s_xor_b32 s44, s44, 0x359dbac0
    s_waitcnt lgkmcnt(8)
    v_mfma_f32_32x32x16_bf16 v[196:211], v[120:123], v[64:67], v[196:211]
    s_waitcnt lgkmcnt(7)
    v_mfma_f32_32x32x16_bf16 v[224:239], v[124:127], v[68:71], v[224:239]
    v_mfma_f32_32x32x16_bf16 v[240:255], v[176:179], v[68:71], v[240:255]
    v_mov_b32 v26, s44
    v_mov_b32 v27, s44
    v_mov_b32 v12, 0x3f317218
    v_mov_b32 v13, v12
    s_waitcnt lgkmcnt(6)
    v_mfma_f32_32x32x16_bf16 v[196:211], v[128:131], v[72:75], v[196:211]
    s_waitcnt lgkmcnt(5)
    v_mfma_f32_32x32x16_bf16 v[224:239], v[132:135], v[16:19], v[224:239]
    v_mfma_f32_32x32x16_bf16 v[240:255], v[180:183], v[16:19], v[240:255]
    v_and_b32 v2, 15, v0
    v_lshlrev_b32 v2, 6, v2
    v_bfe_u32 v11, v0, 4, 1
    v_lshl_add_u32 v2, v11, 5, v2
    s_waitcnt lgkmcnt(4)
    v_mfma_f32_32x32x16_bf16 v[196:211], v[136:139], v[20:23], v[196:211]
    s_waitcnt lgkmcnt(3)
    v_mfma_f32_32x32x16_bf16 v[224:239], v[140:143], v[28:31], v[224:239]
    v_mfma_f32_32x32x16_bf16 v[240:255], v[184:187], v[28:31], v[240:255]
    v_bfe_u32 v11, v0, 5, 1
    v_lshl_add_u32 v2, v11, 4, v2
    v_add_u32 v2, s99, v2
    v_add_u32 v40, s99, v1
    s_waitcnt lgkmcnt(2)
    v_mfma_f32_32x32x16_bf16 v[196:211], v[144:147], v[32:35], v[196:211]
    s_waitcnt lgkmcnt(1)
    v_mfma_f32_32x32x16_bf16 v[224:239], v[148:151], v[44:47], v[224:239]
    v_mfma_f32_32x32x16_bf16 v[240:255], v[212:215], v[44:47], v[240:255]
    v_bfe_u32 v41, v0, 2, 4
    v_mul_u32_u24 v41, 73728, v41
    v_and_b32 v11, 3, v0
    v_lshl_add_u32 v41, v11, 4, v41
    s_waitcnt lgkmcnt(0)
    v_mfma_f32_32x32x16_bf16 v[196:211], v[152:155], v[48:51], v[196:211]
    s_waitcnt vmcnt(3)
    s_cmp_eq_u32 s5, 3
    s_cbranch_scc1 L4_got
    s_mov_b32 s39, 0
L4_alm:
    s_waitcnt vmcnt(0)
    v_cmp_le_u32 s[56:57], 2, v38
    s_add_u32 s39, s39, 1
    s_cmp_eq_u64 s[56:57], -1
    s_cbranch_scc1 L4_mr
    s_sleep 4
    buffer_load_dword v38, v8, s[16:19], 0 offen offset:0 sc1
    s_cmp_lt_u32 s39, 0x10000
    s_cbranch_scc1 L4_alm
L4_mr:
    s_bitcmp1_b32 s5, 0
    s_cbranch_scc1 L4_m1
    s_add_u32 s6, s23, 0
    buffer_load_dwordx4 a[0:3], v6, s[16:19], s6 offen sc1
    s_add_u32 s6, s23, 2359296
    buffer_load_dwordx4 a[4:7], v6, s[16:19], s6 offen sc1
    s_add_u32 s6, s23, 4718592
    buffer_load_dwordx4 a[8:11], v6, s[16:19], s6 offen sc1
    s_add_u32 s6, s23, 7077888
    buffer_load_dwordx4 a[12:15], v6, s[16:19], s6 offen sc1
    s_add_u32 s6, s23, 9437184
    buffer_load_dwordx4 a[16:19], v6, s[16:19], s6 offen sc1
    s_add_u32 s6, s23, 11796480
    buffer_load_dwordx4 a[20:23], v6, s[16:19], s6 offen sc1
    s_add_u32 s6, s23, 14155776
    buffer_load_dwordx4 a[24:27], v6, s[16:19], s6 offen sc1
    s_add_u32 s6, s23, 16515072
    buffer_load_dwordx4 a[28:31], v6, s[16:19], s6 offen sc1
    s_bitcmp1_b32 s5, 1
    s_cbranch_scc0 L4_m1
    s_waitcnt vmcnt(0)
    s_branch L4_got
L4_m1:
    s_add_u32 s6, s7, 0
    buffer_load_dwordx4 a[32:35], v6, s[16:19], s6 offen sc1
    s_add_u32 s6, s7, 2359296
    buffer_load_dwordx4 a[36:39], v6, s[16:19], s6 offen sc1
    s_add_u32 s6, s7, 4718592
    buffer_load_dwordx4 a[40:43], v6, s[16:19], s6 offen sc1
    s_add_u32 s6, s7, 7077888
    buffer_load_dwordx4 a[44:47], v6, s[16:19], s6 offen sc1
    s_add_u32 s6, s7, 9437184
    buffer_load_dwordx4 a[48:51], v6, s[16:19], s6 offen sc1
    s_add_u32 s6, s7, 11796480
    buffer_load_dwordx4 a[52:55], v6, s[16:19], s6 offen sc1
    s_add_u32 s6, s7, 14155776
    buffer_load_dwordx4 a[56:59], v6, s[16:19], s6 offen sc1
    s_add_u32 s6, s7, 16515072
    buffer_load_dwordx4 a[60:63], v6, s[16:19], s6 offen sc1
    s_waitcnt vmcnt(8)
L4_got:
    v_cmp_le_u32 s[56:57], 1, v7
    s_nop 0
    s_cmp_eq_u64 s[56:57], -1
    s_cselect_b32 s62, s3, 0x40000000
    s_cselect_b32 s61, 4, 0
    s_or_b32 s5, s5, s61
    s_nop 3
    v_mfma_f32_32x32x16_bf16 v[84:99], v[188:191], a[0:3], 0
    s_add_u32 s6, s62, 0
    buffer_load_dwordx4 a[64:67], v6, s[16:19], s6 offen sc1
    ds_write_b128 v14, v[240:243] offset:4096
    ds_write_b128 v14, v[244:247] offset:5120
    ds_write_b128 v14, v[248:251] offset:6144
    v_mfma_f32_32x32x16_bf16 v[84:99], v[188:191], a[4:7], v[84:99]
    s_add_u32 s6, s62, 2359296
    buffer_load_dwordx4 a[68:71], v6, s[16:19], s6 offen sc1
    ds_write_b128 v14, v[252:255] offset:7168
    v_add_f32 v224, v224, v196
    v_add_f32 v225, v225, v197
    v_mfma_f32_32x32x16_bf16 v[84:99], v[188:191], a[8:11], v[84:99]
    s_add_u32 s6, s62, 4718592
    buffer_load_dwordx4 a[72:75], v6, s[16:19], s6 offen sc1
    v_add_f32 v226, v226, v198
    v_add_f32 v227, v227, v199
    ds_write_b128 v14, v[224:227] offset:0
    v_mfma_f32_32x32x16_bf16 v[84:99], v[188:191], a[12:15], v[84:99]
    s_add_u32 s6, s62, 7077888
    buffer_load_dwordx4 a[76:79], v6, s[16:19], s6 offen sc1
    v_add_f32 v228, v228, v200
    v_add_f32 v229, v229, v201
    v_add_f32 v230, v230, v202
    v_mfma_f32_32x32x16_bf16 v[84:99], v[188:191], a[16:19], v[84:99]
    s_add_u32 s6, s62, 9437184
    buffer_load_dwordx4 a[80:83], v6, s[16:19], s6 offen sc1
    v_add_f32 v231, v231, v203
    ds_write_b128 v14, v[228:231] offset:1024
    v_add_f32 v232, v232, v204
    v_mfma_f32_32x32x16_bf16 v[84:99], v[188:191], a[20:23], v[84:99]
    s_add_u32 s6, s62, 11796480
    buffer_load_dwordx4 a[84:87], v6, s[16:19], s6 offen sc1
    v_add_f32 v233, v233, v205
    v_add_f32 v234, v234, v206
    v_add_f32 v235, v235, v207
    v_mfma_f32_32x32x16_bf16 v[84:99], v[188:191], a[24:27], v[84:99]
    s_add_u32 s6, s62, 14155776
    buffer_load_dwordx4 a[88:91], v6, s[16:19], s6 offen sc1
    ds_write_b128 v14, v[232:235] offset:2048
    v_add_f32 v236, v236, v208
    v_add_f32 v237, v237, v209
    v_mfma_f32_32x32x16_bf16 v[84:99], v[188:191], a[28:31], v[84:99]
    s_add_u32 s6, s62, 16515072
    buffer_load_dwordx4 a[92:95], v6, s[16:19], s6 offen sc1
    v_add_f32 v238, v238, v210
    v_add_f32 v239, v239, v211
    ds_write_b128 v14, v[236:239] offset:3072
    s_waitcnt lgkmcnt(0)
    s_barrier
    ds_read_b128 v[44:47], v15 offset:0
    ds_read_b128 v[48:51], v15 offset:1024
    ds_read_b128 v[52:55], v15 offset:8192
    ds_read_b128 v[56:59], v15 offset:9216
    ds_read_b128 v[196:199], v10 offset:0
    ds_read_b128 v[200:203], v10 offset:1024
    ds_read_b128 v[204:207], v10 offset:8192
    ds_read_b128 v[208:211], v10 offset:9216
    ds_read_b128 v[212:215], v10 offset:16384
    ds_read_b128 v[216:219], v10 offset:17408
    ds_read_b128 v[220:223], v10 offset:24576
    ds_read_b128 v[224:227], v10 offset:25600
    s_waitcnt vmcnt(8)
    s_bitcmp1_b32 s5, 2
    s_cbranch_scc1 L4_np
    buffer_load_dword v7, v8, s[16:19], 0 offen offset:128 sc1
L4_np:
    v_mfma_f32_32x32x16_bf16 v[84:99], v[192:195], a[96:99], v[84:99]
    v_mfma_f32_32x32x16_bf16 v[100:115], v[192:195], a[100:103], 0
    v_mfma_f32_32x32x16_bf16 v[116:131], v[192:195], a[104:107], 0
    v_mfma_f32_32x32x16_bf16 v[100:115], v[188:191], a[32:35], v[100:115]
    v_mfma_f32_32x32x16_bf16 v[100:115], v[188:191], a[36:39], v[100:115]
    v_mfma_f32_32x32x16_bf16 v[100:115], v[188:191], a[40:43], v[100:115]
    v_mfma_f32_32x32x16_bf16 v[100:115], v[188:191], a[44:47], v[100:115]
    v_mfma_f32_32x32x16_bf16 v[100:115], v[188:191], a[48:51], v[100:115]
    v_mfma_f32_32x32x16_bf16 v[100:115], v[188:191], a[52:55], v[100:115]
    v_mfma_f32_32x32x16_bf16 v[100:115], v[188:191], a[56:59], v[100:115]
    v_mfma_f32_32x32x16_bf16 v[100:115], v[188:191], a[60:63], v[100:115]
    s_waitcnt lgkmcnt(0)
    s_nop 0
    v_pk_fma_f32 v[60:61], v[44:45], v[4:5], v[92:93]
    v_pk_fma_f32 v[62:63], v[46:47], v[4:5], v[94:95]
    v_pk_fma_f32 v[64:65], v[48:49], v[4:5], v[96:97]
    v_pk_fma_f32 v[66:67], v[50:51], v[4:5], v[98:99]
    v_pk_fma_f32 v[60:61], v[52:53], v[26:27], v[60:61]
    v_pk_fma_f32 v[62:63], v[54:55], v[26:27], v[62:63]
    v_pk_fma_f32 v[64:65], v[56:57], v[26:27], v[64:65]
    v_pk_fma_f32 v[66:67], v[58:59], v[26:27], v[66:67]
    v_pk_fma_f32 v[84:85], v[84:85], v[12:13], v[60:61]
    v_pk_fma_f32 v[86:87], v[86:87], v[12:13], v[62:63]
    v_pk_fma_f32 v[88:89], v[88:89], v[12:13], v[64:65]
    v_pk_fma_f32 v[90:91], v[90:91], v[12:13], v[66:67]
    v_cvt_pk_bf16_f32 v132, v84, v85
    v_cvt_pk_bf16_f32 v133, v86, v87
    v_cvt_pk_bf16_f32 v134, v88, v89
    v_cvt_pk_bf16_f32 v135, v90, v91
    ds_write_b128 v2, v[132:135] offset:0
    ds_read_b128 v[144:147], v40 offset:0
    v_pk_add_f32 v[196:197], v[196:197], v[212:213]
    v_pk_add_f32 v[204:205], v[204:205], v[220:221]
    v_pk_add_f32 v[198:199], v[198:199], v[214:215]
    v_pk_add_f32 v[206:207], v[206:207], v[222:223]
    v_pk_add_f32 v[200:201], v[200:201], v[216:217]
    v_pk_add_f32 v[208:209], v[208:209], v[224:225]
    v_pk_add_f32 v[202:203], v[202:203], v[218:219]
    v_pk_add_f32 v[210:211], v[210:211], v[226:227]
    v_pk_fma_f32 v[68:69], v[196:197], v[4:5], v[108:109]
    v_pk_fma_f32 v[70:71], v[198:199], v[4:5], v[110:111]
    v_pk_fma_f32 v[72:73], v[200:201], v[4:5], v[112:113]
    v_pk_fma_f32 v[74:75], v[202:203], v[4:5], v[114:115]
    v_pk_fma_f32 v[68:69], v[204:205], v[24:25], v[68:69]
    v_pk_fma_f32 v[70:71], v[206:207], v[24:25], v[70:71]
    v_pk_fma_f32 v[72:73], v[208:209], v[24:25], v[72:73]
    v_pk_fma_f32 v[74:75], v[210:211], v[24:25], v[74:75]
    v_pk_fma_f32 v[100:101], v[100:101], v[12:13], v[68:69]
    v_pk_fma_f32 v[102:103], v[102:103], v[12:13], v[70:71]
    v_pk_fma_f32 v[104:105], v[104:105], v[12:13], v[72:73]
    v_pk_fma_f32 v[106:107], v[106:107], v[12:13], v[74:75]
    v_cvt_pk_bf16_f32 v136, v100, v101
    v_cvt_pk_bf16_f32 v137, v102, v103
    v_cvt_pk_bf16_f32 v138, v104, v105
    v_cvt_pk_bf16_f32 v139, v106, v107
    ds_write_b128 v2, v[136:139] offset:1024
    ds_read_b128 v[148:151], v40 offset:1024
    v_pk_fma_f32 v[76:77], v[44:45], v[4:5], v[124:125]
    v_pk_fma_f32 v[78:79], v[46:47], v[4:5], v[126:127]
    v_pk_fma_f32 v[80:81], v[48:49], v[4:5], v[128:129]
    v_pk_fma_f32 v[82:83], v[50:51], v[4:5], v[130:131]
    v_pk_fma_f32 v[76:77], v[52:53], v[26:27], v[76:77] neg_lo:[1,0,0] neg_hi:[1,0,0]
    v_pk_fma_f32 v[78:79], v[54:55], v[26:27], v[78:79] neg_lo:[1,0,0] neg_hi:[1,0,0]
    v_pk_fma_f32 v[80:81], v[56:57], v[26:27], v[80:81] neg_lo:[1,0,0] neg_hi:[1,0,0]
    v_pk_fma_f32 v[82:83], v[58:59], v[26:27], v[82:83] neg_lo:[1,0,0] neg_hi:[1,0,0]
    s_waitcnt lgkmcnt(0)
    s_bitcmp1_b32 s5, 2
    s_cbranch_scc1 L4_lt
    s_mov_b32 s39, 0
L4_all:
    s_waitcnt vmcnt(0)
    v_cmp_le_u32 s[56:57], 1, v7
    s_add_u32 s39, s39, 1
    s_cmp_eq_u64 s[56:57], -1
    s_cbranch_scc1 L4_lr
    s_sleep 4
    buffer_load_dword v7, v8, s[16:19], 0 offen offset:128 sc1
    s_cmp_lt_u32 s39, 0x10000
    s_cbranch_scc1 L4_all
L4_lr:
    s_add_u32 s6, s3, 0
    buffer_load_dwordx4 a[64:67], v6, s[16:19], s6 offen sc1
    s_add_u32 s6, s3, 2359296
    buffer_load_dwordx4 a[68:71], v6, s[16:19], s6 offen sc1
    s_add_u32 s6, s3, 4718592
    buffer_load_dwordx4 a[72:75], v6, s[16:19], s6 offen sc1
    s_add_u32 s6, s3, 7077888
    buffer_load_dwordx4 a[76:79], v6, s[16:19], s6 offen sc1
    s_add_u32 s6, s3, 9437184
    buffer_load_dwordx4 a[80:83], v6, s[16:19], s6 offen sc1
    s_add_u32 s6, s3, 11796480
    buffer_load_dwordx4 a[84:87], v6, s[16:19], s6 offen sc1
    s_add_u32 s6, s3, 14155776
    buffer_load_dwordx4 a[88:91], v6, s[16:19], s6 offen sc1
    s_add_u32 s6, s3, 16515072
    buffer_load_dwordx4 a[92:95], v6, s[16:19], s6 offen sc1
L4_lt:
    s_waitcnt vmcnt(7)
    v_mfma_f32_32x32x16_bf16 v[116:131], v[188:191], a[64:67], v[116:131]
    s_waitcnt vmcnt(6)
    v_mfma_f32_32x32x16_bf16 v[116:131], v[188:191], a[68:71], v[116:131]
    s_waitcnt vmcnt(5)
    v_mfma_f32_32x32x16_bf16 v[116:131], v[188:191], a[72:75], v[116:131]
    s_waitcnt vmcnt(4)
    v_mfma_f32_32x32x16_bf16 v[116:131], v[188:191], a[76:79], v[116:131]
    s_waitcnt vmcnt(3)
    v_mfma_f32_32x32x16_bf16 v[116:131], v[188:191], a[80:83], v[116:131]
    s_waitcnt vmcnt(2)
    v_mfma_f32_32x32x16_bf16 v[116:131], v[188:191], a[84:87], v[116:131]
    s_waitcnt vmcnt(1)
    v_mfma_f32_32x32x16_bf16 v[116:131], v[188:191], a[88:91], v[116:131]
    s_waitcnt vmcnt(0)
    v_mfma_f32_32x32x16_bf16 v[116:131], v[188:191], a[92:95], v[116:131]
    buffer_store_dwordx4 v[144:147], v41, s[12:15], s96 offen sc1 nt
    buffer_store_dwordx4 v[148:151], v41, s[12:15], s97 offen sc1 nt
    s_nop 9
    v_pk_fma_f32 v[116:117], v[116:117], v[12:13], v[76:77]
    v_pk_fma_f32 v[118:119], v[118:119], v[12:13], v[78:79]
    v_pk_fma_f32 v[120:121], v[120:121], v[12:13], v[80:81]
    v_pk_fma_f32 v[122:123], v[122:123], v[12:13], v[82:83]
    v_cvt_pk_bf16_f32 v140, v116, v117
    v_cvt_pk_bf16_f32 v141, v118, v119
    v_cvt_pk_bf16_f32 v142, v120, v121
    v_cvt_pk_bf16_f32 v143, v122, v123
    ds_write_b128 v2, v[140:143] offset:2048
    ds_read_b128 v[152:155], v40 offset:2048
    s_waitcnt lgkmcnt(0)
    buffer_store_dwordx4 v[152:155], v41, s[12:15], s98 offen sc1 nt
L4_done:
L2_end:
    s_endpgm
L2_visit:
    s_bitcmp1_b32 s100, 0
    s_cbranch_scc1 L2_pad0
L2_ret0:
    s_bitcmp1_b32 s100, 1
    s_cbranch_scc1 L2_pad1
L2_ret1:
    s_bitcmp1_b32 s100, 2
    s_cbranch_scc1 L2_pad2
L2_ret2:
    s_bitcmp1_b32 s100, 3
    s_cbranch_scc1 L2_pad3
L2_ret3:
    s_bitcmp1_b32 s100, 4
    s_cbranch_scc1 L2_pad4
L2_ret4:
    s_bitcmp1_b32 s100, 5
    s_cbranch_scc1 L2_pad5
L2_ret5:
    s_bitcmp1_b32 s100, 6
    s_cbranch_scc1 L2_pad6
L2_ret6:
    s_bitcmp1_b32 s100, 7
    s_cbranch_scc1 L2_pad7
L2_ret7:
    s_bitcmp1_b32 s100, 8
    s_cbranch_scc1 L2_pad8
L2_ret8:
    s_bitcmp1_b32 s100, 9
    s_cbranch_scc1 L2_pad9
L2_ret9:
    s_cmp_eq_u32 s101, 0
    s_cbranch_scc1 L2_vret0
    s_branch L2_vret1
L2_spin0:
    s_mov_b32 s39, 0
L2_sl0:
    buffer_load_dword v7, v6, s[16:19], s47 offen sc1
    s_waitcnt vmcnt(0)
    v_cmp_le_u32 vcc, 1, v7
    s_nop 1
    s_cmp_eq_u64 vcc, -1
    s_cbranch_scc1 L2_ok0
    s_add_u32 s39, s39, 1
    s_cmp_lt_u32 s39, 0x10000
    s_cbranch_scc1 L2_sl0
    s_branch L2_ok0
L2_spin1:
    s_mov_b32 s39, 0
L2_sl1:
    buffer_load_dword v7, v6, s[16:19], s47 offen sc1
    s_waitcnt vmcnt(0)
    v_cmp_le_u32 vcc, 2, v7
    s_nop 1
    s_cmp_eq_u64 vcc, -1
    s_cbranch_scc1 L2_ok1
    s_add_u32 s39, s39, 1
    s_cmp_lt_u32 s39, 0x10000
    s_cbranch_scc1 L2_sl1
    s_branch L2_ok1
L2_spin2:
    s_mov_b32 s39, 0
L2_sl2:
    buffer_load_dword v7, v6, s[16:19], s47 offen sc1
    s_waitcnt vmcnt(0)
    v_cmp_le_u32 vcc, 3, v7
    s_nop 1
    s_cmp_eq_u64 vcc, -1
    s_cbranch_scc1 L2_ok2
    s_add_u32 s39, s39, 1
    s_cmp_lt_u32 s39, 0x10000
    s_cbranch_scc1 L2_sl2
    s_branch L2_ok2
L2_xspin:
    s_mov_b32 s39, 0
L2_xsl:
    buffer_load_dword v252, v253, s[16:19], s24 offen sc1
    s_waitcnt vmcnt(0)
    s_cmp_eq_u32 s3, -1
    s_cbranch_scc1 L2_nopubb
    v_mov_b32 v251, 1
    v_accvgpr_read_b32 v255, a1
    s_mov_b64 exec, 1
    ds_add_rtn_u32 v251, v250, v251
    v_add_u32 v255, 1, v255
    s_waitcnt lgkmcnt(0)
    v_readfirstlane_b32 s25, v251
    s_nop 0
    s_cmp_lg_u32 s25, s3
    s_cbranch_scc1 L2_nopub1b
    buffer_store_dword v255, v249, s[16:19], s24 offen sc1
L2_nopub1b:
    s_mov_b64 exec, -1
    s_mov_b32 s3, -1
L2_nopubb:
    v_cmp_ne_u32 vcc, v252, v238
    s_nop 1
    s_cmp_eq_u64 vcc, -1
    s_cbranch_scc1 L2_xok
    s_sleep 4
    s_add_u32 s39, s39, 1
    s_cmp_lt_u32 s39, 0x10000
    s_cbranch_scc1 L2_xsl
    s_branch L2_xok
L2_gspin:
    s_mov_b32 s39, 0
L2_gsl:
    buffer_load_dword v7, v58, s[16:19], s24 offen sc1
    s_waitcnt vmcnt(0)
    v_cmp_ne_u32 vcc, v220, v7
    s_nop 1
    s_cmp_eq_u64 vcc, -1
    s_cbranch_scc1 L2_gok
    s_sleep 4
    s_add_u32 s39, s39, 1
    s_cmp_lt_u32 s39, 0x10000
    s_cbranch_scc1 L2_gsl
    s_branch L2_gok
L2_uspin:
    s_mov_b32 s39, 0
L2_usl:
    buffer_load_dword v7, v58, s[16:19], s24 offen sc1
    s_waitcnt vmcnt(0)
    v_cmp_ne_u32 vcc, v220, v7
    s_nop 1
    s_cmp_eq_u64 vcc, -1
    s_cbranch_scc1 L2_uok
    s_sleep 4
    s_add_u32 s39, s39, 1
    s_cmp_lt_u32 s39, 0x10000
    s_cbranch_scc1 L2_usl
    s_branch L2_uok
L_text_end:
.section .rodata,"a"
.p2align 6
.amdhsa_kernel parallel_sum__spectral_gfnet__dense_activation_mish__prompt_kernel
  .amdhsa_next_free_vgpr 512
  .amdhsa_next_free_sgpr 102
  .amdhsa_accum_offset 256
  .amdhsa_group_segment_fixed_size 0
  .amdhsa_kernarg_size 80
  .amdhsa_user_sgpr_count 2
  .amdhsa_user_sgpr_kernarg_segment_ptr 1
  .amdhsa_system_sgpr_workgroup_id_x 1
  .amdhsa_float_denorm_mode_32 3
.end_amdhsa_kernel
```
